```python
import torch

def _softmax(x, axis=-1):
    return torch.softmax(x, dim=axis)

def _gelu(x):
    return torch.nn.functional.gelu(x, approximate='tanh')

def _silu(x):
    return torch.nn.functional.silu(x)

def _sigmoid(x):
    return torch.sigmoid(x)

def _layernorm(x, axis=-1, eps=1e-05):
    m = x.mean(dim=axis, keepdim=True)
    v = x.var(dim=axis, keepdim=True, unbiased=False)
    return (x - m) / torch.sqrt(v + eps)

def _scatter_add(tgt, idx, src, axis=0):
    return tgt.clone().index_add_(axis, idx, src)

def _segment_sum(src, seg, n):
    out = torch.zeros((n,) + src.shape[1:], dtype=src.dtype)
    return out.index_add_(0, seg, src)

def _pad(x, pw):
    flat = tuple((v for pair in reversed(pw) for v in pair))
    return torch.nn.functional.pad(x, flat)
kernel_name = 'gated_mix__memory_aug_recurrent_mem_tr__swiglu_ffn__prompt'

def setup_inputs():

    _w = lambda a: (lambda t: t.to(torch.bfloat16) if t.is_floating_point() else t)(torch.as_tensor(a))

    def _A_setup():
        B, S, Dm = (1, 2048, 576)
        H, Dh = (32, 128)
        M, seg = (8, 32)
        seg = min(seg, S)
        S = S // seg * seg
        return {'x': _w((lambda *s: torch.randn(*s, dtype=torch.bfloat16) * 0.05)(B, S, Dm)), 'mem0': _w((lambda *s: torch.randn(*s, dtype=torch.bfloat16) * 0.4)(B, M, Dm)), 'Wq': _w((lambda *s: torch.randn(*s, dtype=torch.bfloat16) * 6.4)(Dm, H, Dh) * Dm ** (-0.5)), 'Wk': _w((lambda *s: torch.randn(*s, dtype=torch.bfloat16) * 6.4)(Dm, H, Dh) * Dm ** (-0.5)), 'Wv': _w((lambda *s: torch.randn(*s, dtype=torch.bfloat16) * 0.4)(Dm, H, Dh) * Dm ** (-0.5)), 'Wo': _w((lambda *s: torch.randn(*s, dtype=torch.bfloat16) * 0.4)(H, Dh, Dm) * (H * Dh) ** (-0.5)), 'seg_len': seg}
    _A_in = _A_setup()

    def _B_setup():
        B, S, D, F = (1, 2048, 576, 4608)
        return {'x': _w((lambda *s: torch.randn(*s, dtype=torch.bfloat16) * 0.05)(B, S, D)), 'w_gate': _w((lambda *s: torch.randn(*s, dtype=torch.bfloat16) * 0.05)(D, F)), 'w_up': _w((lambda *s: torch.randn(*s, dtype=torch.bfloat16) * 0.05)(D, F)), 'w_down': _w((lambda *s: torch.randn(*s, dtype=torch.bfloat16) * 0.05)(F, D))}
    _B_in = _B_setup()
    return {'A_x': _A_in['x'], 'A_mem0': _A_in['mem0'], 'A_Wq': _A_in['Wq'], 'A_Wk': _A_in['Wk'], 'A_Wv': _A_in['Wv'], 'A_Wo': _A_in['Wo'], 'A_seg_len': _A_in['seg_len'], 'B_x': _B_in['x'], 'B_w_gate': _B_in['w_gate'], 'B_w_up': _B_in['w_up'], 'B_w_down': _B_in['w_down'], 'gate_w': _w((lambda *s: torch.randn(*s, dtype=torch.bfloat16) * 0.05)(576) * 16.0)}

def reference(A_x, A_mem0, A_Wq, A_Wk, A_Wv, A_Wo, A_seg_len, B_x, B_w_gate, B_w_up, B_w_down, gate_w):

    def _A_ref(x, mem0, Wq, Wk, Wv, Wo, seg_len):
        B, S, Dm = x.shape
        H, Dh = (Wq.shape[1], Wq.shape[2])
        M = mem0.shape[1]
        scale = Dh ** (-0.5)
        n_seg = S // seg_len
        L = M + seg_len
        idx = torch.arange(L)
        mask = (idx[:, None] < M) | (idx[:, None] >= idx[None, :])
        mem = mem0
        outs = []
        for s in range(n_seg):
            xs = x[:, s * seg_len:(s + 1) * seg_len, :].clone()
            h = torch.concatenate([mem, xs], axis=1)
            q = torch.einsum('btd,dhe->bhte', h, Wq)
            k = torch.einsum('btd,dhe->bhte', h, Wk)
            v = torch.einsum('btd,dhe->bhte', h, Wv)
            scores = torch.einsum('bhqe,bhke->bhqk', q, k) * scale
            scores = torch.where(mask[None, None], scores, -1000000000.0)
            p = _softmax(scores, axis=-1)
            o = torch.einsum('bhqk,bhke->bhqe', p, v)
            o = torch.einsum('bhte,hed->btd', o, Wo)
            mem = o[:, :M, :].clone()
            outs.append(o[:, M:, :])
        return torch.concatenate(outs, axis=1)

    def _B_ref(x, w_gate, w_up, w_down):
        g = _silu(x @ w_gate)
        u = x @ w_up
        return g * u @ w_down
    x = A_x
    g = _sigmoid((x * gate_w).sum(-1, keepdims=True))
    a = _A_ref(x, A_mem0, A_Wq, A_Wk, A_Wv, A_Wo, A_seg_len)
    b = _B_ref(x, B_w_gate, B_w_up, B_w_down)
    return g * a + (1 - g) * b
```

```asm
; @launch grid=(256,1,1) block=(256,1,1) lds=163840
.amdgcn_target "amdgcn-amd-amdhsa--gfx950"
.text
.globl gated_mix__memory_aug_recurrent_mem_tr__swiglu_ffn__prompt_kernel
.p2align 8
.type gated_mix__memory_aug_recurrent_mem_tr__swiglu_ffn__prompt_kernel,@function
gated_mix__memory_aug_recurrent_mem_tr__swiglu_ffn__prompt_kernel:
  s_cmp_ge_u32 s2, 256
  s_cbranch_scc1 L_main_exit
  s_load_dwordx2 s[40:41], s[0:1], 0
  s_load_dwordx2 s[42:43], s[0:1], 16
  s_load_dwordx2 s[44:45], s[0:1], 24
  s_load_dwordx2 s[46:47], s[0:1], 32
  s_load_dwordx2 s[56:57], s[0:1], 40
  s_load_dwordx2 s[48:49], s[0:1], 56
  s_load_dwordx2 s[50:51], s[0:1], 64
  s_load_dwordx2 s[52:53], s[0:1], 72
  s_load_dwordx2 s[54:55], s[0:1], 80
  s_load_dwordx2 s[58:59], s[0:1], 88
  s_load_dwordx2 s[60:61], s[0:1], 96
  s_load_dwordx2 s[16:17], s[0:1], 112
  v_lshrrev_b32 v1, 6, v0
  s_nop 0
  v_readfirstlane_b32 s31, v1
  s_waitcnt lgkmcnt(0)
  s_mov_b32 s18, 0x10000000
  s_mov_b32 s19, 0x00020000
  s_load_dwordx2 s[62:63], s[0:1], 104
  s_waitcnt lgkmcnt(0)
  s_getreg_b32 s68, hwreg(HW_REG_XCC_ID, 0, 4)
  s_and_b32 s68, s68, 7
  s_cmp_lg_u32 s31, 0
  s_cbranch_scc1 L_role_wait
  s_cmp_eq_u32 s68, 0
  s_cselect_b32 s69, 1, 0
  s_mov_b64 s[66:67], exec
  s_mov_b64 exec, 1
  v_mov_b32 v2, 32
  v_mov_b32 v4, s69
  v_mov_b32 v5, 1
  global_atomic_add_x2 v[6:7], v2, v[4:5], s[62:63] sc0 sc1
  s_waitcnt vmcnt(0)
  v_readfirstlane_b32 s70, v6
  v_readfirstlane_b32 s71, v7
  s_mov_b64 exec, s[66:67]
  s_cmp_eq_u32 s68, 0
  s_cbranch_scc0 L_role_other
  s_mov_b32 s69, s70
  s_branch L_role_have
L_role_other:
  s_sub_u32 s71, 255, s71
  s_add_u32 s71, s71, s70
  s_mov_b32 s69, 1000
  s_cmp_lt_u32 s71, 32
  s_cbranch_scc0 L_role_have
  s_mov_b64 s[66:67], exec
  s_mov_b64 exec, 1
  v_mov_b32 v2, 32
  v_mov_b32 v3, 1
  global_atomic_add v4, v2, v3, s[62:63] sc0 sc1
  s_waitcnt vmcnt(0)
  v_readfirstlane_b32 s69, v4
  s_mov_b64 exec, s[66:67]
L_role_have:
  v_mov_b32 v2, 159744
  v_mov_b32 v3, s69
  ds_write_b32 v2, v3
  s_waitcnt lgkmcnt(0)
L_role_wait:
  s_barrier
  v_mov_b32 v2, 159744
  ds_read_b32 v3, v2
  s_waitcnt lgkmcnt(0)
  v_readfirstlane_b32 s69, v3
  s_nop 3
  s_barrier
  s_cmp_lt_u32 s69, 32
  s_cbranch_scc1 L_chain
  s_sub_u32 s72, s68, 1
  s_cmp_eq_u32 s68, 0
  s_cselect_b32 s72, 0, s72
  s_mov_b32 s73, 0
  v_and_b32 v1, 63, v0
  v_and_b32 v2, 31, v1
  v_lshrrev_b32 v3, 5, v1
  s_lshr_b32 s27, s31, 1
  s_lshl_b32 s27, s27, 14
  v_lshlrev_b32 v4, 7, v2
  v_add_u32 v4, s27, v4
  v_lshrrev_b32 v5, 1, v2
  v_and_b32 v5, 7, v5
  v_xor_b32 v5, v5, v3
  v_lshlrev_b32 v5, 4, v5
  v_add_u32 v80, v4, v5
  v_xor_b32 v81, 32, v80
  v_xor_b32 v82, 64, v80
  v_xor_b32 v83, 96, v80
  v_lshrrev_b32 v4, 3, v1
  v_mul_u32_u24 v4, 1152, v4
  v_and_b32 v5, 7, v1
  v_lshrrev_b32 v6, 4, v1
  v_xor_b32 v5, v5, v6
  v_lshlrev_b32 v7, 4, v5
  v_add_u32 v88, v4, v7
  v_xor_b32 v5, 4, v5
  v_lshlrev_b32 v7, 4, v5
  v_add_u32 v89, v4, v7
L_wq_next:
  s_cmp_lg_u32 s31, 0
  s_cbranch_scc1 L_wq_wait
  s_add_u32 s74, s72, 16
  s_lshl_b32 s74, s74, 2
  s_mov_b64 s[66:67], exec
  s_mov_b64 exec, 1
  v_mov_b32 v2, s74
  v_mov_b32 v3, 1
  global_atomic_add v4, v2, v3, s[62:63] sc0 sc1
  s_waitcnt vmcnt(0)
  v_readfirstlane_b32 s75, v4
  s_mov_b64 exec, s[66:67]
  v_mov_b32 v2, 159744
  v_mov_b32 v3, s75
  ds_write_b32 v2, v3
  s_waitcnt lgkmcnt(0)
L_wq_wait:
  s_barrier
  v_mov_b32 v2, 159744
  ds_read_b32 v3, v2
  s_waitcnt lgkmcnt(0)
  v_readfirstlane_b32 s75, v3
  s_nop 3
  s_barrier
  s_cmp_lt_u32 s75, 96
  s_cbranch_scc1 L_wq_job
  s_add_u32 s72, s72, 1
  s_cmp_eq_u32 s72, 7
  s_cselect_b32 s72, 0, s72
  s_add_u32 s73, s73, 1
  s_cmp_lt_u32 s73, 7
  s_cbranch_scc1 L_wq_next
  s_branch L_wd_start
L_wq_job:
  s_lshr_b32 s76, s75, 5
  s_mul_i32 s76, s76, 7
  s_add_u32 s76, s76, s72
  s_and_b32 s77, s75, 31
  s_lshr_b32 s78, s77, 3
  s_and_b32 s79, s77, 7
  s_cmp_lt_u32 s76, 8
  s_cbranch_scc0 L_wq_notkv
  s_lshr_b32 s27, s76, 2
  s_lshl_b32 s27, s27, 2
  s_add_u32 s34, s27, s78
  s_and_b32 s27, s76, 3
  s_lshl_b32 s27, s27, 3
  s_add_u32 s35, s27, s79
  s_cmp_ge_u32 s35, 16
  s_cselect_b32 s33, 1, 0
  s_and_b32 s35, s35, 15
  s_branch L_wq_dec
L_wq_notkv:
  s_cmp_lt_u32 s76, 12
  s_cbranch_scc0 L_wq_h
  s_sub_u32 s28, s76, 8
  s_lshr_b32 s27, s28, 1
  s_lshl_b32 s27, s27, 2
  s_add_u32 s34, s27, s78
  s_and_b32 s27, s28, 1
  s_lshl_b32 s27, s27, 3
  s_add_u32 s35, s27, s79
  s_mov_b32 s33, 2
  s_branch L_wq_dec
L_wq_h:
  s_mov_b32 s33, 3
  s_cmp_eq_u32 s76, 20
  s_cbranch_scc1 L_wq_h20
  s_sub_u32 s28, s76, 12
  s_lshr_b32 s27, s28, 2
  s_lshl_b32 s27, s27, 2
  s_add_u32 s34, s27, s78
  s_and_b32 s27, s28, 3
  s_lshl_b32 s27, s27, 3
  s_add_u32 s35, s27, s79
  s_branch L_wq_dec
L_wq_h20:
  s_lshr_b32 s34, s77, 2
  s_and_b32 s35, s77, 3
  s_lshl_b32 s90, s34, 3
  s_lshl_b32 s91, s35, 6
  s_add_u32 s92, s91, 32
  s_add_u32 s35, s35, 32
  s_branch L_wq_dec2
L_wq_dec:
  s_lshl_b32 s90, s78, 4
  s_lshl_b32 s91, s79, 5
  s_mov_b32 s92, 0x1000
L_wq_dec2:
  s_cmp_eq_u32 s33, 3
  s_cselect_b32 s36, 1, 0
  s_mov_b32 s37, 8192
  s_cselect_b32 s37, 9216, s37
  s_mov_b32 s8, s40
  s_mov_b32 s9, s41
  s_mov_b32 s10, 2359296
  s_mov_b32 s11, 0x00020000
  s_mov_b32 s12, s44
  s_mov_b32 s13, s45
  s_cmp_eq_u32 s33, 1
  s_cselect_b32 s12, s46, s12
  s_cselect_b32 s13, s47, s13
  s_cmp_eq_u32 s33, 2
  s_cselect_b32 s12, s42, s12
  s_cselect_b32 s13, s43, s13
  s_mov_b32 s14, 4718592
  s_cmp_eq_u32 s33, 3
  s_cbranch_scc0 L_j_nhw
  s_cmp_lt_u32 s31, 2
  s_cselect_b32 s12, s50, s52
  s_cselect_b32 s13, s51, s53
  s_mov_b32 s14, 5308416
L_j_nhw:
  s_mov_b32 s15, 0x00020000
  s_lshl_b32 s27, s34, 8
  s_lshl_b32 s28, s31, 6
  s_add_u32 s27, s27, s28
  s_mul_i32 s20, s27, 1152
  s_lshl_b32 s24, s31, 13
  s_lshr_b32 s27, s31, 1
  s_and_b32 s28, s31, 1
  s_mul_i32 s21, s28, s37
  s_lshl_b32 s21, s21, 5
  s_lshl_b32 s29, s35, 9
  s_lshl_b32 s30, s27, 8
  s_add_u32 s29, s29, s30
  s_lshl_b32 s30, s35, 8
  s_cmp_eq_u32 s36, 1
  s_cselect_b32 s29, s30, s29
  s_add_u32 s21, s21, s29
  s_lshl_b32 s25, s27, 14
  s_lshl_b32 s28, s28, 13
  s_add_u32 s25, s25, s28
  s_add_u32 s25, s25, 32768
  s_lshl_b32 s22, s37, 2
  s_lshl_b32 s23, s37, 6
  v_and_b32 v1, 63, v0
  v_lshrrev_b32 v2, 4, v1
  v_and_b32 v3, 15, v1
  v_lshrrev_b32 v4, 2, v3
  v_and_b32 v5, 3, v3
  v_lshrrev_b32 v6, 1, v2
  v_lshlrev_b32 v6, 3, v6
  v_add_u32 v6, v6, v4
  v_lshlrev_b32 v6, 8, v6
  v_and_b32 v7, 1, v2
  v_lshlrev_b32 v7, 1, v7
  v_lshrrev_b32 v8, 1, v5
  v_add_u32 v7, v7, v8
  v_lshlrev_b32 v7, 4, v7
  v_and_b32 v8, 1, v5
  v_lshlrev_b32 v8, 3, v8
  v_add3_u32 v6, v6, v7, v8
  v_add_u32 v6, 32768, v6
  v_lshlrev_b32 v7, 6, v4
  s_and_b32 s27, s31, 1
  s_lshl_b32 s28, s27, 14
  s_mov_b32 s29, 0
  s_lshl_b32 s30, s27, 7
  s_add_u32 s30, s30, 0
  s_cmp_eq_u32 s36, 0
  s_cselect_b32 s28, s28, 0
  s_cselect_b32 s29, s29, s30
  v_xor_b32 v8, s29, v7
  v_add3_u32 v84, v6, v8, s28
  s_lshl_b32 s28, s27, 14
  s_mov_b32 s29, 64
  s_lshl_b32 s30, s27, 7
  s_add_u32 s30, s30, 64
  s_cmp_eq_u32 s36, 0
  s_cselect_b32 s28, s28, 0
  s_cselect_b32 s29, s29, s30
  v_xor_b32 v8, s29, v7
  v_add3_u32 v85, v6, v8, s28
  s_lshl_b32 s28, s27, 14
  s_mov_b32 s29, 128
  s_lshl_b32 s30, s27, 7
  s_add_u32 s30, s30, 0
  s_cmp_eq_u32 s36, 0
  s_cselect_b32 s28, s28, 16384
  s_cselect_b32 s29, s29, s30
  v_xor_b32 v8, s29, v7
  v_add3_u32 v86, v6, v8, s28
  s_lshl_b32 s28, s27, 14
  s_mov_b32 s29, 192
  s_lshl_b32 s30, s27, 7
  s_add_u32 s30, s30, 64
  s_cmp_eq_u32 s36, 0
  s_cselect_b32 s28, s28, 16384
  s_cselect_b32 s29, s29, s30
  v_xor_b32 v8, s29, v7
  v_add3_u32 v87, v6, v8, s28
  v_lshrrev_b32 v2, 4, v1
  v_mul_lo_u32 v4, v2, s37
  v_lshlrev_b32 v5, 2, v2
  v_xor_b32 v5, v3, v5
  v_lshlrev_b32 v5, 4, v5
  v_add_u32 v90, v4, v5
  v_and_b32 v1, 63, v0
  s_and_b32 s27, s31, 1
  s_cmp_eq_u32 s27, 0
  s_cbranch_scc0 L_j_txw
  s_mov_b32 s84, s12
  s_mov_b32 s85, s13
  s_mov_b32 s86, s14
  s_mov_b32 s87, 0x00020000
  v_lshrrev_b32 v2, 2, v1
  v_mul_lo_u32 v2, v2, s37
  v_and_b32 v3, 3, v1
  v_lshlrev_b32 v3, 6, v3
  v_add_u32 v92, v2, v3
  s_add_u32 s28, s90, 128
  s_mul_i32 s28, s28, s37
  s_add_u32 s88, s21, s28
  s_mov_b32 s89, s23
  s_branch L_j_tdw
L_j_txw:
  s_mov_b32 s84, s8
  s_mov_b32 s85, s9
  s_mov_b32 s86, s10
  s_mov_b32 s87, 0x00020000
  v_lshrrev_b32 v2, 1, v1
  v_mul_u32_u24 v2, 1152, v2
  v_and_b32 v3, 1, v1
  v_lshlrev_b32 v3, 6, v3
  v_add_u32 v92, v2, v3
  s_cmp_eq_u32 s31, 1
  s_cselect_b32 s28, s91, s92
  s_lshl_b32 s29, s34, 8
  s_add_u32 s28, s28, s29
  s_mul_i32 s88, s28, 1152
  s_add_u32 s88, s88, 256
  s_mov_b32 s89, 128
L_j_tdw:
  s_cmp_eq_u32 s33, 1
  s_cbranch_scc1 L_j_vw
  s_mov_b32 s32, 0
  s_add_u32 m0, s24, s32
  s_mov_b32 s27, s20
  buffer_load_dwordx4 v88, s[8:11], s27 offen lds
  s_add_u32 m0, m0, 1024
  s_add_u32 s27, s27, 9216
  buffer_load_dwordx4 v89, s[8:11], s27 offen lds
  s_add_u32 m0, m0, 1024
  s_add_u32 s27, s27, 9216
  buffer_load_dwordx4 v88, s[8:11], s27 offen lds
  s_add_u32 m0, m0, 1024
  s_add_u32 s27, s27, 9216
  buffer_load_dwordx4 v89, s[8:11], s27 offen lds
  s_add_u32 m0, m0, 1024
  s_add_u32 s27, s27, 9216
  buffer_load_dwordx4 v88, s[8:11], s27 offen lds
  s_add_u32 m0, m0, 1024
  s_add_u32 s27, s27, 9216
  buffer_load_dwordx4 v89, s[8:11], s27 offen lds
  s_add_u32 m0, m0, 1024
  s_add_u32 s27, s27, 9216
  buffer_load_dwordx4 v88, s[8:11], s27 offen lds
  s_add_u32 m0, m0, 1024
  s_add_u32 s27, s27, 9216
  buffer_load_dwordx4 v89, s[8:11], s27 offen lds
  s_add_u32 m0, s25, s32
  s_mov_b32 s27, s21
  buffer_load_dwordx4 v90, s[12:15], s27 offen lds
  s_add_u32 m0, m0, 1024
  s_add_u32 s27, s27, s22
  buffer_load_dwordx4 v90, s[12:15], s27 offen lds
  s_add_u32 m0, m0, 1024
  s_add_u32 s27, s27, s22
  buffer_load_dwordx4 v90, s[12:15], s27 offen lds
  s_add_u32 m0, m0, 1024
  s_add_u32 s27, s27, s22
  buffer_load_dwordx4 v90, s[12:15], s27 offen lds
  s_add_u32 m0, m0, 1024
  s_add_u32 s27, s27, s22
  buffer_load_dwordx4 v90, s[12:15], s27 offen lds
  s_add_u32 m0, m0, 1024
  s_add_u32 s27, s27, s22
  buffer_load_dwordx4 v90, s[12:15], s27 offen lds
  s_add_u32 m0, m0, 1024
  s_add_u32 s27, s27, s22
  buffer_load_dwordx4 v90, s[12:15], s27 offen lds
  s_add_u32 m0, m0, 1024
  s_add_u32 s27, s27, s22
  buffer_load_dwordx4 v90, s[12:15], s27 offen lds
  s_add_u32 s20, s20, 128
  s_add_u32 s21, s21, s23
  s_xor_b32 s32, s32, 0x10000
  s_add_u32 m0, s24, s32
  s_mov_b32 s27, s20
  buffer_load_dwordx4 v88, s[8:11], s27 offen lds
  s_add_u32 m0, m0, 1024
  s_add_u32 s27, s27, 9216
  buffer_load_dwordx4 v89, s[8:11], s27 offen lds
  s_add_u32 m0, m0, 1024
  s_add_u32 s27, s27, 9216
  buffer_load_dwordx4 v88, s[8:11], s27 offen lds
  s_add_u32 m0, m0, 1024
  s_add_u32 s27, s27, 9216
  buffer_load_dwordx4 v89, s[8:11], s27 offen lds
  s_add_u32 m0, m0, 1024
  s_add_u32 s27, s27, 9216
  buffer_load_dwordx4 v88, s[8:11], s27 offen lds
  s_add_u32 m0, m0, 1024
  s_add_u32 s27, s27, 9216
  buffer_load_dwordx4 v89, s[8:11], s27 offen lds
  s_add_u32 m0, m0, 1024
  s_add_u32 s27, s27, 9216
  buffer_load_dwordx4 v88, s[8:11], s27 offen lds
  s_add_u32 m0, m0, 1024
  s_add_u32 s27, s27, 9216
  buffer_load_dwordx4 v89, s[8:11], s27 offen lds
  s_add_u32 m0, s25, s32
  s_mov_b32 s27, s21
  buffer_load_dwordx4 v90, s[12:15], s27 offen lds
  s_add_u32 m0, m0, 1024
  s_add_u32 s27, s27, s22
  buffer_load_dwordx4 v90, s[12:15], s27 offen lds
  s_add_u32 m0, m0, 1024
  s_add_u32 s27, s27, s22
  buffer_load_dwordx4 v90, s[12:15], s27 offen lds
  s_add_u32 m0, m0, 1024
  s_add_u32 s27, s27, s22
  buffer_load_dwordx4 v90, s[12:15], s27 offen lds
  s_add_u32 m0, m0, 1024
  s_add_u32 s27, s27, s22
  buffer_load_dwordx4 v90, s[12:15], s27 offen lds
  s_add_u32 m0, m0, 1024
  s_add_u32 s27, s27, s22
  buffer_load_dwordx4 v90, s[12:15], s27 offen lds
  s_add_u32 m0, m0, 1024
  s_add_u32 s27, s27, s22
  buffer_load_dwordx4 v90, s[12:15], s27 offen lds
  s_add_u32 m0, m0, 1024
  s_add_u32 s27, s27, s22
  buffer_load_dwordx4 v90, s[12:15], s27 offen lds
  s_add_u32 s20, s20, 128
  s_add_u32 s21, s21, s23
  s_xor_b32 s32, s32, 0x10000
  s_waitcnt vmcnt(16)
  s_barrier
  ds_read_b128 v[16:19], v80 offset:0
  ds_read_b128 v[20:23], v80 offset:4096
  ds_read_b128 v[24:27], v80 offset:8192
  ds_read_b128 v[28:31], v80 offset:12288
  ds_read_b64_tr_b16 v[48:49], v84 offset:0
  ds_read_b64_tr_b16 v[50:51], v84 offset:1024
  ds_read_b64_tr_b16 v[52:53], v85 offset:0
  ds_read_b64_tr_b16 v[54:55], v85 offset:1024
  ds_read_b64_tr_b16 v[56:57], v86 offset:0
  ds_read_b64_tr_b16 v[58:59], v86 offset:1024
  ds_read_b64_tr_b16 v[60:61], v87 offset:0
  ds_read_b64_tr_b16 v[62:63], v87 offset:1024
  ds_read_b128 v[32:35], v81 offset:0
  s_waitcnt lgkmcnt(7)
  v_mfma_f32_32x32x16_bf16 a[0:15], v[48:51], v[16:19], 0
  ds_read_b128 v[36:39], v81 offset:4096
  ds_read_b128 v[40:43], v81 offset:8192
  v_mfma_f32_32x32x16_bf16 a[16:31], v[48:51], v[20:23], 0
  ds_read_b128 v[44:47], v81 offset:12288
  ds_read_b64_tr_b16 v[64:65], v84 offset:4096
  v_mfma_f32_32x32x16_bf16 a[32:47], v[48:51], v[24:27], 0
  ds_read_b64_tr_b16 v[66:67], v84 offset:5120
  ds_read_b64_tr_b16 v[68:69], v85 offset:4096
  ds_read_b64_tr_b16 v[70:71], v85 offset:5120
  ds_read_b64_tr_b16 v[72:73], v86 offset:4096
  v_mfma_f32_32x32x16_bf16 a[48:63], v[48:51], v[28:31], 0
  ds_read_b64_tr_b16 v[74:75], v86 offset:5120
  ds_read_b64_tr_b16 v[76:77], v87 offset:4096
  ds_read_b64_tr_b16 v[78:79], v87 offset:5120
  ds_read_b64_tr_b16 v[48:49], v84 offset:8192
  s_waitcnt lgkmcnt(15)
  v_mfma_f32_32x32x16_bf16 a[64:79], v[52:55], v[16:19], 0
  ds_read_b64_tr_b16 v[50:51], v84 offset:9216
  v_mfma_f32_32x32x16_bf16 a[80:95], v[52:55], v[20:23], 0
  v_mfma_f32_32x32x16_bf16 a[96:111], v[52:55], v[24:27], 0
  v_mfma_f32_32x32x16_bf16 a[112:127], v[52:55], v[28:31], 0
  ds_read_b64_tr_b16 v[52:53], v85 offset:8192
  ds_read_b64_tr_b16 v[54:55], v85 offset:9216
  v_mfma_f32_32x32x16_bf16 a[128:143], v[56:59], v[16:19], 0
  v_mfma_f32_32x32x16_bf16 a[144:159], v[56:59], v[20:23], 0
  v_mfma_f32_32x32x16_bf16 a[160:175], v[56:59], v[24:27], 0
  v_mfma_f32_32x32x16_bf16 a[176:191], v[56:59], v[28:31], 0
  ds_read_b64_tr_b16 v[56:57], v86 offset:8192
  ds_read_b64_tr_b16 v[58:59], v86 offset:9216
  s_waitcnt lgkmcnt(15)
  v_mfma_f32_32x32x16_bf16 a[192:207], v[60:63], v[16:19], 0
  ds_read_b128 v[16:19], v82 offset:0
  v_mfma_f32_32x32x16_bf16 a[208:223], v[60:63], v[20:23], 0
  ds_read_b128 v[20:23], v82 offset:4096
  v_mfma_f32_32x32x16_bf16 a[224:239], v[60:63], v[24:27], 0
  ds_read_b128 v[24:27], v82 offset:8192
  v_mfma_f32_32x32x16_bf16 a[240:255], v[60:63], v[28:31], 0
  ds_read_b128 v[28:31], v82 offset:12288
  ds_read_b64_tr_b16 v[60:61], v87 offset:8192
  ds_read_b64_tr_b16 v[62:63], v87 offset:9216
  s_waitcnt lgkmcnt(15)
  v_mfma_f32_32x32x16_bf16 a[0:15], v[64:67], v[32:35], a[0:15]
  v_mfma_f32_32x32x16_bf16 a[16:31], v[64:67], v[36:39], a[16:31]
  v_mfma_f32_32x32x16_bf16 a[32:47], v[64:67], v[40:43], a[32:47]
  v_mfma_f32_32x32x16_bf16 a[48:63], v[64:67], v[44:47], a[48:63]
  ds_read_b64_tr_b16 v[64:65], v84 offset:12288
  ds_read_b64_tr_b16 v[66:67], v84 offset:13312
  v_mfma_f32_32x32x16_bf16 a[64:79], v[68:71], v[32:35], a[64:79]
  v_mfma_f32_32x32x16_bf16 a[80:95], v[68:71], v[36:39], a[80:95]
  v_mfma_f32_32x32x16_bf16 a[96:111], v[68:71], v[40:43], a[96:111]
  v_mfma_f32_32x32x16_bf16 a[112:127], v[68:71], v[44:47], a[112:127]
  ds_read_b64_tr_b16 v[68:69], v85 offset:12288
  ds_read_b64_tr_b16 v[70:71], v85 offset:13312
  s_waitcnt lgkmcnt(15)
  v_mfma_f32_32x32x16_bf16 a[128:143], v[72:75], v[32:35], a[128:143]
  v_mfma_f32_32x32x16_bf16 a[144:159], v[72:75], v[36:39], a[144:159]
  v_mfma_f32_32x32x16_bf16 a[160:175], v[72:75], v[40:43], a[160:175]
  v_mfma_f32_32x32x16_bf16 a[176:191], v[72:75], v[44:47], a[176:191]
  ds_read_b64_tr_b16 v[72:73], v86 offset:12288
  ds_read_b64_tr_b16 v[74:75], v86 offset:13312
  v_mfma_f32_32x32x16_bf16 a[192:207], v[76:79], v[32:35], a[192:207]
  ds_read_b128 v[32:35], v83 offset:0
  v_mfma_f32_32x32x16_bf16 a[208:223], v[76:79], v[36:39], a[208:223]
  ds_read_b128 v[36:39], v83 offset:4096
  v_mfma_f32_32x32x16_bf16 a[224:239], v[76:79], v[40:43], a[224:239]
  ds_read_b128 v[40:43], v83 offset:8192
  v_mfma_f32_32x32x16_bf16 a[240:255], v[76:79], v[44:47], a[240:255]
  ds_read_b128 v[44:47], v83 offset:12288
  ds_read_b64_tr_b16 v[76:77], v87 offset:12288
  ds_read_b64_tr_b16 v[78:79], v87 offset:13312
  s_waitcnt lgkmcnt(15)
  v_mfma_f32_32x32x16_bf16 a[0:15], v[48:51], v[16:19], a[0:15]
  v_mfma_f32_32x32x16_bf16 a[16:31], v[48:51], v[20:23], a[16:31]
  v_mfma_f32_32x32x16_bf16 a[32:47], v[48:51], v[24:27], a[32:47]
  s_waitcnt lgkmcnt(14)
  v_mfma_f32_32x32x16_bf16 a[48:63], v[48:51], v[28:31], a[48:63]
  v_mfma_f32_32x32x16_bf16 a[64:79], v[52:55], v[16:19], a[64:79]
  v_mfma_f32_32x32x16_bf16 a[80:95], v[52:55], v[20:23], a[80:95]
  v_mfma_f32_32x32x16_bf16 a[96:111], v[52:55], v[24:27], a[96:111]
  v_mfma_f32_32x32x16_bf16 a[112:127], v[52:55], v[28:31], a[112:127]
  v_mfma_f32_32x32x16_bf16 a[128:143], v[56:59], v[16:19], a[128:143]
  v_mfma_f32_32x32x16_bf16 a[144:159], v[56:59], v[20:23], a[144:159]
  v_mfma_f32_32x32x16_bf16 a[160:175], v[56:59], v[24:27], a[160:175]
  v_mfma_f32_32x32x16_bf16 a[176:191], v[56:59], v[28:31], a[176:191]
  s_waitcnt lgkmcnt(12)
  v_mfma_f32_32x32x16_bf16 a[192:207], v[60:63], v[16:19], a[192:207]
  v_mfma_f32_32x32x16_bf16 a[208:223], v[60:63], v[20:23], a[208:223]
  v_mfma_f32_32x32x16_bf16 a[224:239], v[60:63], v[24:27], a[224:239]
  v_mfma_f32_32x32x16_bf16 a[240:255], v[60:63], v[28:31], a[240:255]
  s_mov_b32 s26, 7
L_kanw:
  s_waitcnt vmcnt(0) lgkmcnt(0)
  s_barrier
  v_xor_b32 v80, 0x10000, v80
  v_xor_b32 v84, 0x10000, v84
  v_xor_b32 v85, 0x10000, v85
  v_xor_b32 v86, 0x10000, v86
  v_xor_b32 v87, 0x10000, v87
  ds_read_b128 v[16:19], v80 offset:0
  v_mfma_f32_32x32x16_bf16 a[0:15], v[64:67], v[32:35], a[0:15]
  s_add_u32 m0, s24, s32
  v_xor_b32 v81, 0x10000, v81
  ds_read_b128 v[20:23], v80 offset:4096
  v_xor_b32 v82, 0x10000, v82
  s_mov_b32 s27, s20
  buffer_load_dwordx4 v88, s[8:11], s27 offen lds
  ds_read_b128 v[24:27], v80 offset:8192
  v_mfma_f32_32x32x16_bf16 a[16:31], v[64:67], v[36:39], a[16:31]
  s_add_u32 m0, m0, 1024
  s_add_u32 s27, s27, 9216
  ds_read_b128 v[28:31], v80 offset:12288
  buffer_load_dwordx4 v89, s[8:11], s27 offen lds
  ds_read_b64_tr_b16 v[48:49], v84 offset:0
  v_mfma_f32_32x32x16_bf16 a[32:47], v[64:67], v[40:43], a[32:47]
  ds_read_b64_tr_b16 v[50:51], v84 offset:1024
  s_add_u32 m0, m0, 1024
  ds_read_b64_tr_b16 v[52:53], v85 offset:0
  s_add_u32 s27, s27, 9216
  ds_read_b64_tr_b16 v[54:55], v85 offset:1024
  v_xor_b32 v83, 0x10000, v83
  ds_read_b64_tr_b16 v[56:57], v86 offset:0
  v_mfma_f32_32x32x16_bf16 a[48:63], v[64:67], v[44:47], a[48:63]
  ds_read_b64_tr_b16 v[58:59], v86 offset:1024
  buffer_load_dwordx4 v88, s[8:11], s27 offen lds
  ds_read_b64_tr_b16 v[60:61], v87 offset:0
  s_add_u32 m0, m0, 1024
  ds_read_b64_tr_b16 v[62:63], v87 offset:1024
  v_mfma_f32_32x32x16_bf16 a[64:79], v[68:71], v[32:35], a[64:79]
  ds_read_b64_tr_b16 v[64:65], v84 offset:4096
  s_add_u32 s27, s27, 9216
  ds_read_b64_tr_b16 v[66:67], v84 offset:5120
  v_mfma_f32_32x32x16_bf16 a[80:95], v[68:71], v[36:39], a[80:95]
  buffer_load_dwordx4 v89, s[8:11], s27 offen lds
  s_add_u32 m0, m0, 1024
  v_mfma_f32_32x32x16_bf16 a[96:111], v[68:71], v[40:43], a[96:111]
  s_add_u32 s27, s27, 9216
  v_mfma_f32_32x32x16_bf16 a[112:127], v[68:71], v[44:47], a[112:127]
  ds_read_b64_tr_b16 v[68:69], v85 offset:4096
  ds_read_b64_tr_b16 v[70:71], v85 offset:5120
  buffer_load_dwordx4 v88, s[8:11], s27 offen lds
  v_mfma_f32_32x32x16_bf16 a[128:143], v[72:75], v[32:35], a[128:143]
  s_add_u32 m0, m0, 1024
  s_add_u32 s27, s27, 9216
  v_mfma_f32_32x32x16_bf16 a[144:159], v[72:75], v[36:39], a[144:159]
  buffer_load_dwordx4 v89, s[8:11], s27 offen lds
  v_mfma_f32_32x32x16_bf16 a[160:175], v[72:75], v[40:43], a[160:175]
  s_add_u32 m0, m0, 1024
  s_add_u32 s27, s27, 9216
  v_mfma_f32_32x32x16_bf16 a[176:191], v[72:75], v[44:47], a[176:191]
  ds_read_b64_tr_b16 v[72:73], v86 offset:4096
  ds_read_b64_tr_b16 v[74:75], v86 offset:5120
  buffer_load_dwordx4 v88, s[8:11], s27 offen lds
  v_mfma_f32_32x32x16_bf16 a[192:207], v[76:79], v[32:35], a[192:207]
  ds_read_b128 v[32:35], v81 offset:0
  s_add_u32 m0, m0, 1024
  s_add_u32 s27, s27, 9216
  v_mfma_f32_32x32x16_bf16 a[208:223], v[76:79], v[36:39], a[208:223]
  ds_read_b128 v[36:39], v81 offset:4096
  buffer_load_dwordx4 v89, s[8:11], s27 offen lds
  v_mfma_f32_32x32x16_bf16 a[224:239], v[76:79], v[40:43], a[224:239]
  ds_read_b128 v[40:43], v81 offset:8192
  s_add_u32 m0, s25, s32
  s_mov_b32 s27, s21
  v_mfma_f32_32x32x16_bf16 a[240:255], v[76:79], v[44:47], a[240:255]
  ds_read_b128 v[44:47], v81 offset:12288
  ds_read_b64_tr_b16 v[76:77], v87 offset:4096
  buffer_load_dwordx4 v90, s[12:15], s27 offen lds
  ds_read_b64_tr_b16 v[78:79], v87 offset:5120
  s_waitcnt lgkmcnt(15)
  v_mfma_f32_32x32x16_bf16 a[0:15], v[48:51], v[16:19], a[0:15]
  s_add_u32 m0, m0, 1024
  s_add_u32 s27, s27, s22
  v_mfma_f32_32x32x16_bf16 a[16:31], v[48:51], v[20:23], a[16:31]
  buffer_load_dwordx4 v90, s[12:15], s27 offen lds
  v_mfma_f32_32x32x16_bf16 a[32:47], v[48:51], v[24:27], a[32:47]
  s_add_u32 m0, m0, 1024
  s_add_u32 s27, s27, s22
  v_mfma_f32_32x32x16_bf16 a[48:63], v[48:51], v[28:31], a[48:63]
  ds_read_b64_tr_b16 v[48:49], v84 offset:8192
  ds_read_b64_tr_b16 v[50:51], v84 offset:9216
  buffer_load_dwordx4 v90, s[12:15], s27 offen lds
  v_mfma_f32_32x32x16_bf16 a[64:79], v[52:55], v[16:19], a[64:79]
  s_add_u32 m0, m0, 1024
  s_add_u32 s27, s27, s22
  v_mfma_f32_32x32x16_bf16 a[80:95], v[52:55], v[20:23], a[80:95]
  buffer_load_dwordx4 v90, s[12:15], s27 offen lds
  v_mfma_f32_32x32x16_bf16 a[96:111], v[52:55], v[24:27], a[96:111]
  s_add_u32 m0, m0, 1024
  s_add_u32 s27, s27, s22
  v_mfma_f32_32x32x16_bf16 a[112:127], v[52:55], v[28:31], a[112:127]
  ds_read_b64_tr_b16 v[52:53], v85 offset:8192
  ds_read_b64_tr_b16 v[54:55], v85 offset:9216
  buffer_load_dwordx4 v90, s[12:15], s27 offen lds
  s_waitcnt lgkmcnt(15)
  v_mfma_f32_32x32x16_bf16 a[128:143], v[56:59], v[16:19], a[128:143]
  s_add_u32 m0, m0, 1024
  s_add_u32 s27, s27, s22
  v_mfma_f32_32x32x16_bf16 a[144:159], v[56:59], v[20:23], a[144:159]
  buffer_load_dwordx4 v90, s[12:15], s27 offen lds
  v_mfma_f32_32x32x16_bf16 a[160:175], v[56:59], v[24:27], a[160:175]
  s_add_u32 m0, m0, 1024
  s_add_u32 s27, s27, s22
  v_mfma_f32_32x32x16_bf16 a[176:191], v[56:59], v[28:31], a[176:191]
  ds_read_b64_tr_b16 v[56:57], v86 offset:8192
  ds_read_b64_tr_b16 v[58:59], v86 offset:9216
  buffer_load_dwordx4 v90, s[12:15], s27 offen lds
  v_mfma_f32_32x32x16_bf16 a[192:207], v[60:63], v[16:19], a[192:207]
  ds_read_b128 v[16:19], v82 offset:0
  s_add_u32 m0, m0, 1024
  s_add_u32 s27, s27, s22
  s_add_u32 s20, s20, 128
  s_add_u32 s21, s21, s23
  s_xor_b32 s32, s32, 0x10000
  v_mfma_f32_32x32x16_bf16 a[208:223], v[60:63], v[20:23], a[208:223]
  ds_read_b128 v[20:23], v82 offset:4096
  buffer_load_dwordx4 v90, s[12:15], s27 offen lds
  v_mfma_f32_32x32x16_bf16 a[224:239], v[60:63], v[24:27], a[224:239]
  ds_read_b128 v[24:27], v82 offset:8192
  v_mfma_f32_32x32x16_bf16 a[240:255], v[60:63], v[28:31], a[240:255]
  ds_read_b128 v[28:31], v82 offset:12288
  ds_read_b64_tr_b16 v[60:61], v87 offset:8192
  ds_read_b64_tr_b16 v[62:63], v87 offset:9216
  s_waitcnt lgkmcnt(15)
  v_mfma_f32_32x32x16_bf16 a[0:15], v[64:67], v[32:35], a[0:15]
  v_mfma_f32_32x32x16_bf16 a[16:31], v[64:67], v[36:39], a[16:31]
  v_mfma_f32_32x32x16_bf16 a[32:47], v[64:67], v[40:43], a[32:47]
  s_waitcnt lgkmcnt(14)
  v_mfma_f32_32x32x16_bf16 a[48:63], v[64:67], v[44:47], a[48:63]
  ds_read_b64_tr_b16 v[64:65], v84 offset:12288
  ds_read_b64_tr_b16 v[66:67], v84 offset:13312
  v_mfma_f32_32x32x16_bf16 a[64:79], v[68:71], v[32:35], a[64:79]
  v_mfma_f32_32x32x16_bf16 a[80:95], v[68:71], v[36:39], a[80:95]
  v_mfma_f32_32x32x16_bf16 a[96:111], v[68:71], v[40:43], a[96:111]
  v_mfma_f32_32x32x16_bf16 a[112:127], v[68:71], v[44:47], a[112:127]
  ds_read_b64_tr_b16 v[68:69], v85 offset:12288
  ds_read_b64_tr_b16 v[70:71], v85 offset:13312
  v_mfma_f32_32x32x16_bf16 a[128:143], v[72:75], v[32:35], a[128:143]
  v_mfma_f32_32x32x16_bf16 a[144:159], v[72:75], v[36:39], a[144:159]
  v_mfma_f32_32x32x16_bf16 a[160:175], v[72:75], v[40:43], a[160:175]
  v_mfma_f32_32x32x16_bf16 a[176:191], v[72:75], v[44:47], a[176:191]
  ds_read_b64_tr_b16 v[72:73], v86 offset:12288
  ds_read_b64_tr_b16 v[74:75], v86 offset:13312
  s_waitcnt lgkmcnt(15)
  v_mfma_f32_32x32x16_bf16 a[192:207], v[76:79], v[32:35], a[192:207]
  ds_read_b128 v[32:35], v83 offset:0
  v_mfma_f32_32x32x16_bf16 a[208:223], v[76:79], v[36:39], a[208:223]
  ds_read_b128 v[36:39], v83 offset:4096
  v_mfma_f32_32x32x16_bf16 a[224:239], v[76:79], v[40:43], a[224:239]
  ds_read_b128 v[40:43], v83 offset:8192
  v_mfma_f32_32x32x16_bf16 a[240:255], v[76:79], v[44:47], a[240:255]
  ds_read_b128 v[44:47], v83 offset:12288
  ds_read_b64_tr_b16 v[76:77], v87 offset:12288
  ds_read_b64_tr_b16 v[78:79], v87 offset:13312
  s_waitcnt lgkmcnt(15)
  v_mfma_f32_32x32x16_bf16 a[0:15], v[48:51], v[16:19], a[0:15]
  v_mfma_f32_32x32x16_bf16 a[16:31], v[48:51], v[20:23], a[16:31]
  v_mfma_f32_32x32x16_bf16 a[32:47], v[48:51], v[24:27], a[32:47]
  s_waitcnt lgkmcnt(14)
  v_mfma_f32_32x32x16_bf16 a[48:63], v[48:51], v[28:31], a[48:63]
  v_mfma_f32_32x32x16_bf16 a[64:79], v[52:55], v[16:19], a[64:79]
  v_mfma_f32_32x32x16_bf16 a[80:95], v[52:55], v[20:23], a[80:95]
  v_mfma_f32_32x32x16_bf16 a[96:111], v[52:55], v[24:27], a[96:111]
  v_mfma_f32_32x32x16_bf16 a[112:127], v[52:55], v[28:31], a[112:127]
  v_mfma_f32_32x32x16_bf16 a[128:143], v[56:59], v[16:19], a[128:143]
  v_mfma_f32_32x32x16_bf16 a[144:159], v[56:59], v[20:23], a[144:159]
  v_mfma_f32_32x32x16_bf16 a[160:175], v[56:59], v[24:27], a[160:175]
  v_mfma_f32_32x32x16_bf16 a[176:191], v[56:59], v[28:31], a[176:191]
  s_waitcnt lgkmcnt(12)
  v_mfma_f32_32x32x16_bf16 a[192:207], v[60:63], v[16:19], a[192:207]
  v_mfma_f32_32x32x16_bf16 a[208:223], v[60:63], v[20:23], a[208:223]
  v_mfma_f32_32x32x16_bf16 a[224:239], v[60:63], v[24:27], a[224:239]
  v_mfma_f32_32x32x16_bf16 a[240:255], v[60:63], v[28:31], a[240:255]
  s_sub_u32 s26, s26, 1
  s_cmp_lg_u32 s26, 0
  s_cbranch_scc1 L_kanw
  s_waitcnt vmcnt(0) lgkmcnt(0)
  s_barrier
  v_xor_b32 v80, 0x10000, v80
  v_xor_b32 v84, 0x10000, v84
  v_xor_b32 v85, 0x10000, v85
  v_xor_b32 v86, 0x10000, v86
  v_xor_b32 v87, 0x10000, v87
  ds_read_b128 v[16:19], v80 offset:0
  v_mfma_f32_32x32x16_bf16 a[0:15], v[64:67], v[32:35], a[0:15]
  v_xor_b32 v81, 0x10000, v81
  ds_read_b128 v[20:23], v80 offset:4096
  v_xor_b32 v82, 0x10000, v82
  v_xor_b32 v83, 0x10000, v83
  ds_read_b128 v[24:27], v80 offset:8192
  v_mfma_f32_32x32x16_bf16 a[16:31], v[64:67], v[36:39], a[16:31]
  ds_read_b128 v[28:31], v80 offset:12288
  ds_read_b64_tr_b16 v[48:49], v84 offset:0
  v_mfma_f32_32x32x16_bf16 a[32:47], v[64:67], v[40:43], a[32:47]
  ds_read_b64_tr_b16 v[50:51], v84 offset:1024
  ds_read_b64_tr_b16 v[52:53], v85 offset:0
  ds_read_b64_tr_b16 v[54:55], v85 offset:1024
  ds_read_b64_tr_b16 v[56:57], v86 offset:0
  v_mfma_f32_32x32x16_bf16 a[48:63], v[64:67], v[44:47], a[48:63]
  ds_read_b64_tr_b16 v[58:59], v86 offset:1024
  ds_read_b64_tr_b16 v[60:61], v87 offset:0
  ds_read_b64_tr_b16 v[62:63], v87 offset:1024
  ds_read_b64_tr_b16 v[64:65], v84 offset:4096
  v_mfma_f32_32x32x16_bf16 a[64:79], v[68:71], v[32:35], a[64:79]
  ds_read_b64_tr_b16 v[66:67], v84 offset:5120
  v_mfma_f32_32x32x16_bf16 a[80:95], v[68:71], v[36:39], a[80:95]
  v_mfma_f32_32x32x16_bf16 a[96:111], v[68:71], v[40:43], a[96:111]
  v_mfma_f32_32x32x16_bf16 a[112:127], v[68:71], v[44:47], a[112:127]
  ds_read_b64_tr_b16 v[68:69], v85 offset:4096
  ds_read_b64_tr_b16 v[70:71], v85 offset:5120
  v_mfma_f32_32x32x16_bf16 a[128:143], v[72:75], v[32:35], a[128:143]
  v_mfma_f32_32x32x16_bf16 a[144:159], v[72:75], v[36:39], a[144:159]
  v_mfma_f32_32x32x16_bf16 a[160:175], v[72:75], v[40:43], a[160:175]
  v_mfma_f32_32x32x16_bf16 a[176:191], v[72:75], v[44:47], a[176:191]
  ds_read_b64_tr_b16 v[72:73], v86 offset:4096
  ds_read_b64_tr_b16 v[74:75], v86 offset:5120
  v_mfma_f32_32x32x16_bf16 a[192:207], v[76:79], v[32:35], a[192:207]
  ds_read_b128 v[32:35], v81 offset:0
  v_mfma_f32_32x32x16_bf16 a[208:223], v[76:79], v[36:39], a[208:223]
  ds_read_b128 v[36:39], v81 offset:4096
  v_mfma_f32_32x32x16_bf16 a[224:239], v[76:79], v[40:43], a[224:239]
  ds_read_b128 v[40:43], v81 offset:8192
  v_mfma_f32_32x32x16_bf16 a[240:255], v[76:79], v[44:47], a[240:255]
  ds_read_b128 v[44:47], v81 offset:12288
  ds_read_b64_tr_b16 v[76:77], v87 offset:4096
  ds_read_b64_tr_b16 v[78:79], v87 offset:5120
  s_waitcnt lgkmcnt(15)
  v_mfma_f32_32x32x16_bf16 a[0:15], v[48:51], v[16:19], a[0:15]
  v_mfma_f32_32x32x16_bf16 a[16:31], v[48:51], v[20:23], a[16:31]
  v_mfma_f32_32x32x16_bf16 a[32:47], v[48:51], v[24:27], a[32:47]
  v_mfma_f32_32x32x16_bf16 a[48:63], v[48:51], v[28:31], a[48:63]
  ds_read_b64_tr_b16 v[48:49], v84 offset:8192
  ds_read_b64_tr_b16 v[50:51], v84 offset:9216
  v_mfma_f32_32x32x16_bf16 a[64:79], v[52:55], v[16:19], a[64:79]
  v_mfma_f32_32x32x16_bf16 a[80:95], v[52:55], v[20:23], a[80:95]
  v_mfma_f32_32x32x16_bf16 a[96:111], v[52:55], v[24:27], a[96:111]
  v_mfma_f32_32x32x16_bf16 a[112:127], v[52:55], v[28:31], a[112:127]
  ds_read_b64_tr_b16 v[52:53], v85 offset:8192
  ds_read_b64_tr_b16 v[54:55], v85 offset:9216
  s_waitcnt lgkmcnt(15)
  v_mfma_f32_32x32x16_bf16 a[128:143], v[56:59], v[16:19], a[128:143]
  v_mfma_f32_32x32x16_bf16 a[144:159], v[56:59], v[20:23], a[144:159]
  v_mfma_f32_32x32x16_bf16 a[160:175], v[56:59], v[24:27], a[160:175]
  v_mfma_f32_32x32x16_bf16 a[176:191], v[56:59], v[28:31], a[176:191]
  ds_read_b64_tr_b16 v[56:57], v86 offset:8192
  ds_read_b64_tr_b16 v[58:59], v86 offset:9216
  v_mfma_f32_32x32x16_bf16 a[192:207], v[60:63], v[16:19], a[192:207]
  ds_read_b128 v[16:19], v82 offset:0
  v_mfma_f32_32x32x16_bf16 a[208:223], v[60:63], v[20:23], a[208:223]
  ds_read_b128 v[20:23], v82 offset:4096
  v_mfma_f32_32x32x16_bf16 a[224:239], v[60:63], v[24:27], a[224:239]
  ds_read_b128 v[24:27], v82 offset:8192
  v_mfma_f32_32x32x16_bf16 a[240:255], v[60:63], v[28:31], a[240:255]
  ds_read_b128 v[28:31], v82 offset:12288
  ds_read_b64_tr_b16 v[60:61], v87 offset:8192
  ds_read_b64_tr_b16 v[62:63], v87 offset:9216
  s_waitcnt lgkmcnt(15)
  v_mfma_f32_32x32x16_bf16 a[0:15], v[64:67], v[32:35], a[0:15]
  v_mfma_f32_32x32x16_bf16 a[16:31], v[64:67], v[36:39], a[16:31]
  v_mfma_f32_32x32x16_bf16 a[32:47], v[64:67], v[40:43], a[32:47]
  s_waitcnt lgkmcnt(14)
  v_mfma_f32_32x32x16_bf16 a[48:63], v[64:67], v[44:47], a[48:63]
  ds_read_b64_tr_b16 v[64:65], v84 offset:12288
  ds_read_b64_tr_b16 v[66:67], v84 offset:13312
  v_mfma_f32_32x32x16_bf16 a[64:79], v[68:71], v[32:35], a[64:79]
  v_mfma_f32_32x32x16_bf16 a[80:95], v[68:71], v[36:39], a[80:95]
  v_mfma_f32_32x32x16_bf16 a[96:111], v[68:71], v[40:43], a[96:111]
  v_mfma_f32_32x32x16_bf16 a[112:127], v[68:71], v[44:47], a[112:127]
  ds_read_b64_tr_b16 v[68:69], v85 offset:12288
  ds_read_b64_tr_b16 v[70:71], v85 offset:13312
  v_mfma_f32_32x32x16_bf16 a[128:143], v[72:75], v[32:35], a[128:143]
  v_mfma_f32_32x32x16_bf16 a[144:159], v[72:75], v[36:39], a[144:159]
  v_mfma_f32_32x32x16_bf16 a[160:175], v[72:75], v[40:43], a[160:175]
  v_mfma_f32_32x32x16_bf16 a[176:191], v[72:75], v[44:47], a[176:191]
  ds_read_b64_tr_b16 v[72:73], v86 offset:12288
  ds_read_b64_tr_b16 v[74:75], v86 offset:13312
  s_waitcnt lgkmcnt(15)
  v_mfma_f32_32x32x16_bf16 a[192:207], v[76:79], v[32:35], a[192:207]
  ds_read_b128 v[32:35], v83 offset:0
  v_mfma_f32_32x32x16_bf16 a[208:223], v[76:79], v[36:39], a[208:223]
  ds_read_b128 v[36:39], v83 offset:4096
  v_mfma_f32_32x32x16_bf16 a[224:239], v[76:79], v[40:43], a[224:239]
  ds_read_b128 v[40:43], v83 offset:8192
  v_mfma_f32_32x32x16_bf16 a[240:255], v[76:79], v[44:47], a[240:255]
  ds_read_b128 v[44:47], v83 offset:12288
  ds_read_b64_tr_b16 v[76:77], v87 offset:12288
  ds_read_b64_tr_b16 v[78:79], v87 offset:13312
  s_waitcnt lgkmcnt(15)
  v_mfma_f32_32x32x16_bf16 a[0:15], v[48:51], v[16:19], a[0:15]
  v_mfma_f32_32x32x16_bf16 a[16:31], v[48:51], v[20:23], a[16:31]
  v_mfma_f32_32x32x16_bf16 a[32:47], v[48:51], v[24:27], a[32:47]
  s_waitcnt lgkmcnt(14)
  v_mfma_f32_32x32x16_bf16 a[48:63], v[48:51], v[28:31], a[48:63]
  v_mfma_f32_32x32x16_bf16 a[64:79], v[52:55], v[16:19], a[64:79]
  v_mfma_f32_32x32x16_bf16 a[80:95], v[52:55], v[20:23], a[80:95]
  v_mfma_f32_32x32x16_bf16 a[96:111], v[52:55], v[24:27], a[96:111]
  v_mfma_f32_32x32x16_bf16 a[112:127], v[52:55], v[28:31], a[112:127]
  v_mfma_f32_32x32x16_bf16 a[128:143], v[56:59], v[16:19], a[128:143]
  v_mfma_f32_32x32x16_bf16 a[144:159], v[56:59], v[20:23], a[144:159]
  v_mfma_f32_32x32x16_bf16 a[160:175], v[56:59], v[24:27], a[160:175]
  v_mfma_f32_32x32x16_bf16 a[176:191], v[56:59], v[28:31], a[176:191]
  s_waitcnt lgkmcnt(12)
  v_mfma_f32_32x32x16_bf16 a[192:207], v[60:63], v[16:19], a[192:207]
  v_mfma_f32_32x32x16_bf16 a[208:223], v[60:63], v[20:23], a[208:223]
  v_mfma_f32_32x32x16_bf16 a[224:239], v[60:63], v[24:27], a[224:239]
  v_mfma_f32_32x32x16_bf16 a[240:255], v[60:63], v[28:31], a[240:255]
  s_waitcnt lgkmcnt(5)
  v_mfma_f32_32x32x16_bf16 a[0:15], v[64:67], v[32:35], a[0:15]
  s_waitcnt lgkmcnt(4)
  v_mfma_f32_32x32x16_bf16 a[16:31], v[64:67], v[36:39], a[16:31]
  s_waitcnt lgkmcnt(3)
  v_mfma_f32_32x32x16_bf16 a[32:47], v[64:67], v[40:43], a[32:47]
  s_waitcnt lgkmcnt(2)
  v_mfma_f32_32x32x16_bf16 a[48:63], v[64:67], v[44:47], a[48:63]
  v_mfma_f32_32x32x16_bf16 a[64:79], v[68:71], v[32:35], a[64:79]
  v_mfma_f32_32x32x16_bf16 a[80:95], v[68:71], v[36:39], a[80:95]
  v_mfma_f32_32x32x16_bf16 a[96:111], v[68:71], v[40:43], a[96:111]
  v_mfma_f32_32x32x16_bf16 a[112:127], v[68:71], v[44:47], a[112:127]
  v_mfma_f32_32x32x16_bf16 a[128:143], v[72:75], v[32:35], a[128:143]
  v_mfma_f32_32x32x16_bf16 a[144:159], v[72:75], v[36:39], a[144:159]
  v_mfma_f32_32x32x16_bf16 a[160:175], v[72:75], v[40:43], a[160:175]
  v_mfma_f32_32x32x16_bf16 a[176:191], v[72:75], v[44:47], a[176:191]
  s_waitcnt lgkmcnt(0)
  v_mfma_f32_32x32x16_bf16 a[192:207], v[76:79], v[32:35], a[192:207]
  v_mfma_f32_32x32x16_bf16 a[208:223], v[76:79], v[36:39], a[208:223]
  v_mfma_f32_32x32x16_bf16 a[224:239], v[76:79], v[40:43], a[224:239]
  v_mfma_f32_32x32x16_bf16 a[240:255], v[76:79], v[44:47], a[240:255]
  s_cmp_eq_u32 s33, 3
  s_cbranch_scc1 L_j_ehw
  s_lshr_b32 s27, s31, 1
  s_lshl_b32 s27, s27, 2
  s_lshl_b32 s28, s34, 3
  s_add_u32 s27, s27, s28
  s_mul_i32 s29, s27, 262144
  s_and_b32 s27, s31, 1
  s_lshl_b32 s28, s35, 1
  s_add_u32 s27, s27, s28
  s_lshl_b32 s27, s27, 13
  s_add_u32 s29, s29, s27
  s_cmp_eq_u32 s33, 0
  s_mov_b32 s27, 51380224
  s_cselect_b32 s27, 1048576, s27
  s_add_u32 s29, s29, s27
  v_and_b32 v1, 63, v0
  v_lshrrev_b32 v2, 5, v1
  v_lshlrev_b32 v2, 8, v2
  v_and_b32 v3, 15, v1
  v_lshlrev_b32 v3, 4, v3
  v_bfe_u32 v4, v1, 4, 1
  v_mul_u32_u24 v4, 4096, v4
  v_add3_u32 v91, v2, v3, v4
  v_accvgpr_read_b32 v96, a0
  v_accvgpr_read_b32 v97, a1
  v_accvgpr_read_b32 v98, a2
  v_accvgpr_read_b32 v99, a3
  v_accvgpr_read_b32 v104, a4
  v_accvgpr_read_b32 v105, a5
  v_accvgpr_read_b32 v100, a8
  v_accvgpr_read_b32 v101, a9
  v_accvgpr_read_b32 v102, a10
  v_accvgpr_read_b32 v103, a11
  v_accvgpr_read_b32 v106, a6
  v_accvgpr_read_b32 v107, a7
  v_accvgpr_read_b32 v112, a64
  v_accvgpr_read_b32 v113, a65
  v_accvgpr_read_b32 v108, a12
  v_accvgpr_read_b32 v109, a13
  v_accvgpr_read_b32 v110, a14
  v_accvgpr_read_b32 v111, a15
  v_accvgpr_read_b32 v114, a66
  v_accvgpr_read_b32 v115, a67
  v_accvgpr_read_b32 v120, a68
  v_accvgpr_read_b32 v121, a69
  v_accvgpr_read_b32 v116, a72
  v_accvgpr_read_b32 v117, a73
  v_accvgpr_read_b32 v118, a74
  v_accvgpr_read_b32 v119, a75
  v_accvgpr_read_b32 v122, a70
  v_accvgpr_read_b32 v123, a71
  v_cvt_pk_bf16_f32 v96, v96, v97
  v_accvgpr_read_b32 v124, a76
  v_accvgpr_read_b32 v125, a77
  v_accvgpr_read_b32 v126, a78
  v_accvgpr_read_b32 v127, a79
  v_cvt_pk_bf16_f32 v97, v98, v99
  v_cvt_pk_bf16_f32 v104, v104, v105
  v_cvt_pk_bf16_f32 v98, v100, v101
  v_cvt_pk_bf16_f32 v99, v102, v103
  v_cvt_pk_bf16_f32 v105, v106, v107
  v_cvt_pk_bf16_f32 v112, v112, v113
  v_cvt_pk_bf16_f32 v106, v108, v109
  v_cvt_pk_bf16_f32 v107, v110, v111
  v_cvt_pk_bf16_f32 v113, v114, v115
  v_cvt_pk_bf16_f32 v120, v120, v121
  v_cvt_pk_bf16_f32 v114, v116, v117
  v_cvt_pk_bf16_f32 v115, v118, v119
  v_cvt_pk_bf16_f32 v121, v122, v123
  s_add_u32 s27, s29, 0
  v_cvt_pk_bf16_f32 v122, v124, v125
  v_cvt_pk_bf16_f32 v123, v126, v127
  buffer_store_dwordx4 v[96:99], v91, s[16:19], s27 offen offset:0 sc1
  buffer_store_dwordx4 v[104:107], v91, s[16:19], s27 offen offset:512 sc1
  s_nop 0
  v_accvgpr_read_b32 v96, a128
  v_accvgpr_read_b32 v97, a129
  buffer_store_dwordx4 v[112:115], v91, s[16:19], s27 offen offset:1024 sc1
  v_accvgpr_read_b32 v98, a130
  v_accvgpr_read_b32 v99, a131
  v_accvgpr_read_b32 v104, a132
  v_accvgpr_read_b32 v105, a133
  buffer_store_dwordx4 v[120:123], v91, s[16:19], s27 offen offset:1536 sc1
  v_accvgpr_read_b32 v100, a136
  v_accvgpr_read_b32 v101, a137
  v_accvgpr_read_b32 v102, a138
  v_accvgpr_read_b32 v103, a139
  v_accvgpr_read_b32 v106, a134
  v_accvgpr_read_b32 v107, a135
  v_accvgpr_read_b32 v112, a192
  v_accvgpr_read_b32 v113, a193
  v_accvgpr_read_b32 v108, a140
  v_accvgpr_read_b32 v109, a141
  v_accvgpr_read_b32 v110, a142
  v_accvgpr_read_b32 v111, a143
  v_accvgpr_read_b32 v114, a194
  v_accvgpr_read_b32 v115, a195
  v_accvgpr_read_b32 v120, a196
  v_accvgpr_read_b32 v121, a197
  v_accvgpr_read_b32 v116, a200
  v_accvgpr_read_b32 v117, a201
  v_accvgpr_read_b32 v118, a202
  v_accvgpr_read_b32 v119, a203
  v_accvgpr_read_b32 v122, a198
  v_accvgpr_read_b32 v123, a199
  v_cvt_pk_bf16_f32 v96, v96, v97
  v_accvgpr_read_b32 v124, a204
  v_accvgpr_read_b32 v125, a205
  v_accvgpr_read_b32 v126, a206
  v_accvgpr_read_b32 v127, a207
  v_cvt_pk_bf16_f32 v97, v98, v99
  v_cvt_pk_bf16_f32 v104, v104, v105
  v_cvt_pk_bf16_f32 v98, v100, v101
  v_cvt_pk_bf16_f32 v99, v102, v103
  v_cvt_pk_bf16_f32 v105, v106, v107
  v_cvt_pk_bf16_f32 v112, v112, v113
  v_cvt_pk_bf16_f32 v106, v108, v109
  v_cvt_pk_bf16_f32 v107, v110, v111
  v_cvt_pk_bf16_f32 v113, v114, v115
  v_cvt_pk_bf16_f32 v120, v120, v121
  v_cvt_pk_bf16_f32 v114, v116, v117
  v_cvt_pk_bf16_f32 v115, v118, v119
  v_cvt_pk_bf16_f32 v121, v122, v123
  v_cvt_pk_bf16_f32 v122, v124, v125
  v_cvt_pk_bf16_f32 v123, v126, v127
  buffer_store_dwordx4 v[96:99], v91, s[16:19], s27 offen offset:2048 sc1
  buffer_store_dwordx4 v[104:107], v91, s[16:19], s27 offen offset:2560 sc1
  buffer_store_dwordx4 v[112:115], v91, s[16:19], s27 offen offset:3072 sc1
  buffer_store_dwordx4 v[120:123], v91, s[16:19], s27 offen offset:3584 sc1
  v_accvgpr_read_b32 v96, a16
  v_accvgpr_read_b32 v97, a17
  v_accvgpr_read_b32 v98, a18
  v_accvgpr_read_b32 v99, a19
  v_accvgpr_read_b32 v104, a20
  v_accvgpr_read_b32 v105, a21
  v_accvgpr_read_b32 v100, a24
  v_accvgpr_read_b32 v101, a25
  v_accvgpr_read_b32 v102, a26
  v_accvgpr_read_b32 v103, a27
  v_accvgpr_read_b32 v106, a22
  v_accvgpr_read_b32 v107, a23
  v_accvgpr_read_b32 v112, a80
  v_accvgpr_read_b32 v113, a81
  v_accvgpr_read_b32 v108, a28
  v_accvgpr_read_b32 v109, a29
  v_accvgpr_read_b32 v110, a30
  v_accvgpr_read_b32 v111, a31
  v_accvgpr_read_b32 v114, a82
  v_accvgpr_read_b32 v115, a83
  v_accvgpr_read_b32 v120, a84
  v_accvgpr_read_b32 v121, a85
  v_accvgpr_read_b32 v116, a88
  v_accvgpr_read_b32 v117, a89
  v_accvgpr_read_b32 v118, a90
  v_accvgpr_read_b32 v119, a91
  v_accvgpr_read_b32 v122, a86
  v_accvgpr_read_b32 v123, a87
  v_cvt_pk_bf16_f32 v96, v96, v97
  v_accvgpr_read_b32 v124, a92
  v_accvgpr_read_b32 v125, a93
  v_accvgpr_read_b32 v126, a94
  v_accvgpr_read_b32 v127, a95
  v_cvt_pk_bf16_f32 v97, v98, v99
  v_cvt_pk_bf16_f32 v104, v104, v105
  v_cvt_pk_bf16_f32 v98, v100, v101
  v_cvt_pk_bf16_f32 v99, v102, v103
  v_cvt_pk_bf16_f32 v105, v106, v107
  v_cvt_pk_bf16_f32 v112, v112, v113
  v_cvt_pk_bf16_f32 v106, v108, v109
  v_cvt_pk_bf16_f32 v107, v110, v111
  v_cvt_pk_bf16_f32 v113, v114, v115
  v_cvt_pk_bf16_f32 v120, v120, v121
  v_cvt_pk_bf16_f32 v114, v116, v117
  v_cvt_pk_bf16_f32 v115, v118, v119
  v_cvt_pk_bf16_f32 v121, v122, v123
  s_add_u32 s27, s29, 262144
  v_cvt_pk_bf16_f32 v122, v124, v125
  v_cvt_pk_bf16_f32 v123, v126, v127
  buffer_store_dwordx4 v[96:99], v91, s[16:19], s27 offen offset:0 sc1
  buffer_store_dwordx4 v[104:107], v91, s[16:19], s27 offen offset:512 sc1
  s_nop 0
  v_accvgpr_read_b32 v96, a144
  v_accvgpr_read_b32 v97, a145
  buffer_store_dwordx4 v[112:115], v91, s[16:19], s27 offen offset:1024 sc1
  v_accvgpr_read_b32 v98, a146
  v_accvgpr_read_b32 v99, a147
  v_accvgpr_read_b32 v104, a148
  v_accvgpr_read_b32 v105, a149
  buffer_store_dwordx4 v[120:123], v91, s[16:19], s27 offen offset:1536 sc1
  v_accvgpr_read_b32 v100, a152
  v_accvgpr_read_b32 v101, a153
  v_accvgpr_read_b32 v102, a154
  v_accvgpr_read_b32 v103, a155
  v_accvgpr_read_b32 v106, a150
  v_accvgpr_read_b32 v107, a151
  v_accvgpr_read_b32 v112, a208
  v_accvgpr_read_b32 v113, a209
  v_accvgpr_read_b32 v108, a156
  v_accvgpr_read_b32 v109, a157
  v_accvgpr_read_b32 v110, a158
  v_accvgpr_read_b32 v111, a159
  v_accvgpr_read_b32 v114, a210
  v_accvgpr_read_b32 v115, a211
  v_accvgpr_read_b32 v120, a212
  v_accvgpr_read_b32 v121, a213
  v_accvgpr_read_b32 v116, a216
  v_accvgpr_read_b32 v117, a217
  v_accvgpr_read_b32 v118, a218
  v_accvgpr_read_b32 v119, a219
  v_accvgpr_read_b32 v122, a214
  v_accvgpr_read_b32 v123, a215
  v_cvt_pk_bf16_f32 v96, v96, v97
  v_accvgpr_read_b32 v124, a220
  v_accvgpr_read_b32 v125, a221
  v_accvgpr_read_b32 v126, a222
  v_accvgpr_read_b32 v127, a223
  v_cvt_pk_bf16_f32 v97, v98, v99
  v_cvt_pk_bf16_f32 v104, v104, v105
  v_cvt_pk_bf16_f32 v98, v100, v101
  v_cvt_pk_bf16_f32 v99, v102, v103
  v_cvt_pk_bf16_f32 v105, v106, v107
  v_cvt_pk_bf16_f32 v112, v112, v113
  v_cvt_pk_bf16_f32 v106, v108, v109
  v_cvt_pk_bf16_f32 v107, v110, v111
  v_cvt_pk_bf16_f32 v113, v114, v115
  v_cvt_pk_bf16_f32 v120, v120, v121
  v_cvt_pk_bf16_f32 v114, v116, v117
  v_cvt_pk_bf16_f32 v115, v118, v119
  v_cvt_pk_bf16_f32 v121, v122, v123
  v_cvt_pk_bf16_f32 v122, v124, v125
  v_cvt_pk_bf16_f32 v123, v126, v127
  buffer_store_dwordx4 v[96:99], v91, s[16:19], s27 offen offset:2048 sc1
  buffer_store_dwordx4 v[104:107], v91, s[16:19], s27 offen offset:2560 sc1
  buffer_store_dwordx4 v[112:115], v91, s[16:19], s27 offen offset:3072 sc1
  buffer_store_dwordx4 v[120:123], v91, s[16:19], s27 offen offset:3584 sc1
  v_accvgpr_read_b32 v96, a32
  v_accvgpr_read_b32 v97, a33
  v_accvgpr_read_b32 v98, a34
  v_accvgpr_read_b32 v99, a35
  v_accvgpr_read_b32 v104, a36
  v_accvgpr_read_b32 v105, a37
  v_accvgpr_read_b32 v100, a40
  v_accvgpr_read_b32 v101, a41
  v_accvgpr_read_b32 v102, a42
  v_accvgpr_read_b32 v103, a43
  v_accvgpr_read_b32 v106, a38
  v_accvgpr_read_b32 v107, a39
  v_accvgpr_read_b32 v112, a96
  v_accvgpr_read_b32 v113, a97
  v_accvgpr_read_b32 v108, a44
  v_accvgpr_read_b32 v109, a45
  v_accvgpr_read_b32 v110, a46
  v_accvgpr_read_b32 v111, a47
  v_accvgpr_read_b32 v114, a98
  v_accvgpr_read_b32 v115, a99
  v_accvgpr_read_b32 v120, a100
  v_accvgpr_read_b32 v121, a101
  v_accvgpr_read_b32 v116, a104
  v_accvgpr_read_b32 v117, a105
  v_accvgpr_read_b32 v118, a106
  v_accvgpr_read_b32 v119, a107
  v_accvgpr_read_b32 v122, a102
  v_accvgpr_read_b32 v123, a103
  v_cvt_pk_bf16_f32 v96, v96, v97
  v_accvgpr_read_b32 v124, a108
  v_accvgpr_read_b32 v125, a109
  v_accvgpr_read_b32 v126, a110
  v_accvgpr_read_b32 v127, a111
  v_cvt_pk_bf16_f32 v97, v98, v99
  v_cvt_pk_bf16_f32 v104, v104, v105
  v_cvt_pk_bf16_f32 v98, v100, v101
  v_cvt_pk_bf16_f32 v99, v102, v103
  v_cvt_pk_bf16_f32 v105, v106, v107
  v_cvt_pk_bf16_f32 v112, v112, v113
  v_cvt_pk_bf16_f32 v106, v108, v109
  v_cvt_pk_bf16_f32 v107, v110, v111
  v_cvt_pk_bf16_f32 v113, v114, v115
  v_cvt_pk_bf16_f32 v120, v120, v121
  v_cvt_pk_bf16_f32 v114, v116, v117
  v_cvt_pk_bf16_f32 v115, v118, v119
  v_cvt_pk_bf16_f32 v121, v122, v123
  s_add_u32 s27, s29, 524288
  v_cvt_pk_bf16_f32 v122, v124, v125
  v_cvt_pk_bf16_f32 v123, v126, v127
  buffer_store_dwordx4 v[96:99], v91, s[16:19], s27 offen offset:0 sc1
  buffer_store_dwordx4 v[104:107], v91, s[16:19], s27 offen offset:512 sc1
  s_nop 0
  v_accvgpr_read_b32 v96, a160
  v_accvgpr_read_b32 v97, a161
  buffer_store_dwordx4 v[112:115], v91, s[16:19], s27 offen offset:1024 sc1
  v_accvgpr_read_b32 v98, a162
  v_accvgpr_read_b32 v99, a163
  v_accvgpr_read_b32 v104, a164
  v_accvgpr_read_b32 v105, a165
  buffer_store_dwordx4 v[120:123], v91, s[16:19], s27 offen offset:1536 sc1
  v_accvgpr_read_b32 v100, a168
  v_accvgpr_read_b32 v101, a169
  v_accvgpr_read_b32 v102, a170
  v_accvgpr_read_b32 v103, a171
  v_accvgpr_read_b32 v106, a166
  v_accvgpr_read_b32 v107, a167
  v_accvgpr_read_b32 v112, a224
  v_accvgpr_read_b32 v113, a225
  v_accvgpr_read_b32 v108, a172
  v_accvgpr_read_b32 v109, a173
  v_accvgpr_read_b32 v110, a174
  v_accvgpr_read_b32 v111, a175
  v_accvgpr_read_b32 v114, a226
  v_accvgpr_read_b32 v115, a227
  v_accvgpr_read_b32 v120, a228
  v_accvgpr_read_b32 v121, a229
  v_accvgpr_read_b32 v116, a232
  v_accvgpr_read_b32 v117, a233
  v_accvgpr_read_b32 v118, a234
  v_accvgpr_read_b32 v119, a235
  v_accvgpr_read_b32 v122, a230
  v_accvgpr_read_b32 v123, a231
  v_cvt_pk_bf16_f32 v96, v96, v97
  v_accvgpr_read_b32 v124, a236
  v_accvgpr_read_b32 v125, a237
  v_accvgpr_read_b32 v126, a238
  v_accvgpr_read_b32 v127, a239
  v_cvt_pk_bf16_f32 v97, v98, v99
  v_cvt_pk_bf16_f32 v104, v104, v105
  v_cvt_pk_bf16_f32 v98, v100, v101
  v_cvt_pk_bf16_f32 v99, v102, v103
  v_cvt_pk_bf16_f32 v105, v106, v107
  v_cvt_pk_bf16_f32 v112, v112, v113
  v_cvt_pk_bf16_f32 v106, v108, v109
  v_cvt_pk_bf16_f32 v107, v110, v111
  v_cvt_pk_bf16_f32 v113, v114, v115
  v_cvt_pk_bf16_f32 v120, v120, v121
  v_cvt_pk_bf16_f32 v114, v116, v117
  v_cvt_pk_bf16_f32 v115, v118, v119
  v_cvt_pk_bf16_f32 v121, v122, v123
  v_cvt_pk_bf16_f32 v122, v124, v125
  v_cvt_pk_bf16_f32 v123, v126, v127
  buffer_store_dwordx4 v[96:99], v91, s[16:19], s27 offen offset:2048 sc1
  buffer_store_dwordx4 v[104:107], v91, s[16:19], s27 offen offset:2560 sc1
  buffer_store_dwordx4 v[112:115], v91, s[16:19], s27 offen offset:3072 sc1
  buffer_store_dwordx4 v[120:123], v91, s[16:19], s27 offen offset:3584 sc1
  v_accvgpr_read_b32 v96, a48
  v_accvgpr_read_b32 v97, a49
  v_accvgpr_read_b32 v98, a50
  v_accvgpr_read_b32 v99, a51
  v_accvgpr_read_b32 v104, a52
  v_accvgpr_read_b32 v105, a53
  v_accvgpr_read_b32 v100, a56
  v_accvgpr_read_b32 v101, a57
  v_accvgpr_read_b32 v102, a58
  v_accvgpr_read_b32 v103, a59
  v_accvgpr_read_b32 v106, a54
  v_accvgpr_read_b32 v107, a55
  v_accvgpr_read_b32 v112, a112
  v_accvgpr_read_b32 v113, a113
  v_accvgpr_read_b32 v108, a60
  v_accvgpr_read_b32 v109, a61
  v_accvgpr_read_b32 v110, a62
  v_accvgpr_read_b32 v111, a63
  v_accvgpr_read_b32 v114, a114
  v_accvgpr_read_b32 v115, a115
  v_accvgpr_read_b32 v120, a116
  v_accvgpr_read_b32 v121, a117
  v_accvgpr_read_b32 v116, a120
  v_accvgpr_read_b32 v117, a121
  v_accvgpr_read_b32 v118, a122
  v_accvgpr_read_b32 v119, a123
  v_accvgpr_read_b32 v122, a118
  v_accvgpr_read_b32 v123, a119
  v_cvt_pk_bf16_f32 v96, v96, v97
  v_accvgpr_read_b32 v124, a124
  v_accvgpr_read_b32 v125, a125
  v_accvgpr_read_b32 v126, a126
  v_accvgpr_read_b32 v127, a127
  v_cvt_pk_bf16_f32 v97, v98, v99
  v_cvt_pk_bf16_f32 v104, v104, v105
  v_cvt_pk_bf16_f32 v98, v100, v101
  v_cvt_pk_bf16_f32 v99, v102, v103
  v_cvt_pk_bf16_f32 v105, v106, v107
  v_cvt_pk_bf16_f32 v112, v112, v113
  v_cvt_pk_bf16_f32 v106, v108, v109
  v_cvt_pk_bf16_f32 v107, v110, v111
  v_cvt_pk_bf16_f32 v113, v114, v115
  v_cvt_pk_bf16_f32 v120, v120, v121
  v_cvt_pk_bf16_f32 v114, v116, v117
  v_cvt_pk_bf16_f32 v115, v118, v119
  v_cvt_pk_bf16_f32 v121, v122, v123
  s_add_u32 s27, s29, 786432
  v_cvt_pk_bf16_f32 v122, v124, v125
  v_cvt_pk_bf16_f32 v123, v126, v127
  buffer_store_dwordx4 v[96:99], v91, s[16:19], s27 offen offset:0 sc1
  buffer_store_dwordx4 v[104:107], v91, s[16:19], s27 offen offset:512 sc1
  s_nop 0
  v_accvgpr_read_b32 v96, a176
  v_accvgpr_read_b32 v97, a177
  buffer_store_dwordx4 v[112:115], v91, s[16:19], s27 offen offset:1024 sc1
  v_accvgpr_read_b32 v98, a178
  v_accvgpr_read_b32 v99, a179
  v_accvgpr_read_b32 v104, a180
  v_accvgpr_read_b32 v105, a181
  buffer_store_dwordx4 v[120:123], v91, s[16:19], s27 offen offset:1536 sc1
  v_accvgpr_read_b32 v100, a184
  v_accvgpr_read_b32 v101, a185
  v_accvgpr_read_b32 v102, a186
  v_accvgpr_read_b32 v103, a187
  v_accvgpr_read_b32 v106, a182
  v_accvgpr_read_b32 v107, a183
  v_accvgpr_read_b32 v112, a240
  v_accvgpr_read_b32 v113, a241
  v_accvgpr_read_b32 v108, a188
  v_accvgpr_read_b32 v109, a189
  v_accvgpr_read_b32 v110, a190
  v_accvgpr_read_b32 v111, a191
  v_accvgpr_read_b32 v114, a242
  v_accvgpr_read_b32 v115, a243
  v_accvgpr_read_b32 v120, a244
  v_accvgpr_read_b32 v121, a245
  v_accvgpr_read_b32 v116, a248
  v_accvgpr_read_b32 v117, a249
  v_accvgpr_read_b32 v118, a250
  v_accvgpr_read_b32 v119, a251
  v_accvgpr_read_b32 v122, a246
  v_accvgpr_read_b32 v123, a247
  v_cvt_pk_bf16_f32 v96, v96, v97
  v_accvgpr_read_b32 v124, a252
  v_accvgpr_read_b32 v125, a253
  v_accvgpr_read_b32 v126, a254
  v_accvgpr_read_b32 v127, a255
  v_cvt_pk_bf16_f32 v97, v98, v99
  v_cvt_pk_bf16_f32 v104, v104, v105
  v_cvt_pk_bf16_f32 v98, v100, v101
  v_cvt_pk_bf16_f32 v99, v102, v103
  v_cvt_pk_bf16_f32 v105, v106, v107
  v_cvt_pk_bf16_f32 v112, v112, v113
  v_cvt_pk_bf16_f32 v106, v108, v109
  v_cvt_pk_bf16_f32 v107, v110, v111
  v_cvt_pk_bf16_f32 v113, v114, v115
  v_cvt_pk_bf16_f32 v120, v120, v121
  v_cvt_pk_bf16_f32 v114, v116, v117
  v_cvt_pk_bf16_f32 v115, v118, v119
  v_cvt_pk_bf16_f32 v121, v122, v123
  v_cvt_pk_bf16_f32 v122, v124, v125
  v_cvt_pk_bf16_f32 v123, v126, v127
  buffer_store_dwordx4 v[96:99], v91, s[16:19], s27 offen offset:2048 sc1
  buffer_store_dwordx4 v[104:107], v91, s[16:19], s27 offen offset:2560 sc1
  buffer_store_dwordx4 v[112:115], v91, s[16:19], s27 offen offset:3072 sc1
  buffer_store_dwordx4 v[120:123], v91, s[16:19], s27 offen offset:3584 sc1
  s_branch L_j_donew
L_j_ehw:
  s_lshr_b32 s27, s31, 1
  s_lshl_b32 s27, s27, 2
  s_lshl_b32 s28, s34, 3
  s_add_u32 s27, s27, s28
  s_mul_i32 s27, s27, 144
  s_and_b32 s28, s31, 1
  s_lshl_b32 s28, s28, 1
  s_lshl_b32 s29, s35, 2
  s_add_u32 s27, s27, s28
  s_add_u32 s27, s27, s29
  s_lshl_b32 s29, s27, 11
  s_add_u32 s29, s29, 72351744
  v_and_b32 v1, 63, v0
  v_lshrrev_b32 v2, 5, v1
  v_lshlrev_b32 v2, 9, v2
  v_and_b32 v3, 31, v1
  v_lshlrev_b32 v3, 4, v3
  v_add_u32 v91, v2, v3
  s_mov_b32 s30, 0xbfb8aa3b
  v_accvgpr_read_b32 v96, a0
  v_accvgpr_read_b32 v97, a1
  v_accvgpr_read_b32 v98, a2
  v_accvgpr_read_b32 v99, a3
  v_accvgpr_read_b32 v100, a8
  v_accvgpr_read_b32 v101, a9
  v_accvgpr_read_b32 v102, a10
  v_accvgpr_read_b32 v103, a11
  v_accvgpr_read_b32 v120, a4
  v_accvgpr_read_b32 v121, a5
  v_accvgpr_read_b32 v122, a6
  v_accvgpr_read_b32 v123, a7
  v_accvgpr_read_b32 v124, a12
  v_accvgpr_read_b32 v125, a13
  v_accvgpr_read_b32 v126, a14
  v_accvgpr_read_b32 v127, a15
  v_mul_f32 v112, s30, v96
  v_mul_f32 v113, s30, v97
  v_mul_f32 v114, s30, v98
  v_mul_f32 v115, s30, v99
  v_mul_f32 v116, s30, v100
  v_mul_f32 v117, s30, v101
  v_mul_f32 v118, s30, v102
  v_mul_f32 v119, s30, v103
  v_mul_f32 v136, s30, v120
  v_mul_f32 v137, s30, v121
  v_mul_f32 v138, s30, v122
  v_mul_f32 v139, s30, v123
  v_mul_f32 v140, s30, v124
  v_mul_f32 v141, s30, v125
  v_mul_f32 v142, s30, v126
  v_mul_f32 v143, s30, v127
  v_exp_f32 v112, v112
  s_add_u32 s27, s29, 0
  v_exp_f32 v113, v113
  v_exp_f32 v114, v114
  v_exp_f32 v115, v115
  v_exp_f32 v116, v116
  v_exp_f32 v117, v117
  v_exp_f32 v118, v118
  v_exp_f32 v119, v119
  v_exp_f32 v136, v136
  v_exp_f32 v137, v137
  v_exp_f32 v138, v138
  v_exp_f32 v139, v139
  v_exp_f32 v140, v140
  v_exp_f32 v141, v141
  v_exp_f32 v142, v142
  v_exp_f32 v143, v143
  v_add_f32 v112, 1.0, v112
  v_add_f32 v113, 1.0, v113
  v_add_f32 v114, 1.0, v114
  v_add_f32 v115, 1.0, v115
  v_add_f32 v116, 1.0, v116
  v_add_f32 v117, 1.0, v117
  v_add_f32 v118, 1.0, v118
  v_add_f32 v119, 1.0, v119
  v_add_f32 v136, 1.0, v136
  v_add_f32 v137, 1.0, v137
  v_add_f32 v138, 1.0, v138
  v_add_f32 v139, 1.0, v139
  v_add_f32 v140, 1.0, v140
  v_add_f32 v141, 1.0, v141
  v_add_f32 v142, 1.0, v142
  v_add_f32 v143, 1.0, v143
  v_rcp_f32 v112, v112
  v_rcp_f32 v113, v113
  v_rcp_f32 v114, v114
  v_rcp_f32 v115, v115
  v_rcp_f32 v116, v116
  v_rcp_f32 v117, v117
  v_rcp_f32 v118, v118
  v_rcp_f32 v119, v119
  v_rcp_f32 v136, v136
  v_rcp_f32 v137, v137
  v_rcp_f32 v138, v138
  v_rcp_f32 v139, v139
  v_rcp_f32 v140, v140
  v_rcp_f32 v141, v141
  v_rcp_f32 v142, v142
  v_rcp_f32 v143, v143
  v_accvgpr_read_b32 v104, a128
  v_accvgpr_read_b32 v105, a129
  v_accvgpr_read_b32 v106, a130
  v_accvgpr_read_b32 v107, a131
  v_accvgpr_read_b32 v108, a136
  v_accvgpr_read_b32 v109, a137
  v_accvgpr_read_b32 v110, a138
  v_accvgpr_read_b32 v111, a139
  v_accvgpr_read_b32 v128, a132
  v_accvgpr_read_b32 v129, a133
  v_accvgpr_read_b32 v130, a134
  v_accvgpr_read_b32 v131, a135
  v_accvgpr_read_b32 v132, a140
  v_accvgpr_read_b32 v133, a141
  v_accvgpr_read_b32 v134, a142
  v_accvgpr_read_b32 v135, a143
  v_mul_f32 v96, v96, v104
  v_mul_f32 v97, v97, v105
  v_mul_f32 v98, v98, v106
  v_mul_f32 v99, v99, v107
  v_mul_f32 v100, v100, v108
  v_mul_f32 v101, v101, v109
  v_mul_f32 v102, v102, v110
  v_mul_f32 v103, v103, v111
  v_mul_f32 v120, v120, v128
  v_mul_f32 v121, v121, v129
  v_mul_f32 v122, v122, v130
  v_mul_f32 v123, v123, v131
  v_mul_f32 v124, v124, v132
  v_mul_f32 v125, v125, v133
  v_mul_f32 v126, v126, v134
  v_mul_f32 v127, v127, v135
  v_mul_f32 v96, v96, v112
  v_mul_f32 v97, v97, v113
  v_mul_f32 v98, v98, v114
  v_mul_f32 v99, v99, v115
  v_mul_f32 v100, v100, v116
  v_mul_f32 v101, v101, v117
  v_mul_f32 v102, v102, v118
  v_mul_f32 v103, v103, v119
  v_mul_f32 v120, v120, v136
  v_mul_f32 v121, v121, v137
  v_mul_f32 v122, v122, v138
  v_mul_f32 v123, v123, v139
  v_mul_f32 v124, v124, v140
  v_mul_f32 v125, v125, v141
  v_mul_f32 v126, v126, v142
  v_mul_f32 v127, v127, v143
  v_cvt_pk_bf16_f32 v104, v96, v97
  v_cvt_pk_bf16_f32 v105, v98, v99
  v_cvt_pk_bf16_f32 v106, v100, v101
  v_cvt_pk_bf16_f32 v107, v102, v103
  v_cvt_pk_bf16_f32 v128, v120, v121
  v_cvt_pk_bf16_f32 v129, v122, v123
  v_cvt_pk_bf16_f32 v130, v124, v125
  v_cvt_pk_bf16_f32 v131, v126, v127
  buffer_store_dwordx4 v[104:107], v91, s[16:19], s27 offen offset:0 sc1
  buffer_store_dwordx4 v[128:131], v91, s[16:19], s27 offen offset:1024 sc1
  v_accvgpr_read_b32 v96, a64
  v_accvgpr_read_b32 v97, a65
  v_accvgpr_read_b32 v98, a66
  v_accvgpr_read_b32 v99, a67
  v_accvgpr_read_b32 v100, a72
  v_accvgpr_read_b32 v101, a73
  v_accvgpr_read_b32 v102, a74
  v_accvgpr_read_b32 v103, a75
  v_accvgpr_read_b32 v120, a68
  v_accvgpr_read_b32 v121, a69
  v_accvgpr_read_b32 v122, a70
  v_accvgpr_read_b32 v123, a71
  v_accvgpr_read_b32 v124, a76
  v_accvgpr_read_b32 v125, a77
  v_accvgpr_read_b32 v126, a78
  v_accvgpr_read_b32 v127, a79
  v_mul_f32 v112, s30, v96
  v_mul_f32 v113, s30, v97
  v_mul_f32 v114, s30, v98
  v_mul_f32 v115, s30, v99
  v_mul_f32 v116, s30, v100
  v_mul_f32 v117, s30, v101
  v_mul_f32 v118, s30, v102
  v_mul_f32 v119, s30, v103
  v_mul_f32 v136, s30, v120
  v_mul_f32 v137, s30, v121
  v_mul_f32 v138, s30, v122
  v_mul_f32 v139, s30, v123
  v_mul_f32 v140, s30, v124
  v_mul_f32 v141, s30, v125
  v_mul_f32 v142, s30, v126
  v_mul_f32 v143, s30, v127
  v_exp_f32 v112, v112
  s_add_u32 s27, s29, 2048
  v_exp_f32 v113, v113
  v_exp_f32 v114, v114
  v_exp_f32 v115, v115
  v_exp_f32 v116, v116
  v_exp_f32 v117, v117
  v_exp_f32 v118, v118
  v_exp_f32 v119, v119
  v_exp_f32 v136, v136
  v_exp_f32 v137, v137
  v_exp_f32 v138, v138
  v_exp_f32 v139, v139
  v_exp_f32 v140, v140
  v_exp_f32 v141, v141
  v_exp_f32 v142, v142
  v_exp_f32 v143, v143
  v_add_f32 v112, 1.0, v112
  v_add_f32 v113, 1.0, v113
  v_add_f32 v114, 1.0, v114
  v_add_f32 v115, 1.0, v115
  v_add_f32 v116, 1.0, v116
  v_add_f32 v117, 1.0, v117
  v_add_f32 v118, 1.0, v118
  v_add_f32 v119, 1.0, v119
  v_add_f32 v136, 1.0, v136
  v_add_f32 v137, 1.0, v137
  v_add_f32 v138, 1.0, v138
  v_add_f32 v139, 1.0, v139
  v_add_f32 v140, 1.0, v140
  v_add_f32 v141, 1.0, v141
  v_add_f32 v142, 1.0, v142
  v_add_f32 v143, 1.0, v143
  v_rcp_f32 v112, v112
  v_rcp_f32 v113, v113
  v_rcp_f32 v114, v114
  v_rcp_f32 v115, v115
  v_rcp_f32 v116, v116
  v_rcp_f32 v117, v117
  v_rcp_f32 v118, v118
  v_rcp_f32 v119, v119
  v_rcp_f32 v136, v136
  v_rcp_f32 v137, v137
  v_rcp_f32 v138, v138
  v_rcp_f32 v139, v139
  v_rcp_f32 v140, v140
  v_rcp_f32 v141, v141
  v_rcp_f32 v142, v142
  v_rcp_f32 v143, v143
  v_accvgpr_read_b32 v104, a192
  v_accvgpr_read_b32 v105, a193
  v_accvgpr_read_b32 v106, a194
  v_accvgpr_read_b32 v107, a195
  v_accvgpr_read_b32 v108, a200
  v_accvgpr_read_b32 v109, a201
  v_accvgpr_read_b32 v110, a202
  v_accvgpr_read_b32 v111, a203
  v_accvgpr_read_b32 v128, a196
  v_accvgpr_read_b32 v129, a197
  v_accvgpr_read_b32 v130, a198
  v_accvgpr_read_b32 v131, a199
  v_accvgpr_read_b32 v132, a204
  v_accvgpr_read_b32 v133, a205
  v_accvgpr_read_b32 v134, a206
  v_accvgpr_read_b32 v135, a207
  v_mul_f32 v96, v96, v104
  v_mul_f32 v97, v97, v105
  v_mul_f32 v98, v98, v106
  v_mul_f32 v99, v99, v107
  v_mul_f32 v100, v100, v108
  v_mul_f32 v101, v101, v109
  v_mul_f32 v102, v102, v110
  v_mul_f32 v103, v103, v111
  v_mul_f32 v120, v120, v128
  v_mul_f32 v121, v121, v129
  v_mul_f32 v122, v122, v130
  v_mul_f32 v123, v123, v131
  v_mul_f32 v124, v124, v132
  v_mul_f32 v125, v125, v133
  v_mul_f32 v126, v126, v134
  v_mul_f32 v127, v127, v135
  v_mul_f32 v96, v96, v112
  v_mul_f32 v97, v97, v113
  v_mul_f32 v98, v98, v114
  v_mul_f32 v99, v99, v115
  v_mul_f32 v100, v100, v116
  v_mul_f32 v101, v101, v117
  v_mul_f32 v102, v102, v118
  v_mul_f32 v103, v103, v119
  v_mul_f32 v120, v120, v136
  v_mul_f32 v121, v121, v137
  v_mul_f32 v122, v122, v138
  v_mul_f32 v123, v123, v139
  v_mul_f32 v124, v124, v140
  v_mul_f32 v125, v125, v141
  v_mul_f32 v126, v126, v142
  v_mul_f32 v127, v127, v143
  v_cvt_pk_bf16_f32 v104, v96, v97
  v_cvt_pk_bf16_f32 v105, v98, v99
  v_cvt_pk_bf16_f32 v106, v100, v101
  v_cvt_pk_bf16_f32 v107, v102, v103
  v_cvt_pk_bf16_f32 v128, v120, v121
  v_cvt_pk_bf16_f32 v129, v122, v123
  v_cvt_pk_bf16_f32 v130, v124, v125
  v_cvt_pk_bf16_f32 v131, v126, v127
  buffer_store_dwordx4 v[104:107], v91, s[16:19], s27 offen offset:0 sc1
  buffer_store_dwordx4 v[128:131], v91, s[16:19], s27 offen offset:1024 sc1
  v_accvgpr_read_b32 v96, a16
  v_accvgpr_read_b32 v97, a17
  v_accvgpr_read_b32 v98, a18
  v_accvgpr_read_b32 v99, a19
  v_accvgpr_read_b32 v100, a24
  v_accvgpr_read_b32 v101, a25
  v_accvgpr_read_b32 v102, a26
  v_accvgpr_read_b32 v103, a27
  v_accvgpr_read_b32 v120, a20
  v_accvgpr_read_b32 v121, a21
  v_accvgpr_read_b32 v122, a22
  v_accvgpr_read_b32 v123, a23
  v_accvgpr_read_b32 v124, a28
  v_accvgpr_read_b32 v125, a29
  v_accvgpr_read_b32 v126, a30
  v_accvgpr_read_b32 v127, a31
  v_mul_f32 v112, s30, v96
  v_mul_f32 v113, s30, v97
  v_mul_f32 v114, s30, v98
  v_mul_f32 v115, s30, v99
  v_mul_f32 v116, s30, v100
  v_mul_f32 v117, s30, v101
  v_mul_f32 v118, s30, v102
  v_mul_f32 v119, s30, v103
  v_mul_f32 v136, s30, v120
  v_mul_f32 v137, s30, v121
  v_mul_f32 v138, s30, v122
  v_mul_f32 v139, s30, v123
  v_mul_f32 v140, s30, v124
  v_mul_f32 v141, s30, v125
  v_mul_f32 v142, s30, v126
  v_mul_f32 v143, s30, v127
  v_exp_f32 v112, v112
  s_add_u32 s27, s29, 294912
  v_exp_f32 v113, v113
  v_exp_f32 v114, v114
  v_exp_f32 v115, v115
  v_exp_f32 v116, v116
  v_exp_f32 v117, v117
  v_exp_f32 v118, v118
  v_exp_f32 v119, v119
  v_exp_f32 v136, v136
  v_exp_f32 v137, v137
  v_exp_f32 v138, v138
  v_exp_f32 v139, v139
  v_exp_f32 v140, v140
  v_exp_f32 v141, v141
  v_exp_f32 v142, v142
  v_exp_f32 v143, v143
  v_add_f32 v112, 1.0, v112
  v_add_f32 v113, 1.0, v113
  v_add_f32 v114, 1.0, v114
  v_add_f32 v115, 1.0, v115
  v_add_f32 v116, 1.0, v116
  v_add_f32 v117, 1.0, v117
  v_add_f32 v118, 1.0, v118
  v_add_f32 v119, 1.0, v119
  v_add_f32 v136, 1.0, v136
  v_add_f32 v137, 1.0, v137
  v_add_f32 v138, 1.0, v138
  v_add_f32 v139, 1.0, v139
  v_add_f32 v140, 1.0, v140
  v_add_f32 v141, 1.0, v141
  v_add_f32 v142, 1.0, v142
  v_add_f32 v143, 1.0, v143
  v_rcp_f32 v112, v112
  v_rcp_f32 v113, v113
  v_rcp_f32 v114, v114
  v_rcp_f32 v115, v115
  v_rcp_f32 v116, v116
  v_rcp_f32 v117, v117
  v_rcp_f32 v118, v118
  v_rcp_f32 v119, v119
  v_rcp_f32 v136, v136
  v_rcp_f32 v137, v137
  v_rcp_f32 v138, v138
  v_rcp_f32 v139, v139
  v_rcp_f32 v140, v140
  v_rcp_f32 v141, v141
  v_rcp_f32 v142, v142
  v_rcp_f32 v143, v143
  v_accvgpr_read_b32 v104, a144
  v_accvgpr_read_b32 v105, a145
  v_accvgpr_read_b32 v106, a146
  v_accvgpr_read_b32 v107, a147
  v_accvgpr_read_b32 v108, a152
  v_accvgpr_read_b32 v109, a153
  v_accvgpr_read_b32 v110, a154
  v_accvgpr_read_b32 v111, a155
  v_accvgpr_read_b32 v128, a148
  v_accvgpr_read_b32 v129, a149
  v_accvgpr_read_b32 v130, a150
  v_accvgpr_read_b32 v131, a151
  v_accvgpr_read_b32 v132, a156
  v_accvgpr_read_b32 v133, a157
  v_accvgpr_read_b32 v134, a158
  v_accvgpr_read_b32 v135, a159
  v_mul_f32 v96, v96, v104
  v_mul_f32 v97, v97, v105
  v_mul_f32 v98, v98, v106
  v_mul_f32 v99, v99, v107
  v_mul_f32 v100, v100, v108
  v_mul_f32 v101, v101, v109
  v_mul_f32 v102, v102, v110
  v_mul_f32 v103, v103, v111
  v_mul_f32 v120, v120, v128
  v_mul_f32 v121, v121, v129
  v_mul_f32 v122, v122, v130
  v_mul_f32 v123, v123, v131
  v_mul_f32 v124, v124, v132
  v_mul_f32 v125, v125, v133
  v_mul_f32 v126, v126, v134
  v_mul_f32 v127, v127, v135
  v_mul_f32 v96, v96, v112
  v_mul_f32 v97, v97, v113
  v_mul_f32 v98, v98, v114
  v_mul_f32 v99, v99, v115
  v_mul_f32 v100, v100, v116
  v_mul_f32 v101, v101, v117
  v_mul_f32 v102, v102, v118
  v_mul_f32 v103, v103, v119
  v_mul_f32 v120, v120, v136
  v_mul_f32 v121, v121, v137
  v_mul_f32 v122, v122, v138
  v_mul_f32 v123, v123, v139
  v_mul_f32 v124, v124, v140
  v_mul_f32 v125, v125, v141
  v_mul_f32 v126, v126, v142
  v_mul_f32 v127, v127, v143
  v_cvt_pk_bf16_f32 v104, v96, v97
  v_cvt_pk_bf16_f32 v105, v98, v99
  v_cvt_pk_bf16_f32 v106, v100, v101
  v_cvt_pk_bf16_f32 v107, v102, v103
  v_cvt_pk_bf16_f32 v128, v120, v121
  v_cvt_pk_bf16_f32 v129, v122, v123
  v_cvt_pk_bf16_f32 v130, v124, v125
  v_cvt_pk_bf16_f32 v131, v126, v127
  buffer_store_dwordx4 v[104:107], v91, s[16:19], s27 offen offset:0 sc1
  buffer_store_dwordx4 v[128:131], v91, s[16:19], s27 offen offset:1024 sc1
  v_accvgpr_read_b32 v96, a80
  v_accvgpr_read_b32 v97, a81
  v_accvgpr_read_b32 v98, a82
  v_accvgpr_read_b32 v99, a83
  v_accvgpr_read_b32 v100, a88
  v_accvgpr_read_b32 v101, a89
  v_accvgpr_read_b32 v102, a90
  v_accvgpr_read_b32 v103, a91
  v_accvgpr_read_b32 v120, a84
  v_accvgpr_read_b32 v121, a85
  v_accvgpr_read_b32 v122, a86
  v_accvgpr_read_b32 v123, a87
  v_accvgpr_read_b32 v124, a92
  v_accvgpr_read_b32 v125, a93
  v_accvgpr_read_b32 v126, a94
  v_accvgpr_read_b32 v127, a95
  v_mul_f32 v112, s30, v96
  v_mul_f32 v113, s30, v97
  v_mul_f32 v114, s30, v98
  v_mul_f32 v115, s30, v99
  v_mul_f32 v116, s30, v100
  v_mul_f32 v117, s30, v101
  v_mul_f32 v118, s30, v102
  v_mul_f32 v119, s30, v103
  v_mul_f32 v136, s30, v120
  v_mul_f32 v137, s30, v121
  v_mul_f32 v138, s30, v122
  v_mul_f32 v139, s30, v123
  v_mul_f32 v140, s30, v124
  v_mul_f32 v141, s30, v125
  v_mul_f32 v142, s30, v126
  v_mul_f32 v143, s30, v127
  v_exp_f32 v112, v112
  s_add_u32 s27, s29, 296960
  v_exp_f32 v113, v113
  v_exp_f32 v114, v114
  v_exp_f32 v115, v115
  v_exp_f32 v116, v116
  v_exp_f32 v117, v117
  v_exp_f32 v118, v118
  v_exp_f32 v119, v119
  v_exp_f32 v136, v136
  v_exp_f32 v137, v137
  v_exp_f32 v138, v138
  v_exp_f32 v139, v139
  v_exp_f32 v140, v140
  v_exp_f32 v141, v141
  v_exp_f32 v142, v142
  v_exp_f32 v143, v143
  v_add_f32 v112, 1.0, v112
  v_add_f32 v113, 1.0, v113
  v_add_f32 v114, 1.0, v114
  v_add_f32 v115, 1.0, v115
  v_add_f32 v116, 1.0, v116
  v_add_f32 v117, 1.0, v117
  v_add_f32 v118, 1.0, v118
  v_add_f32 v119, 1.0, v119
  v_add_f32 v136, 1.0, v136
  v_add_f32 v137, 1.0, v137
  v_add_f32 v138, 1.0, v138
  v_add_f32 v139, 1.0, v139
  v_add_f32 v140, 1.0, v140
  v_add_f32 v141, 1.0, v141
  v_add_f32 v142, 1.0, v142
  v_add_f32 v143, 1.0, v143
  v_rcp_f32 v112, v112
  v_rcp_f32 v113, v113
  v_rcp_f32 v114, v114
  v_rcp_f32 v115, v115
  v_rcp_f32 v116, v116
  v_rcp_f32 v117, v117
  v_rcp_f32 v118, v118
  v_rcp_f32 v119, v119
  v_rcp_f32 v136, v136
  v_rcp_f32 v137, v137
  v_rcp_f32 v138, v138
  v_rcp_f32 v139, v139
  v_rcp_f32 v140, v140
  v_rcp_f32 v141, v141
  v_rcp_f32 v142, v142
  v_rcp_f32 v143, v143
  v_accvgpr_read_b32 v104, a208
  v_accvgpr_read_b32 v105, a209
  v_accvgpr_read_b32 v106, a210
  v_accvgpr_read_b32 v107, a211
  v_accvgpr_read_b32 v108, a216
  v_accvgpr_read_b32 v109, a217
  v_accvgpr_read_b32 v110, a218
  v_accvgpr_read_b32 v111, a219
  v_accvgpr_read_b32 v128, a212
  v_accvgpr_read_b32 v129, a213
  v_accvgpr_read_b32 v130, a214
  v_accvgpr_read_b32 v131, a215
  v_accvgpr_read_b32 v132, a220
  v_accvgpr_read_b32 v133, a221
  v_accvgpr_read_b32 v134, a222
  v_accvgpr_read_b32 v135, a223
  v_mul_f32 v96, v96, v104
  v_mul_f32 v97, v97, v105
  v_mul_f32 v98, v98, v106
  v_mul_f32 v99, v99, v107
  v_mul_f32 v100, v100, v108
  v_mul_f32 v101, v101, v109
  v_mul_f32 v102, v102, v110
  v_mul_f32 v103, v103, v111
  v_mul_f32 v120, v120, v128
  v_mul_f32 v121, v121, v129
  v_mul_f32 v122, v122, v130
  v_mul_f32 v123, v123, v131
  v_mul_f32 v124, v124, v132
  v_mul_f32 v125, v125, v133
  v_mul_f32 v126, v126, v134
  v_mul_f32 v127, v127, v135
  v_mul_f32 v96, v96, v112
  v_mul_f32 v97, v97, v113
  v_mul_f32 v98, v98, v114
  v_mul_f32 v99, v99, v115
  v_mul_f32 v100, v100, v116
  v_mul_f32 v101, v101, v117
  v_mul_f32 v102, v102, v118
  v_mul_f32 v103, v103, v119
  v_mul_f32 v120, v120, v136
  v_mul_f32 v121, v121, v137
  v_mul_f32 v122, v122, v138
  v_mul_f32 v123, v123, v139
  v_mul_f32 v124, v124, v140
  v_mul_f32 v125, v125, v141
  v_mul_f32 v126, v126, v142
  v_mul_f32 v127, v127, v143
  v_cvt_pk_bf16_f32 v104, v96, v97
  v_cvt_pk_bf16_f32 v105, v98, v99
  v_cvt_pk_bf16_f32 v106, v100, v101
  v_cvt_pk_bf16_f32 v107, v102, v103
  v_cvt_pk_bf16_f32 v128, v120, v121
  v_cvt_pk_bf16_f32 v129, v122, v123
  v_cvt_pk_bf16_f32 v130, v124, v125
  v_cvt_pk_bf16_f32 v131, v126, v127
  buffer_store_dwordx4 v[104:107], v91, s[16:19], s27 offen offset:0 sc1
  buffer_store_dwordx4 v[128:131], v91, s[16:19], s27 offen offset:1024 sc1
  v_accvgpr_read_b32 v96, a32
  v_accvgpr_read_b32 v97, a33
  v_accvgpr_read_b32 v98, a34
  v_accvgpr_read_b32 v99, a35
  v_accvgpr_read_b32 v100, a40
  v_accvgpr_read_b32 v101, a41
  v_accvgpr_read_b32 v102, a42
  v_accvgpr_read_b32 v103, a43
  v_accvgpr_read_b32 v120, a36
  v_accvgpr_read_b32 v121, a37
  v_accvgpr_read_b32 v122, a38
  v_accvgpr_read_b32 v123, a39
  v_accvgpr_read_b32 v124, a44
  v_accvgpr_read_b32 v125, a45
  v_accvgpr_read_b32 v126, a46
  v_accvgpr_read_b32 v127, a47
  v_mul_f32 v112, s30, v96
  v_mul_f32 v113, s30, v97
  v_mul_f32 v114, s30, v98
  v_mul_f32 v115, s30, v99
  v_mul_f32 v116, s30, v100
  v_mul_f32 v117, s30, v101
  v_mul_f32 v118, s30, v102
  v_mul_f32 v119, s30, v103
  v_mul_f32 v136, s30, v120
  v_mul_f32 v137, s30, v121
  v_mul_f32 v138, s30, v122
  v_mul_f32 v139, s30, v123
  v_mul_f32 v140, s30, v124
  v_mul_f32 v141, s30, v125
  v_mul_f32 v142, s30, v126
  v_mul_f32 v143, s30, v127
  v_exp_f32 v112, v112
  s_add_u32 s27, s29, 589824
  v_exp_f32 v113, v113
  v_exp_f32 v114, v114
  v_exp_f32 v115, v115
  v_exp_f32 v116, v116
  v_exp_f32 v117, v117
  v_exp_f32 v118, v118
  v_exp_f32 v119, v119
  v_exp_f32 v136, v136
  v_exp_f32 v137, v137
  v_exp_f32 v138, v138
  v_exp_f32 v139, v139
  v_exp_f32 v140, v140
  v_exp_f32 v141, v141
  v_exp_f32 v142, v142
  v_exp_f32 v143, v143
  v_add_f32 v112, 1.0, v112
  v_add_f32 v113, 1.0, v113
  v_add_f32 v114, 1.0, v114
  v_add_f32 v115, 1.0, v115
  v_add_f32 v116, 1.0, v116
  v_add_f32 v117, 1.0, v117
  v_add_f32 v118, 1.0, v118
  v_add_f32 v119, 1.0, v119
  v_add_f32 v136, 1.0, v136
  v_add_f32 v137, 1.0, v137
  v_add_f32 v138, 1.0, v138
  v_add_f32 v139, 1.0, v139
  v_add_f32 v140, 1.0, v140
  v_add_f32 v141, 1.0, v141
  v_add_f32 v142, 1.0, v142
  v_add_f32 v143, 1.0, v143
  v_rcp_f32 v112, v112
  v_rcp_f32 v113, v113
  v_rcp_f32 v114, v114
  v_rcp_f32 v115, v115
  v_rcp_f32 v116, v116
  v_rcp_f32 v117, v117
  v_rcp_f32 v118, v118
  v_rcp_f32 v119, v119
  v_rcp_f32 v136, v136
  v_rcp_f32 v137, v137
  v_rcp_f32 v138, v138
  v_rcp_f32 v139, v139
  v_rcp_f32 v140, v140
  v_rcp_f32 v141, v141
  v_rcp_f32 v142, v142
  v_rcp_f32 v143, v143
  v_accvgpr_read_b32 v104, a160
  v_accvgpr_read_b32 v105, a161
  v_accvgpr_read_b32 v106, a162
  v_accvgpr_read_b32 v107, a163
  v_accvgpr_read_b32 v108, a168
  v_accvgpr_read_b32 v109, a169
  v_accvgpr_read_b32 v110, a170
  v_accvgpr_read_b32 v111, a171
  v_accvgpr_read_b32 v128, a164
  v_accvgpr_read_b32 v129, a165
  v_accvgpr_read_b32 v130, a166
  v_accvgpr_read_b32 v131, a167
  v_accvgpr_read_b32 v132, a172
  v_accvgpr_read_b32 v133, a173
  v_accvgpr_read_b32 v134, a174
  v_accvgpr_read_b32 v135, a175
  v_mul_f32 v96, v96, v104
  v_mul_f32 v97, v97, v105
  v_mul_f32 v98, v98, v106
  v_mul_f32 v99, v99, v107
  v_mul_f32 v100, v100, v108
  v_mul_f32 v101, v101, v109
  v_mul_f32 v102, v102, v110
  v_mul_f32 v103, v103, v111
  v_mul_f32 v120, v120, v128
  v_mul_f32 v121, v121, v129
  v_mul_f32 v122, v122, v130
  v_mul_f32 v123, v123, v131
  v_mul_f32 v124, v124, v132
  v_mul_f32 v125, v125, v133
  v_mul_f32 v126, v126, v134
  v_mul_f32 v127, v127, v135
  v_mul_f32 v96, v96, v112
  v_mul_f32 v97, v97, v113
  v_mul_f32 v98, v98, v114
  v_mul_f32 v99, v99, v115
  v_mul_f32 v100, v100, v116
  v_mul_f32 v101, v101, v117
  v_mul_f32 v102, v102, v118
  v_mul_f32 v103, v103, v119
  v_mul_f32 v120, v120, v136
  v_mul_f32 v121, v121, v137
  v_mul_f32 v122, v122, v138
  v_mul_f32 v123, v123, v139
  v_mul_f32 v124, v124, v140
  v_mul_f32 v125, v125, v141
  v_mul_f32 v126, v126, v142
  v_mul_f32 v127, v127, v143
  v_cvt_pk_bf16_f32 v104, v96, v97
  v_cvt_pk_bf16_f32 v105, v98, v99
  v_cvt_pk_bf16_f32 v106, v100, v101
  v_cvt_pk_bf16_f32 v107, v102, v103
  v_cvt_pk_bf16_f32 v128, v120, v121
  v_cvt_pk_bf16_f32 v129, v122, v123
  v_cvt_pk_bf16_f32 v130, v124, v125
  v_cvt_pk_bf16_f32 v131, v126, v127
  buffer_store_dwordx4 v[104:107], v91, s[16:19], s27 offen offset:0 sc1
  buffer_store_dwordx4 v[128:131], v91, s[16:19], s27 offen offset:1024 sc1
  v_accvgpr_read_b32 v96, a96
  v_accvgpr_read_b32 v97, a97
  v_accvgpr_read_b32 v98, a98
  v_accvgpr_read_b32 v99, a99
  v_accvgpr_read_b32 v100, a104
  v_accvgpr_read_b32 v101, a105
  v_accvgpr_read_b32 v102, a106
  v_accvgpr_read_b32 v103, a107
  v_accvgpr_read_b32 v120, a100
  v_accvgpr_read_b32 v121, a101
  v_accvgpr_read_b32 v122, a102
  v_accvgpr_read_b32 v123, a103
  v_accvgpr_read_b32 v124, a108
  v_accvgpr_read_b32 v125, a109
  v_accvgpr_read_b32 v126, a110
  v_accvgpr_read_b32 v127, a111
  v_mul_f32 v112, s30, v96
  v_mul_f32 v113, s30, v97
  v_mul_f32 v114, s30, v98
  v_mul_f32 v115, s30, v99
  v_mul_f32 v116, s30, v100
  v_mul_f32 v117, s30, v101
  v_mul_f32 v118, s30, v102
  v_mul_f32 v119, s30, v103
  v_mul_f32 v136, s30, v120
  v_mul_f32 v137, s30, v121
  v_mul_f32 v138, s30, v122
  v_mul_f32 v139, s30, v123
  v_mul_f32 v140, s30, v124
  v_mul_f32 v141, s30, v125
  v_mul_f32 v142, s30, v126
  v_mul_f32 v143, s30, v127
  v_exp_f32 v112, v112
  s_add_u32 s27, s29, 591872
  v_exp_f32 v113, v113
  v_exp_f32 v114, v114
  v_exp_f32 v115, v115
  v_exp_f32 v116, v116
  v_exp_f32 v117, v117
  v_exp_f32 v118, v118
  v_exp_f32 v119, v119
  v_exp_f32 v136, v136
  v_exp_f32 v137, v137
  v_exp_f32 v138, v138
  v_exp_f32 v139, v139
  v_exp_f32 v140, v140
  v_exp_f32 v141, v141
  v_exp_f32 v142, v142
  v_exp_f32 v143, v143
  v_add_f32 v112, 1.0, v112
  v_add_f32 v113, 1.0, v113
  v_add_f32 v114, 1.0, v114
  v_add_f32 v115, 1.0, v115
  v_add_f32 v116, 1.0, v116
  v_add_f32 v117, 1.0, v117
  v_add_f32 v118, 1.0, v118
  v_add_f32 v119, 1.0, v119
  v_add_f32 v136, 1.0, v136
  v_add_f32 v137, 1.0, v137
  v_add_f32 v138, 1.0, v138
  v_add_f32 v139, 1.0, v139
  v_add_f32 v140, 1.0, v140
  v_add_f32 v141, 1.0, v141
  v_add_f32 v142, 1.0, v142
  v_add_f32 v143, 1.0, v143
  v_rcp_f32 v112, v112
  v_rcp_f32 v113, v113
  v_rcp_f32 v114, v114
  v_rcp_f32 v115, v115
  v_rcp_f32 v116, v116
  v_rcp_f32 v117, v117
  v_rcp_f32 v118, v118
  v_rcp_f32 v119, v119
  v_rcp_f32 v136, v136
  v_rcp_f32 v137, v137
  v_rcp_f32 v138, v138
  v_rcp_f32 v139, v139
  v_rcp_f32 v140, v140
  v_rcp_f32 v141, v141
  v_rcp_f32 v142, v142
  v_rcp_f32 v143, v143
  v_accvgpr_read_b32 v104, a224
  v_accvgpr_read_b32 v105, a225
  v_accvgpr_read_b32 v106, a226
  v_accvgpr_read_b32 v107, a227
  v_accvgpr_read_b32 v108, a232
  v_accvgpr_read_b32 v109, a233
  v_accvgpr_read_b32 v110, a234
  v_accvgpr_read_b32 v111, a235
  v_accvgpr_read_b32 v128, a228
  v_accvgpr_read_b32 v129, a229
  v_accvgpr_read_b32 v130, a230
  v_accvgpr_read_b32 v131, a231
  v_accvgpr_read_b32 v132, a236
  v_accvgpr_read_b32 v133, a237
  v_accvgpr_read_b32 v134, a238
  v_accvgpr_read_b32 v135, a239
  v_mul_f32 v96, v96, v104
  v_mul_f32 v97, v97, v105
  v_mul_f32 v98, v98, v106
  v_mul_f32 v99, v99, v107
  v_mul_f32 v100, v100, v108
  v_mul_f32 v101, v101, v109
  v_mul_f32 v102, v102, v110
  v_mul_f32 v103, v103, v111
  v_mul_f32 v120, v120, v128
  v_mul_f32 v121, v121, v129
  v_mul_f32 v122, v122, v130
  v_mul_f32 v123, v123, v131
  v_mul_f32 v124, v124, v132
  v_mul_f32 v125, v125, v133
  v_mul_f32 v126, v126, v134
  v_mul_f32 v127, v127, v135
  v_mul_f32 v96, v96, v112
  v_mul_f32 v97, v97, v113
  v_mul_f32 v98, v98, v114
  v_mul_f32 v99, v99, v115
  v_mul_f32 v100, v100, v116
  v_mul_f32 v101, v101, v117
  v_mul_f32 v102, v102, v118
  v_mul_f32 v103, v103, v119
  v_mul_f32 v120, v120, v136
  v_mul_f32 v121, v121, v137
  v_mul_f32 v122, v122, v138
  v_mul_f32 v123, v123, v139
  v_mul_f32 v124, v124, v140
  v_mul_f32 v125, v125, v141
  v_mul_f32 v126, v126, v142
  v_mul_f32 v127, v127, v143
  v_cvt_pk_bf16_f32 v104, v96, v97
  v_cvt_pk_bf16_f32 v105, v98, v99
  v_cvt_pk_bf16_f32 v106, v100, v101
  v_cvt_pk_bf16_f32 v107, v102, v103
  v_cvt_pk_bf16_f32 v128, v120, v121
  v_cvt_pk_bf16_f32 v129, v122, v123
  v_cvt_pk_bf16_f32 v130, v124, v125
  v_cvt_pk_bf16_f32 v131, v126, v127
  buffer_store_dwordx4 v[104:107], v91, s[16:19], s27 offen offset:0 sc1
  buffer_store_dwordx4 v[128:131], v91, s[16:19], s27 offen offset:1024 sc1
  v_accvgpr_read_b32 v96, a48
  v_accvgpr_read_b32 v97, a49
  v_accvgpr_read_b32 v98, a50
  v_accvgpr_read_b32 v99, a51
  v_accvgpr_read_b32 v100, a56
  v_accvgpr_read_b32 v101, a57
  v_accvgpr_read_b32 v102, a58
  v_accvgpr_read_b32 v103, a59
  v_accvgpr_read_b32 v120, a52
  v_accvgpr_read_b32 v121, a53
  v_accvgpr_read_b32 v122, a54
  v_accvgpr_read_b32 v123, a55
  v_accvgpr_read_b32 v124, a60
  v_accvgpr_read_b32 v125, a61
  v_accvgpr_read_b32 v126, a62
  v_accvgpr_read_b32 v127, a63
  v_mul_f32 v112, s30, v96
  v_mul_f32 v113, s30, v97
  v_mul_f32 v114, s30, v98
  v_mul_f32 v115, s30, v99
  v_mul_f32 v116, s30, v100
  v_mul_f32 v117, s30, v101
  v_mul_f32 v118, s30, v102
  v_mul_f32 v119, s30, v103
  v_mul_f32 v136, s30, v120
  v_mul_f32 v137, s30, v121
  v_mul_f32 v138, s30, v122
  v_mul_f32 v139, s30, v123
  v_mul_f32 v140, s30, v124
  v_mul_f32 v141, s30, v125
  v_mul_f32 v142, s30, v126
  v_mul_f32 v143, s30, v127
  v_exp_f32 v112, v112
  s_add_u32 s27, s29, 884736
  v_exp_f32 v113, v113
  v_exp_f32 v114, v114
  v_exp_f32 v115, v115
  v_exp_f32 v116, v116
  v_exp_f32 v117, v117
  v_exp_f32 v118, v118
  v_exp_f32 v119, v119
  v_exp_f32 v136, v136
  v_exp_f32 v137, v137
  v_exp_f32 v138, v138
  v_exp_f32 v139, v139
  v_exp_f32 v140, v140
  v_exp_f32 v141, v141
  v_exp_f32 v142, v142
  v_exp_f32 v143, v143
  v_add_f32 v112, 1.0, v112
  v_add_f32 v113, 1.0, v113
  v_add_f32 v114, 1.0, v114
  v_add_f32 v115, 1.0, v115
  v_add_f32 v116, 1.0, v116
  v_add_f32 v117, 1.0, v117
  v_add_f32 v118, 1.0, v118
  v_add_f32 v119, 1.0, v119
  v_add_f32 v136, 1.0, v136
  v_add_f32 v137, 1.0, v137
  v_add_f32 v138, 1.0, v138
  v_add_f32 v139, 1.0, v139
  v_add_f32 v140, 1.0, v140
  v_add_f32 v141, 1.0, v141
  v_add_f32 v142, 1.0, v142
  v_add_f32 v143, 1.0, v143
  v_rcp_f32 v112, v112
  v_rcp_f32 v113, v113
  v_rcp_f32 v114, v114
  v_rcp_f32 v115, v115
  v_rcp_f32 v116, v116
  v_rcp_f32 v117, v117
  v_rcp_f32 v118, v118
  v_rcp_f32 v119, v119
  v_rcp_f32 v136, v136
  v_rcp_f32 v137, v137
  v_rcp_f32 v138, v138
  v_rcp_f32 v139, v139
  v_rcp_f32 v140, v140
  v_rcp_f32 v141, v141
  v_rcp_f32 v142, v142
  v_rcp_f32 v143, v143
  v_accvgpr_read_b32 v104, a176
  v_accvgpr_read_b32 v105, a177
  v_accvgpr_read_b32 v106, a178
  v_accvgpr_read_b32 v107, a179
  v_accvgpr_read_b32 v108, a184
  v_accvgpr_read_b32 v109, a185
  v_accvgpr_read_b32 v110, a186
  v_accvgpr_read_b32 v111, a187
  v_accvgpr_read_b32 v128, a180
  v_accvgpr_read_b32 v129, a181
  v_accvgpr_read_b32 v130, a182
  v_accvgpr_read_b32 v131, a183
  v_accvgpr_read_b32 v132, a188
  v_accvgpr_read_b32 v133, a189
  v_accvgpr_read_b32 v134, a190
  v_accvgpr_read_b32 v135, a191
  v_mul_f32 v96, v96, v104
  v_mul_f32 v97, v97, v105
  v_mul_f32 v98, v98, v106
  v_mul_f32 v99, v99, v107
  v_mul_f32 v100, v100, v108
  v_mul_f32 v101, v101, v109
  v_mul_f32 v102, v102, v110
  v_mul_f32 v103, v103, v111
  v_mul_f32 v120, v120, v128
  v_mul_f32 v121, v121, v129
  v_mul_f32 v122, v122, v130
  v_mul_f32 v123, v123, v131
  v_mul_f32 v124, v124, v132
  v_mul_f32 v125, v125, v133
  v_mul_f32 v126, v126, v134
  v_mul_f32 v127, v127, v135
  v_mul_f32 v96, v96, v112
  v_mul_f32 v97, v97, v113
  v_mul_f32 v98, v98, v114
  v_mul_f32 v99, v99, v115
  v_mul_f32 v100, v100, v116
  v_mul_f32 v101, v101, v117
  v_mul_f32 v102, v102, v118
  v_mul_f32 v103, v103, v119
  v_mul_f32 v120, v120, v136
  v_mul_f32 v121, v121, v137
  v_mul_f32 v122, v122, v138
  v_mul_f32 v123, v123, v139
  v_mul_f32 v124, v124, v140
  v_mul_f32 v125, v125, v141
  v_mul_f32 v126, v126, v142
  v_mul_f32 v127, v127, v143
  v_cvt_pk_bf16_f32 v104, v96, v97
  v_cvt_pk_bf16_f32 v105, v98, v99
  v_cvt_pk_bf16_f32 v106, v100, v101
  v_cvt_pk_bf16_f32 v107, v102, v103
  v_cvt_pk_bf16_f32 v128, v120, v121
  v_cvt_pk_bf16_f32 v129, v122, v123
  v_cvt_pk_bf16_f32 v130, v124, v125
  v_cvt_pk_bf16_f32 v131, v126, v127
  buffer_store_dwordx4 v[104:107], v91, s[16:19], s27 offen offset:0 sc1
  buffer_store_dwordx4 v[128:131], v91, s[16:19], s27 offen offset:1024 sc1
  v_accvgpr_read_b32 v96, a112
  v_accvgpr_read_b32 v97, a113
  v_accvgpr_read_b32 v98, a114
  v_accvgpr_read_b32 v99, a115
  v_accvgpr_read_b32 v100, a120
  v_accvgpr_read_b32 v101, a121
  v_accvgpr_read_b32 v102, a122
  v_accvgpr_read_b32 v103, a123
  v_accvgpr_read_b32 v120, a116
  v_accvgpr_read_b32 v121, a117
  v_accvgpr_read_b32 v122, a118
  v_accvgpr_read_b32 v123, a119
  v_accvgpr_read_b32 v124, a124
  v_accvgpr_read_b32 v125, a125
  v_accvgpr_read_b32 v126, a126
  v_accvgpr_read_b32 v127, a127
  v_mul_f32 v112, s30, v96
  v_mul_f32 v113, s30, v97
  v_mul_f32 v114, s30, v98
  v_mul_f32 v115, s30, v99
  v_mul_f32 v116, s30, v100
  v_mul_f32 v117, s30, v101
  v_mul_f32 v118, s30, v102
  v_mul_f32 v119, s30, v103
  v_mul_f32 v136, s30, v120
  v_mul_f32 v137, s30, v121
  v_mul_f32 v138, s30, v122
  v_mul_f32 v139, s30, v123
  v_mul_f32 v140, s30, v124
  v_mul_f32 v141, s30, v125
  v_mul_f32 v142, s30, v126
  v_mul_f32 v143, s30, v127
  v_exp_f32 v112, v112
  s_add_u32 s27, s29, 886784
  v_exp_f32 v113, v113
  v_exp_f32 v114, v114
  v_exp_f32 v115, v115
  v_exp_f32 v116, v116
  v_exp_f32 v117, v117
  v_exp_f32 v118, v118
  v_exp_f32 v119, v119
  v_exp_f32 v136, v136
  v_exp_f32 v137, v137
  v_exp_f32 v138, v138
  v_exp_f32 v139, v139
  v_exp_f32 v140, v140
  v_exp_f32 v141, v141
  v_exp_f32 v142, v142
  v_exp_f32 v143, v143
  v_add_f32 v112, 1.0, v112
  v_add_f32 v113, 1.0, v113
  v_add_f32 v114, 1.0, v114
  v_add_f32 v115, 1.0, v115
  v_add_f32 v116, 1.0, v116
  v_add_f32 v117, 1.0, v117
  v_add_f32 v118, 1.0, v118
  v_add_f32 v119, 1.0, v119
  v_add_f32 v136, 1.0, v136
  v_add_f32 v137, 1.0, v137
  v_add_f32 v138, 1.0, v138
  v_add_f32 v139, 1.0, v139
  v_add_f32 v140, 1.0, v140
  v_add_f32 v141, 1.0, v141
  v_add_f32 v142, 1.0, v142
  v_add_f32 v143, 1.0, v143
  v_rcp_f32 v112, v112
  v_rcp_f32 v113, v113
  v_rcp_f32 v114, v114
  v_rcp_f32 v115, v115
  v_rcp_f32 v116, v116
  v_rcp_f32 v117, v117
  v_rcp_f32 v118, v118
  v_rcp_f32 v119, v119
  v_rcp_f32 v136, v136
  v_rcp_f32 v137, v137
  v_rcp_f32 v138, v138
  v_rcp_f32 v139, v139
  v_rcp_f32 v140, v140
  v_rcp_f32 v141, v141
  v_rcp_f32 v142, v142
  v_rcp_f32 v143, v143
  v_accvgpr_read_b32 v104, a240
  v_accvgpr_read_b32 v105, a241
  v_accvgpr_read_b32 v106, a242
  v_accvgpr_read_b32 v107, a243
  v_accvgpr_read_b32 v108, a248
  v_accvgpr_read_b32 v109, a249
  v_accvgpr_read_b32 v110, a250
  v_accvgpr_read_b32 v111, a251
  v_accvgpr_read_b32 v128, a244
  v_accvgpr_read_b32 v129, a245
  v_accvgpr_read_b32 v130, a246
  v_accvgpr_read_b32 v131, a247
  v_accvgpr_read_b32 v132, a252
  v_accvgpr_read_b32 v133, a253
  v_accvgpr_read_b32 v134, a254
  v_accvgpr_read_b32 v135, a255
  v_mul_f32 v96, v96, v104
  v_mul_f32 v97, v97, v105
  v_mul_f32 v98, v98, v106
  v_mul_f32 v99, v99, v107
  v_mul_f32 v100, v100, v108
  v_mul_f32 v101, v101, v109
  v_mul_f32 v102, v102, v110
  v_mul_f32 v103, v103, v111
  v_mul_f32 v120, v120, v128
  v_mul_f32 v121, v121, v129
  v_mul_f32 v122, v122, v130
  v_mul_f32 v123, v123, v131
  v_mul_f32 v124, v124, v132
  v_mul_f32 v125, v125, v133
  v_mul_f32 v126, v126, v134
  v_mul_f32 v127, v127, v135
  v_mul_f32 v96, v96, v112
  v_mul_f32 v97, v97, v113
  v_mul_f32 v98, v98, v114
  v_mul_f32 v99, v99, v115
  v_mul_f32 v100, v100, v116
  v_mul_f32 v101, v101, v117
  v_mul_f32 v102, v102, v118
  v_mul_f32 v103, v103, v119
  v_mul_f32 v120, v120, v136
  v_mul_f32 v121, v121, v137
  v_mul_f32 v122, v122, v138
  v_mul_f32 v123, v123, v139
  v_mul_f32 v124, v124, v140
  v_mul_f32 v125, v125, v141
  v_mul_f32 v126, v126, v142
  v_mul_f32 v127, v127, v143
  v_cvt_pk_bf16_f32 v104, v96, v97
  v_cvt_pk_bf16_f32 v105, v98, v99
  v_cvt_pk_bf16_f32 v106, v100, v101
  v_cvt_pk_bf16_f32 v107, v102, v103
  v_cvt_pk_bf16_f32 v128, v120, v121
  v_cvt_pk_bf16_f32 v129, v122, v123
  v_cvt_pk_bf16_f32 v130, v124, v125
  v_cvt_pk_bf16_f32 v131, v126, v127
  buffer_store_dwordx4 v[104:107], v91, s[16:19], s27 offen offset:0 sc1
  buffer_store_dwordx4 v[128:131], v91, s[16:19], s27 offen offset:1024 sc1
  s_branch L_j_donew
L_j_vw:
  s_mov_b32 s32, 0
  s_add_u32 m0, s24, s32
  s_mov_b32 s27, s20
  buffer_load_dwordx4 v88, s[8:11], s27 offen lds
  s_add_u32 m0, m0, 1024
  s_add_u32 s27, s27, 9216
  buffer_load_dwordx4 v89, s[8:11], s27 offen lds
  s_add_u32 m0, m0, 1024
  s_add_u32 s27, s27, 9216
  buffer_load_dwordx4 v88, s[8:11], s27 offen lds
  s_add_u32 m0, m0, 1024
  s_add_u32 s27, s27, 9216
  buffer_load_dwordx4 v89, s[8:11], s27 offen lds
  s_add_u32 m0, m0, 1024
  s_add_u32 s27, s27, 9216
  buffer_load_dwordx4 v88, s[8:11], s27 offen lds
  s_add_u32 m0, m0, 1024
  s_add_u32 s27, s27, 9216
  buffer_load_dwordx4 v89, s[8:11], s27 offen lds
  s_add_u32 m0, m0, 1024
  s_add_u32 s27, s27, 9216
  buffer_load_dwordx4 v88, s[8:11], s27 offen lds
  s_add_u32 m0, m0, 1024
  s_add_u32 s27, s27, 9216
  buffer_load_dwordx4 v89, s[8:11], s27 offen lds
  s_add_u32 m0, s25, s32
  s_mov_b32 s27, s21
  buffer_load_dwordx4 v90, s[12:15], s27 offen lds
  s_add_u32 m0, m0, 1024
  s_add_u32 s27, s27, s22
  buffer_load_dwordx4 v90, s[12:15], s27 offen lds
  s_add_u32 m0, m0, 1024
  s_add_u32 s27, s27, s22
  buffer_load_dwordx4 v90, s[12:15], s27 offen lds
  s_add_u32 m0, m0, 1024
  s_add_u32 s27, s27, s22
  buffer_load_dwordx4 v90, s[12:15], s27 offen lds
  s_add_u32 m0, m0, 1024
  s_add_u32 s27, s27, s22
  buffer_load_dwordx4 v90, s[12:15], s27 offen lds
  s_add_u32 m0, m0, 1024
  s_add_u32 s27, s27, s22
  buffer_load_dwordx4 v90, s[12:15], s27 offen lds
  s_add_u32 m0, m0, 1024
  s_add_u32 s27, s27, s22
  buffer_load_dwordx4 v90, s[12:15], s27 offen lds
  s_add_u32 m0, m0, 1024
  s_add_u32 s27, s27, s22
  buffer_load_dwordx4 v90, s[12:15], s27 offen lds
  s_add_u32 s20, s20, 128
  s_add_u32 s21, s21, s23
  s_xor_b32 s32, s32, 0x10000
  s_add_u32 m0, s24, s32
  s_mov_b32 s27, s20
  buffer_load_dwordx4 v88, s[8:11], s27 offen lds
  s_add_u32 m0, m0, 1024
  s_add_u32 s27, s27, 9216
  buffer_load_dwordx4 v89, s[8:11], s27 offen lds
  s_add_u32 m0, m0, 1024
  s_add_u32 s27, s27, 9216
  buffer_load_dwordx4 v88, s[8:11], s27 offen lds
  s_add_u32 m0, m0, 1024
  s_add_u32 s27, s27, 9216
  buffer_load_dwordx4 v89, s[8:11], s27 offen lds
  s_add_u32 m0, m0, 1024
  s_add_u32 s27, s27, 9216
  buffer_load_dwordx4 v88, s[8:11], s27 offen lds
  s_add_u32 m0, m0, 1024
  s_add_u32 s27, s27, 9216
  buffer_load_dwordx4 v89, s[8:11], s27 offen lds
  s_add_u32 m0, m0, 1024
  s_add_u32 s27, s27, 9216
  buffer_load_dwordx4 v88, s[8:11], s27 offen lds
  s_add_u32 m0, m0, 1024
  s_add_u32 s27, s27, 9216
  buffer_load_dwordx4 v89, s[8:11], s27 offen lds
  s_add_u32 m0, s25, s32
  s_mov_b32 s27, s21
  buffer_load_dwordx4 v90, s[12:15], s27 offen lds
  s_add_u32 m0, m0, 1024
  s_add_u32 s27, s27, s22
  buffer_load_dwordx4 v90, s[12:15], s27 offen lds
  s_add_u32 m0, m0, 1024
  s_add_u32 s27, s27, s22
  buffer_load_dwordx4 v90, s[12:15], s27 offen lds
  s_add_u32 m0, m0, 1024
  s_add_u32 s27, s27, s22
  buffer_load_dwordx4 v90, s[12:15], s27 offen lds
  s_add_u32 m0, m0, 1024
  s_add_u32 s27, s27, s22
  buffer_load_dwordx4 v90, s[12:15], s27 offen lds
  s_add_u32 m0, m0, 1024
  s_add_u32 s27, s27, s22
  buffer_load_dwordx4 v90, s[12:15], s27 offen lds
  s_add_u32 m0, m0, 1024
  s_add_u32 s27, s27, s22
  buffer_load_dwordx4 v90, s[12:15], s27 offen lds
  s_add_u32 m0, m0, 1024
  s_add_u32 s27, s27, s22
  buffer_load_dwordx4 v90, s[12:15], s27 offen lds
  s_add_u32 s20, s20, 128
  s_add_u32 s21, s21, s23
  s_xor_b32 s32, s32, 0x10000
  s_waitcnt vmcnt(16)
  s_barrier
  ds_read_b128 v[16:19], v80 offset:0
  ds_read_b128 v[20:23], v80 offset:4096
  ds_read_b128 v[24:27], v80 offset:8192
  ds_read_b128 v[28:31], v80 offset:12288
  ds_read_b64_tr_b16 v[48:49], v84 offset:0
  ds_read_b64_tr_b16 v[50:51], v84 offset:1024
  ds_read_b64_tr_b16 v[52:53], v85 offset:0
  ds_read_b64_tr_b16 v[54:55], v85 offset:1024
  ds_read_b64_tr_b16 v[56:57], v86 offset:0
  ds_read_b64_tr_b16 v[58:59], v86 offset:1024
  ds_read_b64_tr_b16 v[60:61], v87 offset:0
  ds_read_b64_tr_b16 v[62:63], v87 offset:1024
  ds_read_b128 v[32:35], v81 offset:0
  s_waitcnt lgkmcnt(7)
  v_mfma_f32_32x32x16_bf16 a[0:15], v[16:19], v[48:51], 0
  ds_read_b128 v[36:39], v81 offset:4096
  ds_read_b128 v[40:43], v81 offset:8192
  v_mfma_f32_32x32x16_bf16 a[16:31], v[20:23], v[48:51], 0
  ds_read_b128 v[44:47], v81 offset:12288
  ds_read_b64_tr_b16 v[64:65], v84 offset:4096
  v_mfma_f32_32x32x16_bf16 a[32:47], v[24:27], v[48:51], 0
  ds_read_b64_tr_b16 v[66:67], v84 offset:5120
  ds_read_b64_tr_b16 v[68:69], v85 offset:4096
  ds_read_b64_tr_b16 v[70:71], v85 offset:5120
  ds_read_b64_tr_b16 v[72:73], v86 offset:4096
  v_mfma_f32_32x32x16_bf16 a[48:63], v[28:31], v[48:51], 0
  ds_read_b64_tr_b16 v[74:75], v86 offset:5120
  ds_read_b64_tr_b16 v[76:77], v87 offset:4096
  ds_read_b64_tr_b16 v[78:79], v87 offset:5120
  ds_read_b64_tr_b16 v[48:49], v84 offset:8192
  s_waitcnt lgkmcnt(15)
  v_mfma_f32_32x32x16_bf16 a[64:79], v[16:19], v[52:55], 0
  ds_read_b64_tr_b16 v[50:51], v84 offset:9216
  v_mfma_f32_32x32x16_bf16 a[80:95], v[20:23], v[52:55], 0
  v_mfma_f32_32x32x16_bf16 a[96:111], v[24:27], v[52:55], 0
  v_mfma_f32_32x32x16_bf16 a[112:127], v[28:31], v[52:55], 0
  ds_read_b64_tr_b16 v[52:53], v85 offset:8192
  ds_read_b64_tr_b16 v[54:55], v85 offset:9216
  v_mfma_f32_32x32x16_bf16 a[128:143], v[16:19], v[56:59], 0
  v_mfma_f32_32x32x16_bf16 a[144:159], v[20:23], v[56:59], 0
  v_mfma_f32_32x32x16_bf16 a[160:175], v[24:27], v[56:59], 0
  v_mfma_f32_32x32x16_bf16 a[176:191], v[28:31], v[56:59], 0
  ds_read_b64_tr_b16 v[56:57], v86 offset:8192
  ds_read_b64_tr_b16 v[58:59], v86 offset:9216
  s_waitcnt lgkmcnt(15)
  v_mfma_f32_32x32x16_bf16 a[192:207], v[16:19], v[60:63], 0
  ds_read_b128 v[16:19], v82 offset:0
  v_mfma_f32_32x32x16_bf16 a[208:223], v[20:23], v[60:63], 0
  ds_read_b128 v[20:23], v82 offset:4096
  v_mfma_f32_32x32x16_bf16 a[224:239], v[24:27], v[60:63], 0
  ds_read_b128 v[24:27], v82 offset:8192
  v_mfma_f32_32x32x16_bf16 a[240:255], v[28:31], v[60:63], 0
  ds_read_b128 v[28:31], v82 offset:12288
  ds_read_b64_tr_b16 v[60:61], v87 offset:8192
  ds_read_b64_tr_b16 v[62:63], v87 offset:9216
  s_waitcnt lgkmcnt(15)
  v_mfma_f32_32x32x16_bf16 a[0:15], v[32:35], v[64:67], a[0:15]
  v_mfma_f32_32x32x16_bf16 a[16:31], v[36:39], v[64:67], a[16:31]
  v_mfma_f32_32x32x16_bf16 a[32:47], v[40:43], v[64:67], a[32:47]
  v_mfma_f32_32x32x16_bf16 a[48:63], v[44:47], v[64:67], a[48:63]
  ds_read_b64_tr_b16 v[64:65], v84 offset:12288
  ds_read_b64_tr_b16 v[66:67], v84 offset:13312
  v_mfma_f32_32x32x16_bf16 a[64:79], v[32:35], v[68:71], a[64:79]
  v_mfma_f32_32x32x16_bf16 a[80:95], v[36:39], v[68:71], a[80:95]
  v_mfma_f32_32x32x16_bf16 a[96:111], v[40:43], v[68:71], a[96:111]
  v_mfma_f32_32x32x16_bf16 a[112:127], v[44:47], v[68:71], a[112:127]
  ds_read_b64_tr_b16 v[68:69], v85 offset:12288
  ds_read_b64_tr_b16 v[70:71], v85 offset:13312
  s_waitcnt lgkmcnt(15)
  v_mfma_f32_32x32x16_bf16 a[128:143], v[32:35], v[72:75], a[128:143]
  v_mfma_f32_32x32x16_bf16 a[144:159], v[36:39], v[72:75], a[144:159]
  v_mfma_f32_32x32x16_bf16 a[160:175], v[40:43], v[72:75], a[160:175]
  v_mfma_f32_32x32x16_bf16 a[176:191], v[44:47], v[72:75], a[176:191]
  ds_read_b64_tr_b16 v[72:73], v86 offset:12288
  ds_read_b64_tr_b16 v[74:75], v86 offset:13312
  v_mfma_f32_32x32x16_bf16 a[192:207], v[32:35], v[76:79], a[192:207]
  ds_read_b128 v[32:35], v83 offset:0
  v_mfma_f32_32x32x16_bf16 a[208:223], v[36:39], v[76:79], a[208:223]
  ds_read_b128 v[36:39], v83 offset:4096
  v_mfma_f32_32x32x16_bf16 a[224:239], v[40:43], v[76:79], a[224:239]
  ds_read_b128 v[40:43], v83 offset:8192
  v_mfma_f32_32x32x16_bf16 a[240:255], v[44:47], v[76:79], a[240:255]
  ds_read_b128 v[44:47], v83 offset:12288
  ds_read_b64_tr_b16 v[76:77], v87 offset:12288
  ds_read_b64_tr_b16 v[78:79], v87 offset:13312
  s_waitcnt lgkmcnt(15)
  v_mfma_f32_32x32x16_bf16 a[0:15], v[16:19], v[48:51], a[0:15]
  v_mfma_f32_32x32x16_bf16 a[16:31], v[20:23], v[48:51], a[16:31]
  v_mfma_f32_32x32x16_bf16 a[32:47], v[24:27], v[48:51], a[32:47]
  s_waitcnt lgkmcnt(14)
  v_mfma_f32_32x32x16_bf16 a[48:63], v[28:31], v[48:51], a[48:63]
  v_mfma_f32_32x32x16_bf16 a[64:79], v[16:19], v[52:55], a[64:79]
  v_mfma_f32_32x32x16_bf16 a[80:95], v[20:23], v[52:55], a[80:95]
  v_mfma_f32_32x32x16_bf16 a[96:111], v[24:27], v[52:55], a[96:111]
  v_mfma_f32_32x32x16_bf16 a[112:127], v[28:31], v[52:55], a[112:127]
  v_mfma_f32_32x32x16_bf16 a[128:143], v[16:19], v[56:59], a[128:143]
  v_mfma_f32_32x32x16_bf16 a[144:159], v[20:23], v[56:59], a[144:159]
  v_mfma_f32_32x32x16_bf16 a[160:175], v[24:27], v[56:59], a[160:175]
  v_mfma_f32_32x32x16_bf16 a[176:191], v[28:31], v[56:59], a[176:191]
  s_waitcnt lgkmcnt(12)
  v_mfma_f32_32x32x16_bf16 a[192:207], v[16:19], v[60:63], a[192:207]
  v_mfma_f32_32x32x16_bf16 a[208:223], v[20:23], v[60:63], a[208:223]
  v_mfma_f32_32x32x16_bf16 a[224:239], v[24:27], v[60:63], a[224:239]
  v_mfma_f32_32x32x16_bf16 a[240:255], v[28:31], v[60:63], a[240:255]
  s_mov_b32 s26, 7
L_kavw:
  s_waitcnt vmcnt(0) lgkmcnt(0)
  s_barrier
  v_xor_b32 v80, 0x10000, v80
  v_xor_b32 v84, 0x10000, v84
  v_xor_b32 v85, 0x10000, v85
  v_xor_b32 v86, 0x10000, v86
  v_xor_b32 v87, 0x10000, v87
  ds_read_b128 v[16:19], v80 offset:0
  v_mfma_f32_32x32x16_bf16 a[0:15], v[32:35], v[64:67], a[0:15]
  s_add_u32 m0, s24, s32
  v_xor_b32 v81, 0x10000, v81
  ds_read_b128 v[20:23], v80 offset:4096
  v_xor_b32 v82, 0x10000, v82
  s_mov_b32 s27, s20
  buffer_load_dwordx4 v88, s[8:11], s27 offen lds
  ds_read_b128 v[24:27], v80 offset:8192
  v_mfma_f32_32x32x16_bf16 a[16:31], v[36:39], v[64:67], a[16:31]
  s_add_u32 m0, m0, 1024
  s_add_u32 s27, s27, 9216
  ds_read_b128 v[28:31], v80 offset:12288
  buffer_load_dwordx4 v89, s[8:11], s27 offen lds
  ds_read_b64_tr_b16 v[48:49], v84 offset:0
  v_mfma_f32_32x32x16_bf16 a[32:47], v[40:43], v[64:67], a[32:47]
  ds_read_b64_tr_b16 v[50:51], v84 offset:1024
  s_add_u32 m0, m0, 1024
  ds_read_b64_tr_b16 v[52:53], v85 offset:0
  s_add_u32 s27, s27, 9216
  ds_read_b64_tr_b16 v[54:55], v85 offset:1024
  v_xor_b32 v83, 0x10000, v83
  ds_read_b64_tr_b16 v[56:57], v86 offset:0
  v_mfma_f32_32x32x16_bf16 a[48:63], v[44:47], v[64:67], a[48:63]
  ds_read_b64_tr_b16 v[58:59], v86 offset:1024
  buffer_load_dwordx4 v88, s[8:11], s27 offen lds
  ds_read_b64_tr_b16 v[60:61], v87 offset:0
  s_add_u32 m0, m0, 1024
  ds_read_b64_tr_b16 v[62:63], v87 offset:1024
  v_mfma_f32_32x32x16_bf16 a[64:79], v[32:35], v[68:71], a[64:79]
  ds_read_b64_tr_b16 v[64:65], v84 offset:4096
  s_add_u32 s27, s27, 9216
  ds_read_b64_tr_b16 v[66:67], v84 offset:5120
  v_mfma_f32_32x32x16_bf16 a[80:95], v[36:39], v[68:71], a[80:95]
  buffer_load_dwordx4 v89, s[8:11], s27 offen lds
  s_add_u32 m0, m0, 1024
  v_mfma_f32_32x32x16_bf16 a[96:111], v[40:43], v[68:71], a[96:111]
  s_add_u32 s27, s27, 9216
  v_mfma_f32_32x32x16_bf16 a[112:127], v[44:47], v[68:71], a[112:127]
  ds_read_b64_tr_b16 v[68:69], v85 offset:4096
  ds_read_b64_tr_b16 v[70:71], v85 offset:5120
  buffer_load_dwordx4 v88, s[8:11], s27 offen lds
  v_mfma_f32_32x32x16_bf16 a[128:143], v[32:35], v[72:75], a[128:143]
  s_add_u32 m0, m0, 1024
  s_add_u32 s27, s27, 9216
  v_mfma_f32_32x32x16_bf16 a[144:159], v[36:39], v[72:75], a[144:159]
  buffer_load_dwordx4 v89, s[8:11], s27 offen lds
  v_mfma_f32_32x32x16_bf16 a[160:175], v[40:43], v[72:75], a[160:175]
  s_add_u32 m0, m0, 1024
  s_add_u32 s27, s27, 9216
  v_mfma_f32_32x32x16_bf16 a[176:191], v[44:47], v[72:75], a[176:191]
  ds_read_b64_tr_b16 v[72:73], v86 offset:4096
  ds_read_b64_tr_b16 v[74:75], v86 offset:5120
  buffer_load_dwordx4 v88, s[8:11], s27 offen lds
  v_mfma_f32_32x32x16_bf16 a[192:207], v[32:35], v[76:79], a[192:207]
  ds_read_b128 v[32:35], v81 offset:0
  s_add_u32 m0, m0, 1024
  s_add_u32 s27, s27, 9216
  v_mfma_f32_32x32x16_bf16 a[208:223], v[36:39], v[76:79], a[208:223]
  ds_read_b128 v[36:39], v81 offset:4096
  buffer_load_dwordx4 v89, s[8:11], s27 offen lds
  v_mfma_f32_32x32x16_bf16 a[224:239], v[40:43], v[76:79], a[224:239]
  ds_read_b128 v[40:43], v81 offset:8192
  s_add_u32 m0, s25, s32
  s_mov_b32 s27, s21
  v_mfma_f32_32x32x16_bf16 a[240:255], v[44:47], v[76:79], a[240:255]
  ds_read_b128 v[44:47], v81 offset:12288
  ds_read_b64_tr_b16 v[76:77], v87 offset:4096
  buffer_load_dwordx4 v90, s[12:15], s27 offen lds
  ds_read_b64_tr_b16 v[78:79], v87 offset:5120
  s_waitcnt lgkmcnt(15)
  v_mfma_f32_32x32x16_bf16 a[0:15], v[16:19], v[48:51], a[0:15]
  s_add_u32 m0, m0, 1024
  s_add_u32 s27, s27, s22
  v_mfma_f32_32x32x16_bf16 a[16:31], v[20:23], v[48:51], a[16:31]
  buffer_load_dwordx4 v90, s[12:15], s27 offen lds
  v_mfma_f32_32x32x16_bf16 a[32:47], v[24:27], v[48:51], a[32:47]
  s_add_u32 m0, m0, 1024
  s_add_u32 s27, s27, s22
  v_mfma_f32_32x32x16_bf16 a[48:63], v[28:31], v[48:51], a[48:63]
  ds_read_b64_tr_b16 v[48:49], v84 offset:8192
  ds_read_b64_tr_b16 v[50:51], v84 offset:9216
  buffer_load_dwordx4 v90, s[12:15], s27 offen lds
  v_mfma_f32_32x32x16_bf16 a[64:79], v[16:19], v[52:55], a[64:79]
  s_add_u32 m0, m0, 1024
  s_add_u32 s27, s27, s22
  v_mfma_f32_32x32x16_bf16 a[80:95], v[20:23], v[52:55], a[80:95]
  buffer_load_dwordx4 v90, s[12:15], s27 offen lds
  v_mfma_f32_32x32x16_bf16 a[96:111], v[24:27], v[52:55], a[96:111]
  s_add_u32 m0, m0, 1024
  s_add_u32 s27, s27, s22
  v_mfma_f32_32x32x16_bf16 a[112:127], v[28:31], v[52:55], a[112:127]
  ds_read_b64_tr_b16 v[52:53], v85 offset:8192
  ds_read_b64_tr_b16 v[54:55], v85 offset:9216
  buffer_load_dwordx4 v90, s[12:15], s27 offen lds
  s_waitcnt lgkmcnt(15)
  v_mfma_f32_32x32x16_bf16 a[128:143], v[16:19], v[56:59], a[128:143]
  s_add_u32 m0, m0, 1024
  s_add_u32 s27, s27, s22
  v_mfma_f32_32x32x16_bf16 a[144:159], v[20:23], v[56:59], a[144:159]
  buffer_load_dwordx4 v90, s[12:15], s27 offen lds
  v_mfma_f32_32x32x16_bf16 a[160:175], v[24:27], v[56:59], a[160:175]
  s_add_u32 m0, m0, 1024
  s_add_u32 s27, s27, s22
  v_mfma_f32_32x32x16_bf16 a[176:191], v[28:31], v[56:59], a[176:191]
  ds_read_b64_tr_b16 v[56:57], v86 offset:8192
  ds_read_b64_tr_b16 v[58:59], v86 offset:9216
  buffer_load_dwordx4 v90, s[12:15], s27 offen lds
  v_mfma_f32_32x32x16_bf16 a[192:207], v[16:19], v[60:63], a[192:207]
  ds_read_b128 v[16:19], v82 offset:0
  s_add_u32 m0, m0, 1024
  s_add_u32 s27, s27, s22
  s_add_u32 s20, s20, 128
  s_add_u32 s21, s21, s23
  s_xor_b32 s32, s32, 0x10000
  v_mfma_f32_32x32x16_bf16 a[208:223], v[20:23], v[60:63], a[208:223]
  ds_read_b128 v[20:23], v82 offset:4096
  buffer_load_dwordx4 v90, s[12:15], s27 offen lds
  v_mfma_f32_32x32x16_bf16 a[224:239], v[24:27], v[60:63], a[224:239]
  ds_read_b128 v[24:27], v82 offset:8192
  v_mfma_f32_32x32x16_bf16 a[240:255], v[28:31], v[60:63], a[240:255]
  ds_read_b128 v[28:31], v82 offset:12288
  ds_read_b64_tr_b16 v[60:61], v87 offset:8192
  ds_read_b64_tr_b16 v[62:63], v87 offset:9216
  s_waitcnt lgkmcnt(15)
  v_mfma_f32_32x32x16_bf16 a[0:15], v[32:35], v[64:67], a[0:15]
  v_mfma_f32_32x32x16_bf16 a[16:31], v[36:39], v[64:67], a[16:31]
  v_mfma_f32_32x32x16_bf16 a[32:47], v[40:43], v[64:67], a[32:47]
  s_waitcnt lgkmcnt(14)
  v_mfma_f32_32x32x16_bf16 a[48:63], v[44:47], v[64:67], a[48:63]
  ds_read_b64_tr_b16 v[64:65], v84 offset:12288
  ds_read_b64_tr_b16 v[66:67], v84 offset:13312
  v_mfma_f32_32x32x16_bf16 a[64:79], v[32:35], v[68:71], a[64:79]
  v_mfma_f32_32x32x16_bf16 a[80:95], v[36:39], v[68:71], a[80:95]
  v_mfma_f32_32x32x16_bf16 a[96:111], v[40:43], v[68:71], a[96:111]
  v_mfma_f32_32x32x16_bf16 a[112:127], v[44:47], v[68:71], a[112:127]
  ds_read_b64_tr_b16 v[68:69], v85 offset:12288
  ds_read_b64_tr_b16 v[70:71], v85 offset:13312
  v_mfma_f32_32x32x16_bf16 a[128:143], v[32:35], v[72:75], a[128:143]
  v_mfma_f32_32x32x16_bf16 a[144:159], v[36:39], v[72:75], a[144:159]
  v_mfma_f32_32x32x16_bf16 a[160:175], v[40:43], v[72:75], a[160:175]
  v_mfma_f32_32x32x16_bf16 a[176:191], v[44:47], v[72:75], a[176:191]
  ds_read_b64_tr_b16 v[72:73], v86 offset:12288
  ds_read_b64_tr_b16 v[74:75], v86 offset:13312
  s_waitcnt lgkmcnt(15)
  v_mfma_f32_32x32x16_bf16 a[192:207], v[32:35], v[76:79], a[192:207]
  ds_read_b128 v[32:35], v83 offset:0
  v_mfma_f32_32x32x16_bf16 a[208:223], v[36:39], v[76:79], a[208:223]
  ds_read_b128 v[36:39], v83 offset:4096
  v_mfma_f32_32x32x16_bf16 a[224:239], v[40:43], v[76:79], a[224:239]
  ds_read_b128 v[40:43], v83 offset:8192
  v_mfma_f32_32x32x16_bf16 a[240:255], v[44:47], v[76:79], a[240:255]
  ds_read_b128 v[44:47], v83 offset:12288
  ds_read_b64_tr_b16 v[76:77], v87 offset:12288
  ds_read_b64_tr_b16 v[78:79], v87 offset:13312
  s_waitcnt lgkmcnt(15)
  v_mfma_f32_32x32x16_bf16 a[0:15], v[16:19], v[48:51], a[0:15]
  v_mfma_f32_32x32x16_bf16 a[16:31], v[20:23], v[48:51], a[16:31]
  v_mfma_f32_32x32x16_bf16 a[32:47], v[24:27], v[48:51], a[32:47]
  s_waitcnt lgkmcnt(14)
  v_mfma_f32_32x32x16_bf16 a[48:63], v[28:31], v[48:51], a[48:63]
  v_mfma_f32_32x32x16_bf16 a[64:79], v[16:19], v[52:55], a[64:79]
  v_mfma_f32_32x32x16_bf16 a[80:95], v[20:23], v[52:55], a[80:95]
  v_mfma_f32_32x32x16_bf16 a[96:111], v[24:27], v[52:55], a[96:111]
  v_mfma_f32_32x32x16_bf16 a[112:127], v[28:31], v[52:55], a[112:127]
  v_mfma_f32_32x32x16_bf16 a[128:143], v[16:19], v[56:59], a[128:143]
  v_mfma_f32_32x32x16_bf16 a[144:159], v[20:23], v[56:59], a[144:159]
  v_mfma_f32_32x32x16_bf16 a[160:175], v[24:27], v[56:59], a[160:175]
  v_mfma_f32_32x32x16_bf16 a[176:191], v[28:31], v[56:59], a[176:191]
  s_waitcnt lgkmcnt(12)
  v_mfma_f32_32x32x16_bf16 a[192:207], v[16:19], v[60:63], a[192:207]
  v_mfma_f32_32x32x16_bf16 a[208:223], v[20:23], v[60:63], a[208:223]
  v_mfma_f32_32x32x16_bf16 a[224:239], v[24:27], v[60:63], a[224:239]
  v_mfma_f32_32x32x16_bf16 a[240:255], v[28:31], v[60:63], a[240:255]
  s_sub_u32 s26, s26, 1
  s_cmp_lg_u32 s26, 0
  s_cbranch_scc1 L_kavw
  s_waitcnt vmcnt(0) lgkmcnt(0)
  s_barrier
  v_xor_b32 v80, 0x10000, v80
  v_xor_b32 v84, 0x10000, v84
  v_xor_b32 v85, 0x10000, v85
  v_xor_b32 v86, 0x10000, v86
  v_xor_b32 v87, 0x10000, v87
  ds_read_b128 v[16:19], v80 offset:0
  v_mfma_f32_32x32x16_bf16 a[0:15], v[32:35], v[64:67], a[0:15]
  v_xor_b32 v81, 0x10000, v81
  ds_read_b128 v[20:23], v80 offset:4096
  v_xor_b32 v82, 0x10000, v82
  v_xor_b32 v83, 0x10000, v83
  ds_read_b128 v[24:27], v80 offset:8192
  v_mfma_f32_32x32x16_bf16 a[16:31], v[36:39], v[64:67], a[16:31]
  ds_read_b128 v[28:31], v80 offset:12288
  ds_read_b64_tr_b16 v[48:49], v84 offset:0
  v_mfma_f32_32x32x16_bf16 a[32:47], v[40:43], v[64:67], a[32:47]
  ds_read_b64_tr_b16 v[50:51], v84 offset:1024
  ds_read_b64_tr_b16 v[52:53], v85 offset:0
  ds_read_b64_tr_b16 v[54:55], v85 offset:1024
  ds_read_b64_tr_b16 v[56:57], v86 offset:0
  v_mfma_f32_32x32x16_bf16 a[48:63], v[44:47], v[64:67], a[48:63]
  ds_read_b64_tr_b16 v[58:59], v86 offset:1024
  ds_read_b64_tr_b16 v[60:61], v87 offset:0
  ds_read_b64_tr_b16 v[62:63], v87 offset:1024
  ds_read_b64_tr_b16 v[64:65], v84 offset:4096
  v_mfma_f32_32x32x16_bf16 a[64:79], v[32:35], v[68:71], a[64:79]
  ds_read_b64_tr_b16 v[66:67], v84 offset:5120
  v_mfma_f32_32x32x16_bf16 a[80:95], v[36:39], v[68:71], a[80:95]
  v_mfma_f32_32x32x16_bf16 a[96:111], v[40:43], v[68:71], a[96:111]
  v_mfma_f32_32x32x16_bf16 a[112:127], v[44:47], v[68:71], a[112:127]
  ds_read_b64_tr_b16 v[68:69], v85 offset:4096
  ds_read_b64_tr_b16 v[70:71], v85 offset:5120
  v_mfma_f32_32x32x16_bf16 a[128:143], v[32:35], v[72:75], a[128:143]
  v_mfma_f32_32x32x16_bf16 a[144:159], v[36:39], v[72:75], a[144:159]
  v_mfma_f32_32x32x16_bf16 a[160:175], v[40:43], v[72:75], a[160:175]
  v_mfma_f32_32x32x16_bf16 a[176:191], v[44:47], v[72:75], a[176:191]
  ds_read_b64_tr_b16 v[72:73], v86 offset:4096
  ds_read_b64_tr_b16 v[74:75], v86 offset:5120
  v_mfma_f32_32x32x16_bf16 a[192:207], v[32:35], v[76:79], a[192:207]
  ds_read_b128 v[32:35], v81 offset:0
  v_mfma_f32_32x32x16_bf16 a[208:223], v[36:39], v[76:79], a[208:223]
  ds_read_b128 v[36:39], v81 offset:4096
  v_mfma_f32_32x32x16_bf16 a[224:239], v[40:43], v[76:79], a[224:239]
  ds_read_b128 v[40:43], v81 offset:8192
  v_mfma_f32_32x32x16_bf16 a[240:255], v[44:47], v[76:79], a[240:255]
  ds_read_b128 v[44:47], v81 offset:12288
  ds_read_b64_tr_b16 v[76:77], v87 offset:4096
  ds_read_b64_tr_b16 v[78:79], v87 offset:5120
  s_waitcnt lgkmcnt(15)
  v_mfma_f32_32x32x16_bf16 a[0:15], v[16:19], v[48:51], a[0:15]
  v_mfma_f32_32x32x16_bf16 a[16:31], v[20:23], v[48:51], a[16:31]
  v_mfma_f32_32x32x16_bf16 a[32:47], v[24:27], v[48:51], a[32:47]
  v_mfma_f32_32x32x16_bf16 a[48:63], v[28:31], v[48:51], a[48:63]
  ds_read_b64_tr_b16 v[48:49], v84 offset:8192
  ds_read_b64_tr_b16 v[50:51], v84 offset:9216
  v_mfma_f32_32x32x16_bf16 a[64:79], v[16:19], v[52:55], a[64:79]
  v_mfma_f32_32x32x16_bf16 a[80:95], v[20:23], v[52:55], a[80:95]
  v_mfma_f32_32x32x16_bf16 a[96:111], v[24:27], v[52:55], a[96:111]
  v_mfma_f32_32x32x16_bf16 a[112:127], v[28:31], v[52:55], a[112:127]
  ds_read_b64_tr_b16 v[52:53], v85 offset:8192
  ds_read_b64_tr_b16 v[54:55], v85 offset:9216
  s_waitcnt lgkmcnt(15)
  v_mfma_f32_32x32x16_bf16 a[128:143], v[16:19], v[56:59], a[128:143]
  v_mfma_f32_32x32x16_bf16 a[144:159], v[20:23], v[56:59], a[144:159]
  v_mfma_f32_32x32x16_bf16 a[160:175], v[24:27], v[56:59], a[160:175]
  v_mfma_f32_32x32x16_bf16 a[176:191], v[28:31], v[56:59], a[176:191]
  ds_read_b64_tr_b16 v[56:57], v86 offset:8192
  ds_read_b64_tr_b16 v[58:59], v86 offset:9216
  v_mfma_f32_32x32x16_bf16 a[192:207], v[16:19], v[60:63], a[192:207]
  ds_read_b128 v[16:19], v82 offset:0
  v_mfma_f32_32x32x16_bf16 a[208:223], v[20:23], v[60:63], a[208:223]
  ds_read_b128 v[20:23], v82 offset:4096
  v_mfma_f32_32x32x16_bf16 a[224:239], v[24:27], v[60:63], a[224:239]
  ds_read_b128 v[24:27], v82 offset:8192
  v_mfma_f32_32x32x16_bf16 a[240:255], v[28:31], v[60:63], a[240:255]
  ds_read_b128 v[28:31], v82 offset:12288
  ds_read_b64_tr_b16 v[60:61], v87 offset:8192
  ds_read_b64_tr_b16 v[62:63], v87 offset:9216
  s_waitcnt lgkmcnt(15)
  v_mfma_f32_32x32x16_bf16 a[0:15], v[32:35], v[64:67], a[0:15]
  v_mfma_f32_32x32x16_bf16 a[16:31], v[36:39], v[64:67], a[16:31]
  v_mfma_f32_32x32x16_bf16 a[32:47], v[40:43], v[64:67], a[32:47]
  s_waitcnt lgkmcnt(14)
  v_mfma_f32_32x32x16_bf16 a[48:63], v[44:47], v[64:67], a[48:63]
  ds_read_b64_tr_b16 v[64:65], v84 offset:12288
  ds_read_b64_tr_b16 v[66:67], v84 offset:13312
  v_mfma_f32_32x32x16_bf16 a[64:79], v[32:35], v[68:71], a[64:79]
  v_mfma_f32_32x32x16_bf16 a[80:95], v[36:39], v[68:71], a[80:95]
  v_mfma_f32_32x32x16_bf16 a[96:111], v[40:43], v[68:71], a[96:111]
  v_mfma_f32_32x32x16_bf16 a[112:127], v[44:47], v[68:71], a[112:127]
  ds_read_b64_tr_b16 v[68:69], v85 offset:12288
  ds_read_b64_tr_b16 v[70:71], v85 offset:13312
  v_mfma_f32_32x32x16_bf16 a[128:143], v[32:35], v[72:75], a[128:143]
  v_mfma_f32_32x32x16_bf16 a[144:159], v[36:39], v[72:75], a[144:159]
  v_mfma_f32_32x32x16_bf16 a[160:175], v[40:43], v[72:75], a[160:175]
  v_mfma_f32_32x32x16_bf16 a[176:191], v[44:47], v[72:75], a[176:191]
  ds_read_b64_tr_b16 v[72:73], v86 offset:12288
  ds_read_b64_tr_b16 v[74:75], v86 offset:13312
  s_waitcnt lgkmcnt(15)
  v_mfma_f32_32x32x16_bf16 a[192:207], v[32:35], v[76:79], a[192:207]
  ds_read_b128 v[32:35], v83 offset:0
  v_mfma_f32_32x32x16_bf16 a[208:223], v[36:39], v[76:79], a[208:223]
  ds_read_b128 v[36:39], v83 offset:4096
  v_mfma_f32_32x32x16_bf16 a[224:239], v[40:43], v[76:79], a[224:239]
  ds_read_b128 v[40:43], v83 offset:8192
  v_mfma_f32_32x32x16_bf16 a[240:255], v[44:47], v[76:79], a[240:255]
  ds_read_b128 v[44:47], v83 offset:12288
  ds_read_b64_tr_b16 v[76:77], v87 offset:12288
  ds_read_b64_tr_b16 v[78:79], v87 offset:13312
  s_waitcnt lgkmcnt(15)
  v_mfma_f32_32x32x16_bf16 a[0:15], v[16:19], v[48:51], a[0:15]
  v_mfma_f32_32x32x16_bf16 a[16:31], v[20:23], v[48:51], a[16:31]
  v_mfma_f32_32x32x16_bf16 a[32:47], v[24:27], v[48:51], a[32:47]
  s_waitcnt lgkmcnt(14)
  v_mfma_f32_32x32x16_bf16 a[48:63], v[28:31], v[48:51], a[48:63]
  v_mfma_f32_32x32x16_bf16 a[64:79], v[16:19], v[52:55], a[64:79]
  v_mfma_f32_32x32x16_bf16 a[80:95], v[20:23], v[52:55], a[80:95]
  v_mfma_f32_32x32x16_bf16 a[96:111], v[24:27], v[52:55], a[96:111]
  v_mfma_f32_32x32x16_bf16 a[112:127], v[28:31], v[52:55], a[112:127]
  v_mfma_f32_32x32x16_bf16 a[128:143], v[16:19], v[56:59], a[128:143]
  v_mfma_f32_32x32x16_bf16 a[144:159], v[20:23], v[56:59], a[144:159]
  v_mfma_f32_32x32x16_bf16 a[160:175], v[24:27], v[56:59], a[160:175]
  v_mfma_f32_32x32x16_bf16 a[176:191], v[28:31], v[56:59], a[176:191]
  s_waitcnt lgkmcnt(12)
  v_mfma_f32_32x32x16_bf16 a[192:207], v[16:19], v[60:63], a[192:207]
  v_mfma_f32_32x32x16_bf16 a[208:223], v[20:23], v[60:63], a[208:223]
  v_mfma_f32_32x32x16_bf16 a[224:239], v[24:27], v[60:63], a[224:239]
  v_mfma_f32_32x32x16_bf16 a[240:255], v[28:31], v[60:63], a[240:255]
  s_waitcnt lgkmcnt(5)
  v_mfma_f32_32x32x16_bf16 a[0:15], v[32:35], v[64:67], a[0:15]
  s_waitcnt lgkmcnt(4)
  v_mfma_f32_32x32x16_bf16 a[16:31], v[36:39], v[64:67], a[16:31]
  s_waitcnt lgkmcnt(3)
  v_mfma_f32_32x32x16_bf16 a[32:47], v[40:43], v[64:67], a[32:47]
  s_waitcnt lgkmcnt(2)
  v_mfma_f32_32x32x16_bf16 a[48:63], v[44:47], v[64:67], a[48:63]
  v_mfma_f32_32x32x16_bf16 a[64:79], v[32:35], v[68:71], a[64:79]
  v_mfma_f32_32x32x16_bf16 a[80:95], v[36:39], v[68:71], a[80:95]
  v_mfma_f32_32x32x16_bf16 a[96:111], v[40:43], v[68:71], a[96:111]
  v_mfma_f32_32x32x16_bf16 a[112:127], v[44:47], v[68:71], a[112:127]
  v_mfma_f32_32x32x16_bf16 a[128:143], v[32:35], v[72:75], a[128:143]
  v_mfma_f32_32x32x16_bf16 a[144:159], v[36:39], v[72:75], a[144:159]
  v_mfma_f32_32x32x16_bf16 a[160:175], v[40:43], v[72:75], a[160:175]
  v_mfma_f32_32x32x16_bf16 a[176:191], v[44:47], v[72:75], a[176:191]
  s_waitcnt lgkmcnt(0)
  v_mfma_f32_32x32x16_bf16 a[192:207], v[32:35], v[76:79], a[192:207]
  v_mfma_f32_32x32x16_bf16 a[208:223], v[36:39], v[76:79], a[208:223]
  v_mfma_f32_32x32x16_bf16 a[224:239], v[40:43], v[76:79], a[224:239]
  v_mfma_f32_32x32x16_bf16 a[240:255], v[44:47], v[76:79], a[240:255]
  s_lshr_b32 s27, s31, 1
  s_lshl_b32 s27, s27, 2
  s_lshl_b32 s28, s34, 3
  s_add_u32 s27, s27, s28
  s_mul_i32 s29, s27, 262144
  s_and_b32 s27, s31, 1
  s_lshl_b32 s28, s35, 1
  s_add_u32 s27, s27, s28
  s_lshl_b32 s27, s27, 13
  s_add_u32 s29, s29, s27
  s_add_u32 s29, s29, 17825792
  v_and_b32 v1, 63, v0
  v_lshrrev_b32 v2, 5, v1
  v_lshlrev_b32 v2, 8, v2
  v_and_b32 v3, 15, v1
  v_lshlrev_b32 v3, 4, v3
  v_bfe_u32 v4, v1, 4, 1
  v_mul_u32_u24 v4, 1024, v4
  v_add3_u32 v91, v2, v3, v4
  v_accvgpr_read_b32 v96, a0
  v_accvgpr_read_b32 v97, a1
  v_accvgpr_read_b32 v98, a2
  v_accvgpr_read_b32 v99, a3
  v_accvgpr_read_b32 v100, a8
  v_accvgpr_read_b32 v101, a9
  v_accvgpr_read_b32 v102, a10
  v_accvgpr_read_b32 v103, a11
  v_accvgpr_read_b32 v104, a4
  v_accvgpr_read_b32 v105, a5
  v_accvgpr_read_b32 v106, a6
  v_accvgpr_read_b32 v107, a7
  v_cvt_pk_bf16_f32 v96, v96, v97
  v_accvgpr_read_b32 v108, a12
  v_accvgpr_read_b32 v109, a13
  v_accvgpr_read_b32 v110, a14
  v_accvgpr_read_b32 v111, a15
  v_cvt_pk_bf16_f32 v97, v98, v99
  v_accvgpr_read_b32 v112, a64
  v_accvgpr_read_b32 v113, a65
  v_cvt_pk_bf16_f32 v98, v100, v101
  v_cvt_pk_bf16_f32 v99, v102, v103
  v_accvgpr_read_b32 v114, a66
  v_accvgpr_read_b32 v115, a67
  v_cvt_pk_bf16_f32 v104, v104, v105
  v_accvgpr_read_b32 v116, a72
  v_accvgpr_read_b32 v117, a73
  v_accvgpr_read_b32 v118, a74
  v_accvgpr_read_b32 v119, a75
  v_cvt_pk_bf16_f32 v105, v106, v107
  v_accvgpr_read_b32 v120, a68
  v_accvgpr_read_b32 v121, a69
  s_add_u32 s27, s29, 0
  v_cvt_pk_bf16_f32 v106, v108, v109
  v_cvt_pk_bf16_f32 v107, v110, v111
  v_accvgpr_read_b32 v122, a70
  v_accvgpr_read_b32 v123, a71
  v_cvt_pk_bf16_f32 v112, v112, v113
  v_accvgpr_read_b32 v124, a76
  v_accvgpr_read_b32 v125, a77
  v_accvgpr_read_b32 v126, a78
  v_accvgpr_read_b32 v127, a79
  buffer_store_dwordx4 v[96:99], v91, s[16:19], s27 offen offset:0 sc1
  v_cvt_pk_bf16_f32 v113, v114, v115
  v_cvt_pk_bf16_f32 v114, v116, v117
  v_cvt_pk_bf16_f32 v115, v118, v119
  v_accvgpr_read_b32 v96, a128
  v_accvgpr_read_b32 v97, a129
  v_cvt_pk_bf16_f32 v120, v120, v121
  v_accvgpr_read_b32 v98, a130
  v_accvgpr_read_b32 v99, a131
  buffer_store_dwordx4 v[104:107], v91, s[16:19], s27 offen offset:512 sc1
  v_cvt_pk_bf16_f32 v121, v122, v123
  v_accvgpr_read_b32 v100, a136
  v_accvgpr_read_b32 v101, a137
  v_accvgpr_read_b32 v102, a138
  v_accvgpr_read_b32 v103, a139
  v_cvt_pk_bf16_f32 v122, v124, v125
  v_cvt_pk_bf16_f32 v123, v126, v127
  v_accvgpr_read_b32 v104, a132
  v_accvgpr_read_b32 v105, a133
  v_accvgpr_read_b32 v106, a134
  v_accvgpr_read_b32 v107, a135
  buffer_store_dwordx4 v[112:115], v91, s[16:19], s27 offen offset:2048 sc1
  v_cvt_pk_bf16_f32 v96, v96, v97
  v_accvgpr_read_b32 v108, a140
  v_accvgpr_read_b32 v109, a141
  v_accvgpr_read_b32 v110, a142
  v_accvgpr_read_b32 v111, a143
  v_cvt_pk_bf16_f32 v97, v98, v99
  v_accvgpr_read_b32 v112, a192
  v_accvgpr_read_b32 v113, a193
  v_cvt_pk_bf16_f32 v98, v100, v101
  v_cvt_pk_bf16_f32 v99, v102, v103
  v_accvgpr_read_b32 v114, a194
  v_accvgpr_read_b32 v115, a195
  buffer_store_dwordx4 v[120:123], v91, s[16:19], s27 offen offset:2560 sc1
  v_cvt_pk_bf16_f32 v104, v104, v105
  v_accvgpr_read_b32 v116, a200
  v_accvgpr_read_b32 v117, a201
  v_accvgpr_read_b32 v118, a202
  v_accvgpr_read_b32 v119, a203
  v_cvt_pk_bf16_f32 v105, v106, v107
  v_accvgpr_read_b32 v120, a196
  v_accvgpr_read_b32 v121, a197
  s_add_u32 s28, s27, 4096
  v_cvt_pk_bf16_f32 v106, v108, v109
  v_cvt_pk_bf16_f32 v107, v110, v111
  v_accvgpr_read_b32 v122, a198
  v_accvgpr_read_b32 v123, a199
  v_cvt_pk_bf16_f32 v112, v112, v113
  v_accvgpr_read_b32 v124, a204
  v_accvgpr_read_b32 v125, a205
  v_accvgpr_read_b32 v126, a206
  v_accvgpr_read_b32 v127, a207
  buffer_store_dwordx4 v[96:99], v91, s[16:19], s28 offen offset:0 sc1
  v_cvt_pk_bf16_f32 v113, v114, v115
  s_add_u32 s28, s27, 4096
  v_cvt_pk_bf16_f32 v114, v116, v117
  v_cvt_pk_bf16_f32 v115, v118, v119
  v_cvt_pk_bf16_f32 v120, v120, v121
  buffer_store_dwordx4 v[104:107], v91, s[16:19], s28 offen offset:512 sc1
  v_cvt_pk_bf16_f32 v121, v122, v123
  s_add_u32 s28, s27, 4096
  v_cvt_pk_bf16_f32 v122, v124, v125
  v_cvt_pk_bf16_f32 v123, v126, v127
  buffer_store_dwordx4 v[112:115], v91, s[16:19], s28 offen offset:2048 sc1
  s_add_u32 s28, s27, 4096
  buffer_store_dwordx4 v[120:123], v91, s[16:19], s28 offen offset:2560 sc1
  v_accvgpr_read_b32 v96, a16
  v_accvgpr_read_b32 v97, a17
  v_accvgpr_read_b32 v98, a18
  v_accvgpr_read_b32 v99, a19
  v_accvgpr_read_b32 v100, a24
  v_accvgpr_read_b32 v101, a25
  v_accvgpr_read_b32 v102, a26
  v_accvgpr_read_b32 v103, a27
  v_accvgpr_read_b32 v104, a20
  v_accvgpr_read_b32 v105, a21
  v_accvgpr_read_b32 v106, a22
  v_accvgpr_read_b32 v107, a23
  v_cvt_pk_bf16_f32 v96, v96, v97
  v_accvgpr_read_b32 v108, a28
  v_accvgpr_read_b32 v109, a29
  v_accvgpr_read_b32 v110, a30
  v_accvgpr_read_b32 v111, a31
  v_cvt_pk_bf16_f32 v97, v98, v99
  v_accvgpr_read_b32 v112, a80
  v_accvgpr_read_b32 v113, a81
  v_cvt_pk_bf16_f32 v98, v100, v101
  v_cvt_pk_bf16_f32 v99, v102, v103
  v_accvgpr_read_b32 v114, a82
  v_accvgpr_read_b32 v115, a83
  v_cvt_pk_bf16_f32 v104, v104, v105
  v_accvgpr_read_b32 v116, a88
  v_accvgpr_read_b32 v117, a89
  v_accvgpr_read_b32 v118, a90
  v_accvgpr_read_b32 v119, a91
  v_cvt_pk_bf16_f32 v105, v106, v107
  v_accvgpr_read_b32 v120, a84
  v_accvgpr_read_b32 v121, a85
  s_add_u32 s27, s29, 262144
  v_cvt_pk_bf16_f32 v106, v108, v109
  v_cvt_pk_bf16_f32 v107, v110, v111
  v_accvgpr_read_b32 v122, a86
  v_accvgpr_read_b32 v123, a87
  v_cvt_pk_bf16_f32 v112, v112, v113
  v_accvgpr_read_b32 v124, a92
  v_accvgpr_read_b32 v125, a93
  v_accvgpr_read_b32 v126, a94
  v_accvgpr_read_b32 v127, a95
  buffer_store_dwordx4 v[96:99], v91, s[16:19], s27 offen offset:0 sc1
  v_cvt_pk_bf16_f32 v113, v114, v115
  v_cvt_pk_bf16_f32 v114, v116, v117
  v_cvt_pk_bf16_f32 v115, v118, v119
  v_accvgpr_read_b32 v96, a144
  v_accvgpr_read_b32 v97, a145
  v_cvt_pk_bf16_f32 v120, v120, v121
  v_accvgpr_read_b32 v98, a146
  v_accvgpr_read_b32 v99, a147
  buffer_store_dwordx4 v[104:107], v91, s[16:19], s27 offen offset:512 sc1
  v_cvt_pk_bf16_f32 v121, v122, v123
  v_accvgpr_read_b32 v100, a152
  v_accvgpr_read_b32 v101, a153
  v_accvgpr_read_b32 v102, a154
  v_accvgpr_read_b32 v103, a155
  v_cvt_pk_bf16_f32 v122, v124, v125
  v_cvt_pk_bf16_f32 v123, v126, v127
  v_accvgpr_read_b32 v104, a148
  v_accvgpr_read_b32 v105, a149
  v_accvgpr_read_b32 v106, a150
  v_accvgpr_read_b32 v107, a151
  buffer_store_dwordx4 v[112:115], v91, s[16:19], s27 offen offset:2048 sc1
  v_cvt_pk_bf16_f32 v96, v96, v97
  v_accvgpr_read_b32 v108, a156
  v_accvgpr_read_b32 v109, a157
  v_accvgpr_read_b32 v110, a158
  v_accvgpr_read_b32 v111, a159
  v_cvt_pk_bf16_f32 v97, v98, v99
  v_accvgpr_read_b32 v112, a208
  v_accvgpr_read_b32 v113, a209
  v_cvt_pk_bf16_f32 v98, v100, v101
  v_cvt_pk_bf16_f32 v99, v102, v103
  v_accvgpr_read_b32 v114, a210
  v_accvgpr_read_b32 v115, a211
  buffer_store_dwordx4 v[120:123], v91, s[16:19], s27 offen offset:2560 sc1
  v_cvt_pk_bf16_f32 v104, v104, v105
  v_accvgpr_read_b32 v116, a216
  v_accvgpr_read_b32 v117, a217
  v_accvgpr_read_b32 v118, a218
  v_accvgpr_read_b32 v119, a219
  v_cvt_pk_bf16_f32 v105, v106, v107
  v_accvgpr_read_b32 v120, a212
  v_accvgpr_read_b32 v121, a213
  s_add_u32 s28, s27, 4096
  v_cvt_pk_bf16_f32 v106, v108, v109
  v_cvt_pk_bf16_f32 v107, v110, v111
  v_accvgpr_read_b32 v122, a214
  v_accvgpr_read_b32 v123, a215
  v_cvt_pk_bf16_f32 v112, v112, v113
  v_accvgpr_read_b32 v124, a220
  v_accvgpr_read_b32 v125, a221
  v_accvgpr_read_b32 v126, a222
  v_accvgpr_read_b32 v127, a223
  buffer_store_dwordx4 v[96:99], v91, s[16:19], s28 offen offset:0 sc1
  v_cvt_pk_bf16_f32 v113, v114, v115
  s_add_u32 s28, s27, 4096
  v_cvt_pk_bf16_f32 v114, v116, v117
  v_cvt_pk_bf16_f32 v115, v118, v119
  v_cvt_pk_bf16_f32 v120, v120, v121
  buffer_store_dwordx4 v[104:107], v91, s[16:19], s28 offen offset:512 sc1
  v_cvt_pk_bf16_f32 v121, v122, v123
  s_add_u32 s28, s27, 4096
  v_cvt_pk_bf16_f32 v122, v124, v125
  v_cvt_pk_bf16_f32 v123, v126, v127
  buffer_store_dwordx4 v[112:115], v91, s[16:19], s28 offen offset:2048 sc1
  s_add_u32 s28, s27, 4096
  buffer_store_dwordx4 v[120:123], v91, s[16:19], s28 offen offset:2560 sc1
  v_accvgpr_read_b32 v96, a32
  v_accvgpr_read_b32 v97, a33
  v_accvgpr_read_b32 v98, a34
  v_accvgpr_read_b32 v99, a35
  v_accvgpr_read_b32 v100, a40
  v_accvgpr_read_b32 v101, a41
  v_accvgpr_read_b32 v102, a42
  v_accvgpr_read_b32 v103, a43
  v_accvgpr_read_b32 v104, a36
  v_accvgpr_read_b32 v105, a37
  v_accvgpr_read_b32 v106, a38
  v_accvgpr_read_b32 v107, a39
  v_cvt_pk_bf16_f32 v96, v96, v97
  v_accvgpr_read_b32 v108, a44
  v_accvgpr_read_b32 v109, a45
  v_accvgpr_read_b32 v110, a46
  v_accvgpr_read_b32 v111, a47
  v_cvt_pk_bf16_f32 v97, v98, v99
  v_accvgpr_read_b32 v112, a96
  v_accvgpr_read_b32 v113, a97
  v_cvt_pk_bf16_f32 v98, v100, v101
  v_cvt_pk_bf16_f32 v99, v102, v103
  v_accvgpr_read_b32 v114, a98
  v_accvgpr_read_b32 v115, a99
  v_cvt_pk_bf16_f32 v104, v104, v105
  v_accvgpr_read_b32 v116, a104
  v_accvgpr_read_b32 v117, a105
  v_accvgpr_read_b32 v118, a106
  v_accvgpr_read_b32 v119, a107
  v_cvt_pk_bf16_f32 v105, v106, v107
  v_accvgpr_read_b32 v120, a100
  v_accvgpr_read_b32 v121, a101
  s_add_u32 s27, s29, 524288
  v_cvt_pk_bf16_f32 v106, v108, v109
  v_cvt_pk_bf16_f32 v107, v110, v111
  v_accvgpr_read_b32 v122, a102
  v_accvgpr_read_b32 v123, a103
  v_cvt_pk_bf16_f32 v112, v112, v113
  v_accvgpr_read_b32 v124, a108
  v_accvgpr_read_b32 v125, a109
  v_accvgpr_read_b32 v126, a110
  v_accvgpr_read_b32 v127, a111
  buffer_store_dwordx4 v[96:99], v91, s[16:19], s27 offen offset:0 sc1
  v_cvt_pk_bf16_f32 v113, v114, v115
  v_cvt_pk_bf16_f32 v114, v116, v117
  v_cvt_pk_bf16_f32 v115, v118, v119
  v_accvgpr_read_b32 v96, a160
  v_accvgpr_read_b32 v97, a161
  v_cvt_pk_bf16_f32 v120, v120, v121
  v_accvgpr_read_b32 v98, a162
  v_accvgpr_read_b32 v99, a163
  buffer_store_dwordx4 v[104:107], v91, s[16:19], s27 offen offset:512 sc1
  v_cvt_pk_bf16_f32 v121, v122, v123
  v_accvgpr_read_b32 v100, a168
  v_accvgpr_read_b32 v101, a169
  v_accvgpr_read_b32 v102, a170
  v_accvgpr_read_b32 v103, a171
  v_cvt_pk_bf16_f32 v122, v124, v125
  v_cvt_pk_bf16_f32 v123, v126, v127
  v_accvgpr_read_b32 v104, a164
  v_accvgpr_read_b32 v105, a165
  v_accvgpr_read_b32 v106, a166
  v_accvgpr_read_b32 v107, a167
  buffer_store_dwordx4 v[112:115], v91, s[16:19], s27 offen offset:2048 sc1
  v_cvt_pk_bf16_f32 v96, v96, v97
  v_accvgpr_read_b32 v108, a172
  v_accvgpr_read_b32 v109, a173
  v_accvgpr_read_b32 v110, a174
  v_accvgpr_read_b32 v111, a175
  v_cvt_pk_bf16_f32 v97, v98, v99
  v_accvgpr_read_b32 v112, a224
  v_accvgpr_read_b32 v113, a225
  v_cvt_pk_bf16_f32 v98, v100, v101
  v_cvt_pk_bf16_f32 v99, v102, v103
  v_accvgpr_read_b32 v114, a226
  v_accvgpr_read_b32 v115, a227
  buffer_store_dwordx4 v[120:123], v91, s[16:19], s27 offen offset:2560 sc1
  v_cvt_pk_bf16_f32 v104, v104, v105
  v_accvgpr_read_b32 v116, a232
  v_accvgpr_read_b32 v117, a233
  v_accvgpr_read_b32 v118, a234
  v_accvgpr_read_b32 v119, a235
  v_cvt_pk_bf16_f32 v105, v106, v107
  v_accvgpr_read_b32 v120, a228
  v_accvgpr_read_b32 v121, a229
  s_add_u32 s28, s27, 4096
  v_cvt_pk_bf16_f32 v106, v108, v109
  v_cvt_pk_bf16_f32 v107, v110, v111
  v_accvgpr_read_b32 v122, a230
  v_accvgpr_read_b32 v123, a231
  v_cvt_pk_bf16_f32 v112, v112, v113
  v_accvgpr_read_b32 v124, a236
  v_accvgpr_read_b32 v125, a237
  v_accvgpr_read_b32 v126, a238
  v_accvgpr_read_b32 v127, a239
  buffer_store_dwordx4 v[96:99], v91, s[16:19], s28 offen offset:0 sc1
  v_cvt_pk_bf16_f32 v113, v114, v115
  s_add_u32 s28, s27, 4096
  v_cvt_pk_bf16_f32 v114, v116, v117
  v_cvt_pk_bf16_f32 v115, v118, v119
  v_cvt_pk_bf16_f32 v120, v120, v121
  buffer_store_dwordx4 v[104:107], v91, s[16:19], s28 offen offset:512 sc1
  v_cvt_pk_bf16_f32 v121, v122, v123
  s_add_u32 s28, s27, 4096
  v_cvt_pk_bf16_f32 v122, v124, v125
  v_cvt_pk_bf16_f32 v123, v126, v127
  buffer_store_dwordx4 v[112:115], v91, s[16:19], s28 offen offset:2048 sc1
  s_add_u32 s28, s27, 4096
  buffer_store_dwordx4 v[120:123], v91, s[16:19], s28 offen offset:2560 sc1
  v_accvgpr_read_b32 v96, a48
  v_accvgpr_read_b32 v97, a49
  v_accvgpr_read_b32 v98, a50
  v_accvgpr_read_b32 v99, a51
  v_accvgpr_read_b32 v100, a56
  v_accvgpr_read_b32 v101, a57
  v_accvgpr_read_b32 v102, a58
  v_accvgpr_read_b32 v103, a59
  v_accvgpr_read_b32 v104, a52
  v_accvgpr_read_b32 v105, a53
  v_accvgpr_read_b32 v106, a54
  v_accvgpr_read_b32 v107, a55
  v_cvt_pk_bf16_f32 v96, v96, v97
  v_accvgpr_read_b32 v108, a60
  v_accvgpr_read_b32 v109, a61
  v_accvgpr_read_b32 v110, a62
  v_accvgpr_read_b32 v111, a63
  v_cvt_pk_bf16_f32 v97, v98, v99
  v_accvgpr_read_b32 v112, a112
  v_accvgpr_read_b32 v113, a113
  v_cvt_pk_bf16_f32 v98, v100, v101
  v_cvt_pk_bf16_f32 v99, v102, v103
  v_accvgpr_read_b32 v114, a114
  v_accvgpr_read_b32 v115, a115
  v_cvt_pk_bf16_f32 v104, v104, v105
  v_accvgpr_read_b32 v116, a120
  v_accvgpr_read_b32 v117, a121
  v_accvgpr_read_b32 v118, a122
  v_accvgpr_read_b32 v119, a123
  v_cvt_pk_bf16_f32 v105, v106, v107
  v_accvgpr_read_b32 v120, a116
  v_accvgpr_read_b32 v121, a117
  s_add_u32 s27, s29, 786432
  v_cvt_pk_bf16_f32 v106, v108, v109
  v_cvt_pk_bf16_f32 v107, v110, v111
  v_accvgpr_read_b32 v122, a118
  v_accvgpr_read_b32 v123, a119
  v_cvt_pk_bf16_f32 v112, v112, v113
  v_accvgpr_read_b32 v124, a124
  v_accvgpr_read_b32 v125, a125
  v_accvgpr_read_b32 v126, a126
  v_accvgpr_read_b32 v127, a127
  buffer_store_dwordx4 v[96:99], v91, s[16:19], s27 offen offset:0 sc1
  v_cvt_pk_bf16_f32 v113, v114, v115
  v_cvt_pk_bf16_f32 v114, v116, v117
  v_cvt_pk_bf16_f32 v115, v118, v119
  v_accvgpr_read_b32 v96, a176
  v_accvgpr_read_b32 v97, a177
  v_cvt_pk_bf16_f32 v120, v120, v121
  v_accvgpr_read_b32 v98, a178
  v_accvgpr_read_b32 v99, a179
  buffer_store_dwordx4 v[104:107], v91, s[16:19], s27 offen offset:512 sc1
  v_cvt_pk_bf16_f32 v121, v122, v123
  v_accvgpr_read_b32 v100, a184
  v_accvgpr_read_b32 v101, a185
  v_accvgpr_read_b32 v102, a186
  v_accvgpr_read_b32 v103, a187
  v_cvt_pk_bf16_f32 v122, v124, v125
  v_cvt_pk_bf16_f32 v123, v126, v127
  v_accvgpr_read_b32 v104, a180
  v_accvgpr_read_b32 v105, a181
  v_accvgpr_read_b32 v106, a182
  v_accvgpr_read_b32 v107, a183
  buffer_store_dwordx4 v[112:115], v91, s[16:19], s27 offen offset:2048 sc1
  v_cvt_pk_bf16_f32 v96, v96, v97
  v_accvgpr_read_b32 v108, a188
  v_accvgpr_read_b32 v109, a189
  v_accvgpr_read_b32 v110, a190
  v_accvgpr_read_b32 v111, a191
  v_cvt_pk_bf16_f32 v97, v98, v99
  v_accvgpr_read_b32 v112, a240
  v_accvgpr_read_b32 v113, a241
  v_cvt_pk_bf16_f32 v98, v100, v101
  v_cvt_pk_bf16_f32 v99, v102, v103
  v_accvgpr_read_b32 v114, a242
  v_accvgpr_read_b32 v115, a243
  buffer_store_dwordx4 v[120:123], v91, s[16:19], s27 offen offset:2560 sc1
  v_cvt_pk_bf16_f32 v104, v104, v105
  v_accvgpr_read_b32 v116, a248
  v_accvgpr_read_b32 v117, a249
  v_accvgpr_read_b32 v118, a250
  v_accvgpr_read_b32 v119, a251
  v_cvt_pk_bf16_f32 v105, v106, v107
  v_accvgpr_read_b32 v120, a244
  v_accvgpr_read_b32 v121, a245
  s_add_u32 s28, s27, 4096
  v_cvt_pk_bf16_f32 v106, v108, v109
  v_cvt_pk_bf16_f32 v107, v110, v111
  v_accvgpr_read_b32 v122, a246
  v_accvgpr_read_b32 v123, a247
  v_cvt_pk_bf16_f32 v112, v112, v113
  v_accvgpr_read_b32 v124, a252
  v_accvgpr_read_b32 v125, a253
  v_accvgpr_read_b32 v126, a254
  v_accvgpr_read_b32 v127, a255
  buffer_store_dwordx4 v[96:99], v91, s[16:19], s28 offen offset:0 sc1
  v_cvt_pk_bf16_f32 v113, v114, v115
  s_add_u32 s28, s27, 4096
  v_cvt_pk_bf16_f32 v114, v116, v117
  v_cvt_pk_bf16_f32 v115, v118, v119
  v_cvt_pk_bf16_f32 v120, v120, v121
  buffer_store_dwordx4 v[104:107], v91, s[16:19], s28 offen offset:512 sc1
  v_cvt_pk_bf16_f32 v121, v122, v123
  s_add_u32 s28, s27, 4096
  v_cvt_pk_bf16_f32 v122, v124, v125
  v_cvt_pk_bf16_f32 v123, v126, v127
  buffer_store_dwordx4 v[112:115], v91, s[16:19], s28 offen offset:2048 sc1
  s_add_u32 s28, s27, 4096
  buffer_store_dwordx4 v[120:123], v91, s[16:19], s28 offen offset:2560 sc1
L_j_donew:
  s_waitcnt vmcnt(0)
  s_barrier
  s_cmp_lg_u32 s31, 0
  s_cbranch_scc1 L_wq_next
  s_cmp_eq_u32 s33, 2
  s_cbranch_scc1 L_wq_qsig
  s_mov_b32 s74, 24
  s_cmp_eq_u32 s33, 3
  s_cselect_b32 s74, 32, s74
  s_add_u32 s74, s74, s34
  s_lshl_b32 s74, s74, 2
  s_mov_b64 s[66:67], exec
  s_mov_b64 exec, 1
  v_mov_b32 v2, s74
  v_mov_b32 v3, 1
  global_atomic_add v2, v3, s[62:63] sc1
  s_waitcnt vmcnt(0)
  s_mov_b64 exec, s[66:67]
  s_branch L_wq_next
L_wq_qsig:
  s_mov_b32 s79, 0
L_wq_ci:
  v_mov_b32 v2, 40
  global_load_dword v4, v2, s[62:63] sc1
  s_waitcnt vmcnt(0)
  v_readfirstlane_b32 s80, v4
  s_nop 0
  s_cmp_ge_u32 s80, 32
  s_cbranch_scc1 L_wq_ci_ok
  s_sleep 8
  s_add_u32 s79, s79, 1
  s_cmp_lt_u32 s79, 400000
  s_cbranch_scc1 L_wq_ci
L_wq_ci_ok:
  s_lshl_b32 s74, s34, 2
  s_add_u32 s74, s74, 115409152
  s_mov_b64 s[66:67], exec
  s_mov_b64 exec, 1
  v_mov_b32 v2, 0
  v_mov_b32 v3, 1
  buffer_atomic_add v3, v2, s[16:19], s74 offen sc1
  s_waitcnt vmcnt(0)
  s_mov_b64 exec, s[66:67]
  s_branch L_wq_next
L_wd_start:
  s_cmp_lg_u32 s31, 0
  s_cbranch_scc1 L_gt_wait
  s_mov_b32 s79, 0
L_gt_ci:
  v_mov_b32 v2, 40
  global_load_dword v4, v2, s[62:63] sc1
  s_waitcnt vmcnt(0)
  v_readfirstlane_b32 s80, v4
  s_nop 0
  s_cmp_ge_u32 s80, 32
  s_cbranch_scc1 L_gt_ci_ok
  s_sleep 8
  s_add_u32 s79, s79, 1
  s_cmp_lt_u32 s79, 400000
  s_cbranch_scc1 L_gt_ci
L_gt_ci_ok:
  s_mov_b64 s[66:67], exec
  s_mov_b64 exec, 1
  v_mov_b32 v2, 48
  v_mov_b32 v3, 1
  global_atomic_add v4, v2, v3, s[62:63] sc0 sc1
  s_waitcnt vmcnt(0)
  v_readfirstlane_b32 s77, v4
  s_mov_b64 exec, s[66:67]
  v_mov_b32 v2, 159744
  v_mov_b32 v3, s77
  ds_write_b32 v2, v3
  s_waitcnt lgkmcnt(0)
L_gt_wait:
  s_barrier
  v_mov_b32 v2, 159744
  ds_read_b32 v3, v2
  s_waitcnt lgkmcnt(0)
  v_readfirstlane_b32 s77, v3
  s_nop 3
  s_barrier
  s_cmp_lt_u32 s77, 8
  s_cbranch_scc0 L_gt_skip
  s_mov_b32 s8, s40
  s_mov_b32 s9, s41
  s_mov_b32 s10, 2359296
  s_mov_b32 s11, 0x00020000
  s_lshl_b32 s27, s77, 8
  v_add_u32 v2, s27, v0
  v_mul_u32_u24 v3, 1152, v2
  v_mov_b32 v4, 0
  s_mov_b32 s26, 0
L_gatek1:
  s_lshl_b32 s28, s26, 6
  s_add_u32 s100, s58, s28
  s_addc_u32 s101, s59, 0
  s_load_dwordx16 s[84:99], s[100:101], 0
  buffer_load_dwordx4 v[8:11], v3, s[8:11], s28 offen
  buffer_load_dwordx4 v[12:15], v3, s[8:11], s28 offen offset:16
  buffer_load_dwordx4 v[16:19], v3, s[8:11], s28 offen offset:32
  buffer_load_dwordx4 v[20:23], v3, s[8:11], s28 offen offset:48
  s_waitcnt vmcnt(0) lgkmcnt(0)
  v_dot2c_f32_bf16 v4, s84, v8
  v_dot2c_f32_bf16 v4, s85, v9
  v_dot2c_f32_bf16 v4, s86, v10
  v_dot2c_f32_bf16 v4, s87, v11
  v_dot2c_f32_bf16 v4, s88, v12
  v_dot2c_f32_bf16 v4, s89, v13
  v_dot2c_f32_bf16 v4, s90, v14
  v_dot2c_f32_bf16 v4, s91, v15
  v_dot2c_f32_bf16 v4, s92, v16
  v_dot2c_f32_bf16 v4, s93, v17
  v_dot2c_f32_bf16 v4, s94, v18
  v_dot2c_f32_bf16 v4, s95, v19
  v_dot2c_f32_bf16 v4, s96, v20
  v_dot2c_f32_bf16 v4, s97, v21
  v_dot2c_f32_bf16 v4, s98, v22
  v_dot2c_f32_bf16 v4, s99, v23
  s_add_u32 s26, s26, 1
  s_cmp_lt_u32 s26, 18
  s_cbranch_scc1 L_gatek1
  v_mul_f32 v4, 0xbfb8aa3b, v4
  v_exp_f32 v4, v4
  s_nop 0
  v_add_f32 v4, 1.0, v4
  v_rcp_f32 v4, v4
  v_lshlrev_b32 v2, 2, v2
  s_mov_b32 s27, 115343360
  s_nop 0
  buffer_store_dword v4, v2, s[16:19], s27 offen sc1
  s_waitcnt vmcnt(0)
  s_barrier
  s_cmp_lg_u32 s31, 0
  s_cbranch_scc1 L_gt_skip
  s_mov_b32 s74, 115410176
  s_mov_b64 s[66:67], exec
  s_mov_b64 exec, 1
  v_mov_b32 v2, 0
  v_mov_b32 v3, 1
  buffer_atomic_add v3, v2, s[16:19], s74 offen sc1
  s_waitcnt vmcnt(0)
  s_mov_b64 exec, s[66:67]
L_gt_skip:
  s_sub_u32 s72, s68, 1
  s_cmp_eq_u32 s68, 0
  s_cselect_b32 s72, 0, s72
  s_mov_b32 s73, 0
L_wd_next:
  s_cmp_lg_u32 s31, 0
  s_cbranch_scc1 L_wd_wait
  s_add_u32 s74, s72, 40
  s_lshl_b32 s74, s74, 2
  s_mov_b64 s[66:67], exec
  s_mov_b64 exec, 1
  v_mov_b32 v2, s74
  v_mov_b32 v3, 1
  global_atomic_add v4, v2, v3, s[62:63] sc0 sc1
  s_waitcnt vmcnt(0)
  v_readfirstlane_b32 s75, v4
  s_mov_b64 exec, s[66:67]
  s_mul_i32 s76, s75, 7282
  s_lshr_b32 s76, s76, 16
  s_mul_i32 s77, s76, 7
  s_add_u32 s77, s77, s72
  s_cmp_lt_u32 s75, 27
  s_cselect_b32 s77, s77, 99
  s_cmp_lt_u32 s77, 16
  s_cbranch_scc1 L_wd_valid
  s_mov_b32 s77, 0xffff
  s_branch L_wd_pub
L_wd_valid:
  s_lshr_b32 s78, s77, 1
  s_add_u32 s78, s78, 32
  s_lshl_b32 s78, s78, 2
  s_mov_b32 s79, 0
L_wd_poll:
  v_mov_b32 v2, s78
  global_load_dword v4, v2, s[62:63] sc1
  s_waitcnt vmcnt(0)
  v_readfirstlane_b32 s80, v4
  s_nop 0
  s_cmp_ge_u32 s80, 36
  s_cbranch_scc1 L_wd_ready
  s_sleep 16
  s_add_u32 s79, s79, 1
  s_cmp_lt_u32 s79, 400000
  s_cbranch_scc1 L_wd_poll
L_wd_ready:
  s_mul_i32 s78, s76, 9
  s_sub_u32 s78, s75, s78
  s_mul_i32 s77, s77, 9
  s_add_u32 s77, s77, s78
L_wd_pub:
  v_mov_b32 v2, 159744
  v_mov_b32 v3, s77
  ds_write_b32 v2, v3
  s_waitcnt lgkmcnt(0)
L_wd_wait:
  s_barrier
  v_mov_b32 v2, 159744
  ds_read_b32 v3, v2
  s_waitcnt lgkmcnt(0)
  v_readfirstlane_b32 s77, v3
  s_nop 3
  s_barrier
  s_cmp_lt_u32 s77, 144
  s_cbranch_scc1 L_wd_job
  s_add_u32 s72, s72, 1
  s_cmp_eq_u32 s72, 7
  s_cselect_b32 s72, 0, s72
  s_add_u32 s73, s73, 1
  s_cmp_lt_u32 s73, 7
  s_cbranch_scc1 L_wd_next
  s_branch L_t2_first
L_wd_job:
  s_mul_i32 s90, s77, 7282
  s_lshr_b32 s90, s90, 16
  s_cmp_ge_u32 s90, 7
  s_cselect_b32 s90, 1, 0
  s_mul_i32 s34, s77, 7282
  s_lshr_b32 s34, s34, 16
  s_mul_i32 s27, s34, 9
  s_sub_u32 s35, s77, s27
  s_mov_b32 s8, s16
  s_mov_b32 s9, s17
  s_mov_b32 s10, 0x10000000
  s_mov_b32 s11, 0x00020000
  s_mov_b32 s12, s54
  s_mov_b32 s13, s55
  s_mov_b32 s14, 5308416
  s_mov_b32 s15, 0x00020000
  s_lshl_b32 s27, s34, 2
  s_add_u32 s27, s27, s31
  s_mul_i32 s20, s27, 294912
  s_add_u32 s20, s20, 72351744
  s_lshl_b32 s24, s31, 12
  s_lshr_b32 s27, s31, 1
  s_lshl_b32 s27, s27, 5
  s_and_b32 s28, s31, 1
  s_lshl_b32 s28, s28, 3
  s_add_u32 s27, s27, s28
  s_mul_i32 s21, s27, 1152
  s_lshl_b32 s27, s35, 7
  s_add_u32 s21, s21, s27
  s_lshl_b32 s25, s31, 11
  s_add_u32 s25, s25, 16384
  s_mov_b32 s37, 72
  v_and_b32 v1, 63, v0
  s_lshr_b32 s27, s31, 1
  s_lshl_b32 s27, s27, 13
  v_lshlrev_b32 v45, 4, v1
  v_add_u32 v40, s27, v45
  v_lshrrev_b32 v2, 4, v1
  v_and_b32 v3, 15, v1
  v_lshrrev_b32 v4, 2, v3
  v_and_b32 v5, 3, v3
  v_lshrrev_b32 v6, 1, v2
  v_lshlrev_b32 v6, 3, v6
  v_add_u32 v6, v6, v4
  v_lshlrev_b32 v6, 7, v6
  v_and_b32 v7, 1, v2
  v_lshlrev_b32 v7, 1, v7
  v_lshrrev_b32 v8, 1, v5
  v_add_u32 v7, v7, v8
  s_and_b32 s27, s31, 1
  s_lshl_b32 s27, s27, 2
  v_add_u32 v7, s27, v7
  v_lshrrev_b32 v8, 1, v4
  v_lshlrev_b32 v8, 2, v8
  v_xor_b32 v7, v7, v8
  v_lshlrev_b32 v7, 4, v7
  v_and_b32 v8, 1, v5
  v_lshlrev_b32 v8, 3, v8
  v_add3_u32 v6, v6, v7, v8
  v_add_u32 v44, 16384, v6
  v_lshrrev_b32 v4, 3, v1
  v_lshrrev_b32 v5, 2, v4
  v_lshlrev_b32 v5, 4, v5
  v_and_b32 v6, 3, v4
  v_add_u32 v5, v5, v6
  v_mul_u32_u24 v5, 1152, v5
  v_bfe_u32 v6, v4, 1, 1
  v_lshlrev_b32 v6, 2, v6
  v_and_b32 v7, 7, v1
  v_xor_b32 v6, v6, v7
  v_lshlrev_b32 v6, 4, v6
  v_add_u32 v47, v5, v6
  v_and_b32 v1, 63, v0
  s_cmp_eq_u32 s31, 1
  s_cbranch_scc1 L_b_twwd
  s_mov_b32 s84, s8
  s_mov_b32 s85, s9
  s_mov_b32 s86, s10
  s_mov_b32 s87, 0x00020000
  s_mul_i32 s27, s35, 29
  v_add_u32 v2, s27, v1
  v_lshrrev_b32 v3, 6, v2
  v_mul_u32_u24 v3, 18432, v3
  v_lshlrev_b32 v3, 4, v3
  v_and_b32 v4, 63, v2
  v_lshlrev_b32 v4, 6, v4
  v_add_u32 v3, v3, v4
  v_mov_b32 v5, 0x40000000
  v_cmp_gt_u32 vcc, 29, v1
  s_nop 1
  v_cndmask_b32 v3, v5, v3, vcc
  v_cmp_gt_u32 vcc, 256, v2
  s_nop 1
  v_cndmask_b32 v49, v5, v3, vcc
  s_lshl_b32 s27, s34, 2
  s_mul_i32 s88, s27, 294912
  s_add_u32 s88, s88, 72368128
  s_mov_b32 s89, 4096
  s_cmp_eq_u32 s31, 0
  s_cselect_b32 s88, s88, 0x40000000
  s_cselect_b32 s89, s89, 0
  s_branch L_b_tdwd
L_b_twwd:
  s_mov_b32 s84, s12
  s_mov_b32 s85, s13
  s_mov_b32 s86, s14
  s_mov_b32 s87, 0x00020000
  v_lshrrev_b32 v2, 1, v1
  v_mul_u32_u24 v2, 1152, v2
  v_and_b32 v3, 1, v1
  v_lshlrev_b32 v3, 6, v3
  v_add_u32 v49, v2, v3
  s_lshl_b32 s27, s90, 5
  s_add_u32 s27, s27, 256
  s_mul_i32 s88, s27, 1152
  s_lshl_b32 s27, s35, 7
  s_add_u32 s88, s88, s27
  s_mov_b32 s89, 73728
L_b_tdwd:
  s_mov_b32 s32, 0
  s_mov_b32 s39, 0
  s_add_u32 m0, s24, s32
  s_mov_b32 s27, s20
  buffer_load_dwordx4 v45, s[8:11], s27 offen sc1 lds
  s_add_u32 m0, m0, 1024
  s_add_u32 s27, s27, 1024
  buffer_load_dwordx4 v45, s[8:11], s27 offen sc1 lds
  s_add_u32 m0, m0, 1024
  s_add_u32 s27, s27, 1024
  buffer_load_dwordx4 v45, s[8:11], s27 offen sc1 lds
  s_add_u32 m0, m0, 1024
  s_add_u32 s27, s27, 1024
  buffer_load_dwordx4 v45, s[8:11], s27 offen sc1 lds
  s_add_u32 m0, s25, s32
  s_nop 0
  buffer_load_dwordx4 v47, s[12:15], s21 offen lds
  s_add_u32 m0, m0, 1024
  s_add_u32 s27, s21, 4608
  buffer_load_dwordx4 v47, s[12:15], s27 offen lds
  s_add_u32 s20, s20, 4096
  s_add_u32 s21, s21, 73728
  s_add_u32 s32, s32, 24576
  s_cmp_eq_u32 s32, 98304
  s_cselect_b32 s32, 0, s32
  s_add_u32 m0, s24, s32
  s_mov_b32 s27, s20
  buffer_load_dwordx4 v45, s[8:11], s27 offen sc1 lds
  s_add_u32 m0, m0, 1024
  s_add_u32 s27, s27, 1024
  buffer_load_dwordx4 v45, s[8:11], s27 offen sc1 lds
  s_add_u32 m0, m0, 1024
  s_add_u32 s27, s27, 1024
  buffer_load_dwordx4 v45, s[8:11], s27 offen sc1 lds
  s_add_u32 m0, m0, 1024
  s_add_u32 s27, s27, 1024
  buffer_load_dwordx4 v45, s[8:11], s27 offen sc1 lds
  s_add_u32 m0, s25, s32
  s_nop 0
  buffer_load_dwordx4 v47, s[12:15], s21 offen lds
  s_add_u32 m0, m0, 1024
  s_add_u32 s27, s21, 4608
  buffer_load_dwordx4 v47, s[12:15], s27 offen lds
  s_add_u32 s20, s20, 4096
  s_add_u32 s21, s21, 73728
  s_add_u32 s32, s32, 24576
  s_cmp_eq_u32 s32, 98304
  s_cselect_b32 s32, 0, s32
  s_add_u32 m0, s24, s32
  s_mov_b32 s27, s20
  buffer_load_dwordx4 v45, s[8:11], s27 offen sc1 lds
  s_add_u32 m0, m0, 1024
  s_add_u32 s27, s27, 1024
  buffer_load_dwordx4 v45, s[8:11], s27 offen sc1 lds
  s_add_u32 m0, m0, 1024
  s_add_u32 s27, s27, 1024
  buffer_load_dwordx4 v45, s[8:11], s27 offen sc1 lds
  s_add_u32 m0, m0, 1024
  s_add_u32 s27, s27, 1024
  buffer_load_dwordx4 v45, s[8:11], s27 offen sc1 lds
  s_add_u32 m0, s25, s32
  s_nop 0
  buffer_load_dwordx4 v47, s[12:15], s21 offen lds
  s_add_u32 m0, m0, 1024
  s_add_u32 s27, s21, 4608
  buffer_load_dwordx4 v47, s[12:15], s27 offen lds
  s_add_u32 s20, s20, 4096
  s_add_u32 s21, s21, 73728
  s_add_u32 s32, s32, 24576
  s_cmp_eq_u32 s32, 98304
  s_cselect_b32 s32, 0, s32
  s_add_u32 m0, s24, s32
  s_mov_b32 s27, s20
  buffer_load_dwordx4 v45, s[8:11], s27 offen sc1 lds
  s_add_u32 m0, m0, 1024
  s_add_u32 s27, s27, 1024
  buffer_load_dwordx4 v45, s[8:11], s27 offen sc1 lds
  s_add_u32 m0, m0, 1024
  s_add_u32 s27, s27, 1024
  buffer_load_dwordx4 v45, s[8:11], s27 offen sc1 lds
  s_add_u32 m0, m0, 1024
  s_add_u32 s27, s27, 1024
  buffer_load_dwordx4 v45, s[8:11], s27 offen sc1 lds
  s_add_u32 m0, s25, s32
  s_nop 0
  buffer_load_dwordx4 v47, s[12:15], s21 offen lds
  s_add_u32 m0, m0, 1024
  s_add_u32 s27, s21, 4608
  buffer_load_dwordx4 v47, s[12:15], s27 offen lds
  s_add_u32 s20, s20, 4096
  s_add_u32 s21, s21, 73728
  s_add_u32 s32, s32, 24576
  s_cmp_eq_u32 s32, 98304
  s_cselect_b32 s32, 0, s32
  s_waitcnt vmcnt(18)
  s_barrier
  ds_read_b128 v[16:19], v40 offset:0
  ds_read_b128 v[20:23], v40 offset:4096
  ds_read_b64_tr_b16 v[32:33], v44 offset:0
  ds_read_b64_tr_b16 v[34:35], v44 offset:512
  ds_read_b128 v[24:27], v40 offset:1024
  s_waitcnt lgkmcnt(1)
  v_mfma_f32_32x32x16_bf16 a[0:15], v[32:35], v[16:19], 0
  ds_read_b128 v[28:31], v40 offset:5120
  ds_read_b64_tr_b16 v[36:37], v44 offset:2048
  v_mfma_f32_32x32x16_bf16 a[16:31], v[32:35], v[20:23], 0
  ds_read_b64_tr_b16 v[38:39], v44 offset:2560
  ds_read_b128 v[16:19], v40 offset:2048
  ds_read_b128 v[20:23], v40 offset:6144
  ds_read_b64_tr_b16 v[32:33], v44 offset:4096
  ds_read_b64_tr_b16 v[34:35], v44 offset:4608
  s_waitcnt lgkmcnt(4)
  v_mfma_f32_32x32x16_bf16 a[0:15], v[36:39], v[24:27], a[0:15]
  ds_read_b128 v[24:27], v40 offset:3072
  v_mfma_f32_32x32x16_bf16 a[16:31], v[36:39], v[28:31], a[16:31]
  ds_read_b128 v[28:31], v40 offset:7168
  ds_read_b64_tr_b16 v[36:37], v44 offset:6144
  ds_read_b64_tr_b16 v[38:39], v44 offset:6656
  s_waitcnt lgkmcnt(4)
  v_mfma_f32_32x32x16_bf16 a[0:15], v[32:35], v[16:19], a[0:15]
  v_mfma_f32_32x32x16_bf16 a[16:31], v[32:35], v[20:23], a[16:31]
  s_sub_u32 s26, s37, 4
L_kbwd:
  s_waitcnt vmcnt(12) lgkmcnt(0)
  s_barrier
  s_add_u32 s39, s39, 24576
  s_cmp_eq_u32 s39, 98304
  s_mov_b32 s38, 24576
  s_cselect_b32 s38, 0xfffee000, s38
  v_add_u32 v40, s38, v40
  v_add_u32 v44, s38, v44
  ds_read_b128 v[16:19], v40 offset:0
  v_mfma_f32_32x32x16_bf16 a[0:15], v[36:39], v[24:27], a[0:15]
  s_cselect_b32 s39, 0, s39
  s_add_u32 m0, s24, s32
  ds_read_b128 v[20:23], v40 offset:4096
  s_mov_b32 s27, s20
  buffer_load_dwordx4 v45, s[8:11], s27 offen sc1 lds
  ds_read_b64_tr_b16 v[32:33], v44 offset:0
  v_mfma_f32_32x32x16_bf16 a[16:31], v[36:39], v[28:31], a[16:31]
  ds_read_b64_tr_b16 v[34:35], v44 offset:512
  s_add_u32 m0, m0, 1024
  ds_read_b128 v[24:27], v40 offset:1024
  s_add_u32 s27, s27, 1024
  buffer_load_dwordx4 v45, s[8:11], s27 offen sc1 lds
  ds_read_b128 v[28:31], v40 offset:5120
  s_add_u32 m0, m0, 1024
  s_add_u32 s27, s27, 1024
  buffer_load_dwordx4 v45, s[8:11], s27 offen sc1 lds
  ds_read_b64_tr_b16 v[36:37], v44 offset:2048
  s_add_u32 m0, m0, 1024
  ds_read_b64_tr_b16 v[38:39], v44 offset:2560
  s_add_u32 s27, s27, 1024
  s_waitcnt lgkmcnt(4)
  v_mfma_f32_32x32x16_bf16 a[0:15], v[32:35], v[16:19], a[0:15]
  ds_read_b128 v[16:19], v40 offset:2048
  buffer_load_dwordx4 v45, s[8:11], s27 offen sc1 lds
  s_add_u32 m0, s25, s32
  v_mfma_f32_32x32x16_bf16 a[16:31], v[32:35], v[20:23], a[16:31]
  ds_read_b128 v[20:23], v40 offset:6144
  ds_read_b64_tr_b16 v[32:33], v44 offset:4096
  ds_read_b64_tr_b16 v[34:35], v44 offset:4608
  s_waitcnt lgkmcnt(4)
  v_mfma_f32_32x32x16_bf16 a[0:15], v[36:39], v[24:27], a[0:15]
  buffer_load_dwordx4 v47, s[12:15], s21 offen lds
  s_add_u32 m0, m0, 1024
  s_add_u32 s27, s21, 4608
  s_add_u32 s20, s20, 4096
  v_mfma_f32_32x32x16_bf16 a[16:31], v[36:39], v[28:31], a[16:31]
  s_add_u32 s21, s21, 73728
  s_add_u32 s32, s32, 24576
  s_cmp_eq_u32 s32, 98304
  s_cselect_b32 s32, 0, s32
  ds_read_b128 v[24:27], v40 offset:3072
  buffer_load_dwordx4 v47, s[12:15], s27 offen lds
  ds_read_b128 v[28:31], v40 offset:7168
  s_waitcnt lgkmcnt(2)
  v_mfma_f32_32x32x16_bf16 a[0:15], v[32:35], v[16:19], a[0:15]
  ds_read_b64_tr_b16 v[36:37], v44 offset:6144
  ds_read_b64_tr_b16 v[38:39], v44 offset:6656
  v_mfma_f32_32x32x16_bf16 a[16:31], v[32:35], v[20:23], a[16:31]
  s_sub_u32 s26, s26, 1
  s_cmp_lg_u32 s26, 0
  s_cbranch_scc1 L_kbwd
  s_waitcnt vmcnt(12) lgkmcnt(0)
  s_barrier
  s_add_u32 s39, s39, 24576
  s_cmp_eq_u32 s39, 98304
  s_mov_b32 s38, 24576
  s_cselect_b32 s38, 0xfffee000, s38
  v_add_u32 v40, s38, v40
  v_add_u32 v44, s38, v44
  ds_read_b128 v[16:19], v40 offset:0
  v_mfma_f32_32x32x16_bf16 a[0:15], v[36:39], v[24:27], a[0:15]
  s_cselect_b32 s39, 0, s39
  ds_read_b128 v[20:23], v40 offset:4096
  ds_read_b64_tr_b16 v[32:33], v44 offset:0
  v_mfma_f32_32x32x16_bf16 a[16:31], v[36:39], v[28:31], a[16:31]
  ds_read_b64_tr_b16 v[34:35], v44 offset:512
  ds_read_b128 v[24:27], v40 offset:1024
  ds_read_b128 v[28:31], v40 offset:5120
  ds_read_b64_tr_b16 v[36:37], v44 offset:2048
  ds_read_b64_tr_b16 v[38:39], v44 offset:2560
  s_waitcnt lgkmcnt(4)
  v_mfma_f32_32x32x16_bf16 a[0:15], v[32:35], v[16:19], a[0:15]
  ds_read_b128 v[16:19], v40 offset:2048
  v_mfma_f32_32x32x16_bf16 a[16:31], v[32:35], v[20:23], a[16:31]
  ds_read_b128 v[20:23], v40 offset:6144
  ds_read_b64_tr_b16 v[32:33], v44 offset:4096
  ds_read_b64_tr_b16 v[34:35], v44 offset:4608
  s_waitcnt lgkmcnt(4)
  v_mfma_f32_32x32x16_bf16 a[0:15], v[36:39], v[24:27], a[0:15]
  ds_read_b128 v[24:27], v40 offset:3072
  v_mfma_f32_32x32x16_bf16 a[16:31], v[36:39], v[28:31], a[16:31]
  ds_read_b128 v[28:31], v40 offset:7168
  ds_read_b64_tr_b16 v[36:37], v44 offset:6144
  ds_read_b64_tr_b16 v[38:39], v44 offset:6656
  s_waitcnt lgkmcnt(4)
  v_mfma_f32_32x32x16_bf16 a[0:15], v[32:35], v[16:19], a[0:15]
  v_mfma_f32_32x32x16_bf16 a[16:31], v[32:35], v[20:23], a[16:31]
  s_waitcnt vmcnt(6) lgkmcnt(0)
  s_barrier
  s_add_u32 s39, s39, 24576
  s_cmp_eq_u32 s39, 98304
  s_mov_b32 s38, 24576
  s_cselect_b32 s38, 0xfffee000, s38
  v_add_u32 v40, s38, v40
  v_add_u32 v44, s38, v44
  ds_read_b128 v[16:19], v40 offset:0
  v_mfma_f32_32x32x16_bf16 a[0:15], v[36:39], v[24:27], a[0:15]
  s_cselect_b32 s39, 0, s39
  ds_read_b128 v[20:23], v40 offset:4096
  ds_read_b64_tr_b16 v[32:33], v44 offset:0
  v_mfma_f32_32x32x16_bf16 a[16:31], v[36:39], v[28:31], a[16:31]
  ds_read_b64_tr_b16 v[34:35], v44 offset:512
  ds_read_b128 v[24:27], v40 offset:1024
  ds_read_b128 v[28:31], v40 offset:5120
  ds_read_b64_tr_b16 v[36:37], v44 offset:2048
  ds_read_b64_tr_b16 v[38:39], v44 offset:2560
  s_waitcnt lgkmcnt(4)
  v_mfma_f32_32x32x16_bf16 a[0:15], v[32:35], v[16:19], a[0:15]
  ds_read_b128 v[16:19], v40 offset:2048
  v_mfma_f32_32x32x16_bf16 a[16:31], v[32:35], v[20:23], a[16:31]
  ds_read_b128 v[20:23], v40 offset:6144
  ds_read_b64_tr_b16 v[32:33], v44 offset:4096
  ds_read_b64_tr_b16 v[34:35], v44 offset:4608
  s_waitcnt lgkmcnt(4)
  v_mfma_f32_32x32x16_bf16 a[0:15], v[36:39], v[24:27], a[0:15]
  ds_read_b128 v[24:27], v40 offset:3072
  v_mfma_f32_32x32x16_bf16 a[16:31], v[36:39], v[28:31], a[16:31]
  ds_read_b128 v[28:31], v40 offset:7168
  ds_read_b64_tr_b16 v[36:37], v44 offset:6144
  ds_read_b64_tr_b16 v[38:39], v44 offset:6656
  s_waitcnt lgkmcnt(4)
  v_mfma_f32_32x32x16_bf16 a[0:15], v[32:35], v[16:19], a[0:15]
  v_mfma_f32_32x32x16_bf16 a[16:31], v[32:35], v[20:23], a[16:31]
  s_waitcnt vmcnt(0) lgkmcnt(0)
  s_barrier
  s_add_u32 s39, s39, 24576
  s_cmp_eq_u32 s39, 98304
  s_mov_b32 s38, 24576
  s_cselect_b32 s38, 0xfffee000, s38
  v_add_u32 v40, s38, v40
  v_add_u32 v44, s38, v44
  ds_read_b128 v[16:19], v40 offset:0
  v_mfma_f32_32x32x16_bf16 a[0:15], v[36:39], v[24:27], a[0:15]
  s_cselect_b32 s39, 0, s39
  ds_read_b128 v[20:23], v40 offset:4096
  ds_read_b64_tr_b16 v[32:33], v44 offset:0
  v_mfma_f32_32x32x16_bf16 a[16:31], v[36:39], v[28:31], a[16:31]
  ds_read_b64_tr_b16 v[34:35], v44 offset:512
  ds_read_b128 v[24:27], v40 offset:1024
  ds_read_b128 v[28:31], v40 offset:5120
  ds_read_b64_tr_b16 v[36:37], v44 offset:2048
  ds_read_b64_tr_b16 v[38:39], v44 offset:2560
  s_waitcnt lgkmcnt(4)
  v_mfma_f32_32x32x16_bf16 a[0:15], v[32:35], v[16:19], a[0:15]
  ds_read_b128 v[16:19], v40 offset:2048
  v_mfma_f32_32x32x16_bf16 a[16:31], v[32:35], v[20:23], a[16:31]
  ds_read_b128 v[20:23], v40 offset:6144
  ds_read_b64_tr_b16 v[32:33], v44 offset:4096
  ds_read_b64_tr_b16 v[34:35], v44 offset:4608
  s_waitcnt lgkmcnt(4)
  v_mfma_f32_32x32x16_bf16 a[0:15], v[36:39], v[24:27], a[0:15]
  ds_read_b128 v[24:27], v40 offset:3072
  v_mfma_f32_32x32x16_bf16 a[16:31], v[36:39], v[28:31], a[16:31]
  ds_read_b128 v[28:31], v40 offset:7168
  ds_read_b64_tr_b16 v[36:37], v44 offset:6144
  ds_read_b64_tr_b16 v[38:39], v44 offset:6656
  s_waitcnt lgkmcnt(4)
  v_mfma_f32_32x32x16_bf16 a[0:15], v[32:35], v[16:19], a[0:15]
  v_mfma_f32_32x32x16_bf16 a[16:31], v[32:35], v[20:23], a[16:31]
  s_waitcnt lgkmcnt(0)
  v_mfma_f32_32x32x16_bf16 a[0:15], v[36:39], v[24:27], a[0:15]
  v_mfma_f32_32x32x16_bf16 a[16:31], v[36:39], v[28:31], a[16:31]
  s_lshl_b32 s29, s77, 15
  s_lshl_b32 s27, s31, 13
  s_add_u32 s29, s29, s27
  s_add_u32 s29, s29, 110100480
  v_and_b32 v1, 63, v0
  v_lshlrev_b32 v2, 4, v1
  s_add_u32 s30, s29, 4096
  s_nop 15
  buffer_store_dwordx4 a[0:3], v2, s[16:19], s29 offen offset:0 sc1
  buffer_store_dwordx4 a[4:7], v2, s[16:19], s29 offen offset:1024 sc1
  buffer_store_dwordx4 a[8:11], v2, s[16:19], s29 offen offset:2048 sc1
  buffer_store_dwordx4 a[12:15], v2, s[16:19], s29 offen offset:3072 sc1
  buffer_store_dwordx4 a[16:19], v2, s[16:19], s30 offen offset:0 sc1
  buffer_store_dwordx4 a[20:23], v2, s[16:19], s30 offen offset:1024 sc1
  buffer_store_dwordx4 a[24:27], v2, s[16:19], s30 offen offset:2048 sc1
  buffer_store_dwordx4 a[28:31], v2, s[16:19], s30 offen offset:3072 sc1
  s_waitcnt vmcnt(0)
  s_barrier
  s_cmp_lg_u32 s31, 0
  s_cbranch_scc1 L_wd_next
  s_lshl_b32 s74, s34, 2
  s_add_u32 s74, s74, 115409472
  s_mov_b64 s[66:67], exec
  s_mov_b64 exec, 1
  v_mov_b32 v2, 0
  v_mov_b32 v3, 1
  buffer_atomic_add v3, v2, s[16:19], s74 offen sc1
  s_waitcnt vmcnt(0)
  s_mov_b64 exec, s[66:67]
  s_branch L_wd_next
L_t2_first:
L_t2_next:
  s_cmp_lg_u32 s31, 0
  s_cbranch_scc1 L_t2_wait
  s_mov_b64 s[66:67], exec
  s_mov_b64 exec, 1
  v_mov_b32 v2, 52
  v_mov_b32 v3, 1
  global_atomic_add v4, v2, v3, s[62:63] sc0 sc1
  s_waitcnt vmcnt(0)
  v_readfirstlane_b32 s75, v4
  s_mov_b64 exec, s[66:67]
  s_cmp_ge_u32 s75, 710
  s_cbranch_scc1 L_t2_pub
  s_cmp_lt_u32 s75, 574
  s_cbranch_scc0 L_t2_d1_s
  s_mul_i32 s76, s75, 1599
  s_lshr_b32 s76, s76, 16
  s_mul_i32 s77, s76, 41
  s_sub_u32 s77, s75, s77
  s_mov_b32 s83, 0
  s_branch L_t2_d1_d
L_t2_d1_s:
  s_sub_u32 s77, s75, 574
  s_mul_i32 s76, s77, 964
  s_lshr_b32 s76, s76, 16
  s_mul_i32 s78, s76, 68
  s_sub_u32 s77, s77, s78
  s_add_u32 s76, s76, 14
  s_mov_b32 s83, 1
  s_cmp_eq_u32 s76, 15
  s_cselect_b32 s78, 0, 0
  s_add_u32 s77, s77, s78
L_t2_d1_d:
  s_cmp_lt_u32 s77, 32
  s_cbranch_scc0 L_t2_wopr
  s_lshr_b32 s74, s76, 1
  s_lshl_b32 s74, s74, 2
  s_add_u32 s74, s74, 115409152
  s_mov_b32 s79, 0
L_t2_w2:
  v_mov_b32 v2, 0
  buffer_load_dword v4, v2, s[16:19], s74 offen sc1
  s_waitcnt vmcnt(0)
  v_readfirstlane_b32 s80, v4
  s_nop 0
  s_cmp_ge_u32 s80, 16
  s_cbranch_scc1 L_t2_w2_ok
  s_sleep 8
  s_add_u32 s79, s79, 1
  s_cmp_lt_u32 s79, 400000
  s_cbranch_scc1 L_t2_w2
L_t2_w2_ok:
  s_branch L_t2_pub
L_t2_wopr:
  s_lshl_b32 s74, s76, 4
  s_add_u32 s74, s74, 115409216
  s_lshl_b32 s78, s76, 2
  s_add_u32 s78, s78, 115409472
  s_mov_b32 s81, 115410176
  s_sub_u32 s82, s77, 32
  s_and_b32 s82, s82, 3
  s_lshr_b32 s82, s82, 0
  s_mov_b32 s79, 0
L_t2_w3:
  v_mov_b32 v2, 0
  buffer_load_dwordx4 v[4:7], v2, s[16:19], s74 offen sc1
  buffer_load_dword v8, v2, s[16:19], s78 offen sc1
  buffer_load_dword v9, v2, s[16:19], s81 offen sc1
  s_waitcnt vmcnt(0)
  v_min_i32 v10, v4, v5
  v_min3_i32 v10, v10, v6, v7
  v_mov_b32 v11, v4
  s_cmp_eq_u32 s82, 1
  s_cselect_b64 vcc, -1, 0
  v_cndmask_b32 v11, v11, v5, vcc
  s_cmp_eq_u32 s82, 2
  s_cselect_b64 vcc, -1, 0
  v_cndmask_b32 v11, v11, v6, vcc
  s_cmp_eq_u32 s82, 3
  s_cselect_b64 vcc, -1, 0
  v_cndmask_b32 v11, v11, v7, vcc
  s_cmp_eq_u32 s83, 1
  s_cselect_b64 vcc, -1, 0
  v_cndmask_b32 v10, v10, v11, vcc
  v_add_u32 v8, -1, v8
  v_min3_i32 v10, v10, v8, v9
  s_nop 0
  v_readfirstlane_b32 s80, v10
  s_nop 0
  s_cmp_ge_i32 s80, 8
  s_cbranch_scc1 L_t2_pub
  s_sleep 6
  s_add_u32 s79, s79, 1
  s_cmp_lt_u32 s79, 400000
  s_cbranch_scc1 L_t2_w3
L_t2_pub:
  v_mov_b32 v2, 159744
  v_mov_b32 v3, s75
  ds_write_b32 v2, v3
  s_waitcnt lgkmcnt(0)
L_t2_wait:
  s_barrier
  v_mov_b32 v2, 159744
  ds_read_b32 v3, v2
  s_waitcnt lgkmcnt(0)
  v_readfirstlane_b32 s75, v3
  s_nop 3
  s_barrier
  s_cmp_ge_u32 s75, 710
  s_cbranch_scc1 L_worker_end
  s_cmp_lt_u32 s75, 574
  s_cbranch_scc0 L_t2_d2_s
  s_mul_i32 s76, s75, 1599
  s_lshr_b32 s76, s76, 16
  s_mul_i32 s77, s76, 41
  s_sub_u32 s77, s75, s77
  s_mov_b32 s83, 0
  s_branch L_t2_d2_d
L_t2_d2_s:
  s_sub_u32 s77, s75, 574
  s_mul_i32 s76, s77, 964
  s_lshr_b32 s76, s76, 16
  s_mul_i32 s78, s76, 68
  s_sub_u32 s77, s77, s78
  s_add_u32 s76, s76, 14
  s_mov_b32 s83, 1
  s_cmp_eq_u32 s76, 15
  s_cselect_b32 s78, 0, 0
  s_add_u32 s77, s77, s78
L_t2_d2_d:
  s_cmp_lt_u32 s77, 32
  s_cbranch_scc0 L_t2_opr
  s_lshr_b32 s81, s77, 3
  s_lshl_b32 s82, s76, 2
  s_add_u32 s81, s81, s82
  s_and_b32 s82, s77, 7
  s_lshl_b32 s82, s82, 2
  s_add_u32 s82, s82, s31
  v_and_b32 v1, 63, v0
  v_lshlrev_b32 v2, 4, v1
  s_lshl_b32 s27, s81, 5
  s_add_u32 s27, s27, s82
  s_lshl_b32 s28, s27, 13
  s_lshl_b32 s29, s27, 12
  s_add_u32 s30, s28, 51380224
  buffer_load_dwordx4 v[8:11], v2, s[16:19], s30 offen offset:0 sc1
  buffer_load_dwordx4 v[12:15], v2, s[16:19], s30 offen offset:1024 sc1
  buffer_load_dwordx4 v[16:19], v2, s[16:19], s30 offen offset:2048 sc1
  buffer_load_dwordx4 v[20:23], v2, s[16:19], s30 offen offset:3072 sc1
  s_add_u32 s30, s30, 4096
  buffer_load_dwordx4 v[24:27], v2, s[16:19], s30 offen offset:0 sc1
  buffer_load_dwordx4 v[28:31], v2, s[16:19], s30 offen offset:1024 sc1
  buffer_load_dwordx4 v[32:35], v2, s[16:19], s30 offen offset:2048 sc1
  buffer_load_dwordx4 v[36:39], v2, s[16:19], s30 offen offset:3072 sc1
  s_add_u32 s30, s28, 1048576
  buffer_load_dwordx4 v[40:43], v2, s[16:19], s30 offen offset:0 sc1
  buffer_load_dwordx4 v[44:47], v2, s[16:19], s30 offen offset:1024 sc1
  buffer_load_dwordx4 v[48:51], v2, s[16:19], s30 offen offset:2048 sc1
  buffer_load_dwordx4 v[52:55], v2, s[16:19], s30 offen offset:3072 sc1
  s_add_u32 s30, s30, 4096
  buffer_load_dwordx4 v[56:59], v2, s[16:19], s30 offen offset:0 sc1
  buffer_load_dwordx4 v[60:63], v2, s[16:19], s30 offen offset:1024 sc1
  buffer_load_dwordx4 v[64:67], v2, s[16:19], s30 offen offset:2048 sc1
  buffer_load_dwordx4 v[68:71], v2, s[16:19], s30 offen offset:3072 sc1
  s_add_u32 s30, s28, 17825792
  buffer_load_dwordx4 v[88:91], v2, s[16:19], s30 offen offset:0 sc1
  buffer_load_dwordx4 v[92:95], v2, s[16:19], s30 offen offset:1024 sc1
  buffer_load_dwordx4 v[96:99], v2, s[16:19], s30 offen offset:2048 sc1
  buffer_load_dwordx4 v[100:103], v2, s[16:19], s30 offen offset:3072 sc1
  s_add_u32 s30, s30, 4096
  buffer_load_dwordx4 v[104:107], v2, s[16:19], s30 offen offset:0 sc1
  buffer_load_dwordx4 v[108:111], v2, s[16:19], s30 offen offset:1024 sc1
  buffer_load_dwordx4 v[112:115], v2, s[16:19], s30 offen offset:2048 sc1
  buffer_load_dwordx4 v[116:119], v2, s[16:19], s30 offen offset:3072 sc1
  s_lshl_b32 s74, s81, 2
  s_add_u32 s74, s74, 115408896
  s_mov_b32 s79, 0
L_t2_sw:
  v_mov_b32 v252, 0
  buffer_load_dword v253, v252, s[16:19], s74 offen sc1
  s_waitcnt vmcnt(0)
  v_readfirstlane_b32 s80, v253
  s_nop 0
  s_cmp_ge_u32 s80, 32
  s_cbranch_scc1 L_t2_sw_ok
  s_sleep 6
  s_add_u32 s79, s79, 1
  s_cmp_lt_u32 s79, 400000
  s_cbranch_scc1 L_t2_sw
L_t2_sw_ok:
  s_add_u32 s30, s29, 34603008
  buffer_load_dwordx4 v[72:75], v2, s[16:19], s30 offen offset:0 sc1
  buffer_load_dwordx4 v[76:79], v2, s[16:19], s30 offen offset:1024 sc1
  buffer_load_dwordx4 v[80:83], v2, s[16:19], s30 offen offset:2048 sc1
  buffer_load_dwordx4 v[84:87], v2, s[16:19], s30 offen offset:3072 sc1
  s_add_u32 s30, s29, 42991616
  buffer_load_dwordx4 v[120:123], v2, s[16:19], s30 offen offset:0 sc1
  buffer_load_dwordx4 v[124:127], v2, s[16:19], s30 offen offset:1024 sc1
  buffer_load_dwordx4 v[128:131], v2, s[16:19], s30 offen offset:2048 sc1
  buffer_load_dwordx4 v[132:135], v2, s[16:19], s30 offen offset:3072 sc1
  v_mfma_f32_16x16x32_bf16 v[140:143], v[40:43], v[8:11], 0
  s_mov_b32 s26, 0x3e0293ee
  v_lshrrev_b32 v169, 4, v1
  v_lshlrev_b32 v169, 2, v169
  v_mfma_f32_16x16x32_bf16 v[140:143], v[44:47], v[12:15], v[140:143]
  s_lshl_b32 s27, s81, 7
  v_and_b32 v168, 15, v1
  v_add_u32 v170, 0, v169
  v_mfma_f32_16x16x32_bf16 v[140:143], v[48:51], v[16:19], v[140:143]
  s_lshl_b32 s28, s82, 2
  v_cmp_le_u32 s[64:65], v170, v168
  v_add_u32 v170, 1, v169
  v_mfma_f32_16x16x32_bf16 v[140:143], v[52:55], v[20:23], v[140:143]
  s_add_u32 s27, s27, s28
  v_cmp_le_u32 s[66:67], v170, v168
  v_add_u32 v170, 2, v169
  v_mfma_f32_16x16x32_bf16 v[152:155], v[40:43], v[24:27], 0
  s_lshl_b32 s27, s27, 11
  v_mov_b32 v166, 0xff800000
  v_cmp_le_u32 s[68:69], v170, v168
  v_mfma_f32_16x16x32_bf16 v[156:159], v[56:59], v[24:27], 0
  s_add_u32 s27, s27, 93323264
  v_add_u32 v170, 3, v169
  v_cndmask_b32 v140, v166, v140, s[64:65]
  v_mfma_f32_16x16x32_bf16 v[152:155], v[44:47], v[28:31], v[152:155]
  s_add_u32 s28, s27, 4096
  v_cmp_le_u32 s[70:71], v170, v168
  v_cndmask_b32 v141, v166, v141, s[66:67]
  v_mfma_f32_16x16x32_bf16 v[156:159], v[60:63], v[28:31], v[156:159]
  v_cndmask_b32 v142, v166, v142, s[68:69]
  v_cndmask_b32 v143, v166, v143, s[70:71]
  v_mfma_f32_16x16x32_bf16 v[152:155], v[48:51], v[32:35], v[152:155]
  v_mov_b32 v160, 0x3f803f80
  v_mov_b32 v161, 0x3f803f80
  v_mfma_f32_16x16x32_bf16 v[156:159], v[64:67], v[32:35], v[156:159]
  v_mov_b32 v162, 0x3f803f80
  v_mov_b32 v163, 0x3f803f80
  v_mfma_f32_16x16x32_bf16 v[152:155], v[52:55], v[36:39], v[152:155]
  v_mov_b32 v218, 0
  v_mov_b32 v219, 0
  v_mfma_f32_16x16x32_bf16 v[156:159], v[68:71], v[36:39], v[156:159]
  v_mov_b32 v164, 0x3f80
  v_mov_b32 v165, 0x3f80
  v_lshlrev_b32 v171, 7, v169
  v_lshlrev_b32 v172, 4, v168
  v_add_u32 v171, v171, v172
  s_nop 2
  v_cndmask_b32 v156, v166, v156, s[64:65]
  v_cndmask_b32 v157, v166, v157, s[66:67]
  v_cndmask_b32 v158, v166, v158, s[68:69]
  v_cndmask_b32 v159, v166, v159, s[70:71]
  s_waitcnt vmcnt(7)
  v_mfma_f32_16x16x32_bf16 v[136:139], v[72:75], v[8:11], 0
  s_waitcnt vmcnt(6)
  v_mfma_f32_16x16x32_bf16 v[136:139], v[76:79], v[12:15], v[136:139]
  s_waitcnt vmcnt(5)
  v_mfma_f32_16x16x32_bf16 v[136:139], v[80:83], v[16:19], v[136:139]
  s_waitcnt vmcnt(4)
  v_mfma_f32_16x16x32_bf16 v[136:139], v[84:87], v[20:23], v[136:139]
  v_mfma_f32_16x16x32_bf16 v[148:151], v[72:75], v[24:27], 0
  v_mfma_f32_16x16x32_bf16 v[148:151], v[76:79], v[28:31], v[148:151]
  v_max3_f32 v212, v136, v137, v140
  v_max3_f32 v212, v212, v141, v142
  v_mfma_f32_16x16x32_bf16 v[148:151], v[80:83], v[32:35], v[148:151]
  v_max_f32 v212, v212, v143
  v_mov_b32 v213, v212
  v_mfma_f32_16x16x32_bf16 v[148:151], v[84:87], v[36:39], v[148:151]
  v_permlane16_swap_b32 v212, v213
  v_max_f32 v212, v212, v213
  v_mov_b32 v213, v212
  s_nop 1
  v_permlane32_swap_b32 v212, v213
  v_max_f32 v212, v212, v213
  v_mul_f32 v212, s26, v212
  v_max3_f32 v214, v148, v149, v152
  v_fma_f32 v140, v140, s26, -v212
  v_fma_f32 v141, v141, s26, -v212
  v_fma_f32 v142, v142, s26, -v212
  v_fma_f32 v143, v143, s26, -v212
  v_max3_f32 v214, v214, v153, v154
  v_exp_f32 v140, v140
  v_exp_f32 v141, v141
  v_exp_f32 v142, v142
  v_exp_f32 v143, v143
  v_max3_f32 v214, v214, v155, v156
  v_max3_f32 v214, v214, v157, v158
  v_max_f32 v214, v214, v159
  v_cvt_pk_bf16_f32 v216, v140, v141
  v_cvt_pk_bf16_f32 v217, v142, v143
  v_mov_b32 v215, v214
  v_fma_f32 v136, v136, s26, -v212
  v_fma_f32 v137, v137, s26, -v212
  v_mfma_f32_16x16x32_bf16 v[208:211], v[160:163], v[216:219], 0
  v_exp_f32 v136, v136
  v_exp_f32 v137, v137
  v_permlane16_swap_b32 v214, v215
  v_max_f32 v214, v214, v215
  v_mfma_f32_16x16x32_bf16 v[176:179], v[88:91], v[216:219], 0
  v_mov_b32 v215, v214
  v_cvt_pk_bf16_f32 v220, v136, v136
  v_mfma_f32_16x16x32_bf16 v[180:183], v[92:95], v[216:219], 0
  v_cvt_pk_bf16_f32 v221, v137, v137
  v_permlane32_swap_b32 v214, v215
  v_mfma_f32_16x16x32_bf16 v[184:187], v[96:99], v[216:219], 0
  v_max_f32 v214, v214, v215
  v_mfma_f32_16x16x32_bf16 v[188:191], v[100:103], v[216:219], 0
  v_mul_f32 v214, s26, v214
  v_mfma_f32_16x16x32_bf16 v[192:195], v[104:107], v[216:219], 0
  v_fma_f32 v152, v152, s26, -v214
  v_fma_f32 v153, v153, s26, -v214
  v_mfma_f32_16x16x32_bf16 v[196:199], v[108:111], v[216:219], 0
  v_fma_f32 v154, v154, s26, -v214
  v_fma_f32 v155, v155, s26, -v214
  v_mfma_f32_16x16x32_bf16 v[200:203], v[112:115], v[216:219], 0
  v_fma_f32 v156, v156, s26, -v214
  v_fma_f32 v157, v157, s26, -v214
  v_mfma_f32_16x16x32_bf16 v[204:207], v[116:119], v[216:219], 0
  v_fma_f32 v158, v158, s26, -v214
  v_fma_f32 v159, v159, s26, -v214
  v_mfma_f32_16x16x16_bf16 v[208:211], v[164:165], v[220:221], v[208:211]
  v_exp_f32 v152, v152
  s_waitcnt vmcnt(3)
  v_mfma_f32_16x16x16_bf16 v[176:179], v[120:121], v[220:221], v[176:179]
  v_exp_f32 v153, v153
  v_mfma_f32_16x16x16_bf16 v[180:183], v[122:123], v[220:221], v[180:183]
  v_exp_f32 v154, v154
  s_waitcnt vmcnt(2)
  v_mfma_f32_16x16x16_bf16 v[184:187], v[124:125], v[220:221], v[184:187]
  v_exp_f32 v155, v155
  v_mfma_f32_16x16x16_bf16 v[188:191], v[126:127], v[220:221], v[188:191]
  v_exp_f32 v156, v156
  s_waitcnt vmcnt(1)
  v_mfma_f32_16x16x16_bf16 v[192:195], v[128:129], v[220:221], v[192:195]
  v_exp_f32 v157, v157
  v_mfma_f32_16x16x16_bf16 v[196:199], v[130:131], v[220:221], v[196:199]
  v_exp_f32 v158, v158
  s_waitcnt vmcnt(0)
  v_mfma_f32_16x16x16_bf16 v[200:203], v[132:133], v[220:221], v[200:203]
  v_exp_f32 v159, v159
  v_mfma_f32_16x16x16_bf16 v[204:207], v[134:135], v[220:221], v[204:207]
  v_cvt_pk_bf16_f32 v224, v152, v153
  v_cvt_pk_bf16_f32 v225, v154, v155
  v_cvt_pk_bf16_f32 v226, v156, v157
  v_cvt_pk_bf16_f32 v227, v158, v159
  v_rcp_f32 v232, v208
  v_fma_f32 v148, v148, s26, -v214
  v_fma_f32 v149, v149, s26, -v214
  v_mfma_f32_16x16x32_bf16 v[208:211], v[160:163], v[224:227], 0
  v_exp_f32 v148, v148
  v_exp_f32 v149, v149
  v_mul_f32 v176, v176, v232
  v_mul_f32 v177, v177, v232
  v_mul_f32 v178, v178, v232
  v_mul_f32 v179, v179, v232
  v_mul_f32 v180, v180, v232
  v_mul_f32 v181, v181, v232
  v_mul_f32 v182, v182, v232
  v_mul_f32 v183, v183, v232
  v_mul_f32 v184, v184, v232
  v_mul_f32 v185, v185, v232
  v_mul_f32 v186, v186, v232
  v_mul_f32 v187, v187, v232
  v_mul_f32 v188, v188, v232
  v_mul_f32 v189, v189, v232
  v_mul_f32 v190, v190, v232
  v_mul_f32 v191, v191, v232
  v_mul_f32 v192, v192, v232
  v_mul_f32 v193, v193, v232
  v_mul_f32 v194, v194, v232
  v_mul_f32 v195, v195, v232
  v_mul_f32 v196, v196, v232
  v_mul_f32 v197, v197, v232
  v_mul_f32 v198, v198, v232
  v_mul_f32 v199, v199, v232
  v_mul_f32 v200, v200, v232
  v_mul_f32 v201, v201, v232
  v_mul_f32 v202, v202, v232
  v_mul_f32 v203, v203, v232
  v_mul_f32 v204, v204, v232
  v_mul_f32 v205, v205, v232
  v_mul_f32 v206, v206, v232
  v_mul_f32 v207, v207, v232
  v_cvt_pk_bf16_f32 v236, v176, v177
  v_cvt_pk_bf16_f32 v237, v178, v179
  v_cvt_pk_bf16_f32 v238, v180, v181
  v_cvt_pk_bf16_f32 v239, v182, v183
  v_cvt_pk_bf16_f32 v240, v184, v185
  v_cvt_pk_bf16_f32 v241, v186, v187
  v_cvt_pk_bf16_f32 v242, v188, v189
  v_cvt_pk_bf16_f32 v243, v190, v191
  v_mfma_f32_16x16x32_bf16 v[176:179], v[88:91], v[224:227], 0
  buffer_store_dwordx4 v[236:239], v171, s[16:19], s27 offen offset:0 sc1
  v_mfma_f32_16x16x32_bf16 v[180:183], v[92:95], v[224:227], 0
  buffer_store_dwordx4 v[240:243], v171, s[16:19], s27 offen offset:2048 sc1
  v_cvt_pk_bf16_f32 v244, v192, v193
  v_cvt_pk_bf16_f32 v245, v194, v195
  v_cvt_pk_bf16_f32 v246, v196, v197
  v_cvt_pk_bf16_f32 v247, v198, v199
  v_mfma_f32_16x16x32_bf16 v[184:187], v[96:99], v[224:227], 0
  buffer_store_dwordx4 v[244:247], v171, s[16:19], s28 offen offset:0 sc1
  v_mfma_f32_16x16x32_bf16 v[188:191], v[100:103], v[224:227], 0
  v_cvt_pk_bf16_f32 v248, v200, v201
  v_cvt_pk_bf16_f32 v249, v202, v203
  v_cvt_pk_bf16_f32 v250, v204, v205
  v_cvt_pk_bf16_f32 v251, v206, v207
  v_mfma_f32_16x16x32_bf16 v[192:195], v[104:107], v[224:227], 0
  buffer_store_dwordx4 v[248:251], v171, s[16:19], s28 offen offset:2048 sc1
  v_mfma_f32_16x16x32_bf16 v[196:199], v[108:111], v[224:227], 0
  v_cvt_pk_bf16_f32 v228, v148, v148
  v_cvt_pk_bf16_f32 v229, v149, v149
  v_mfma_f32_16x16x32_bf16 v[200:203], v[112:115], v[224:227], 0
  v_mfma_f32_16x16x32_bf16 v[204:207], v[116:119], v[224:227], 0
  v_mfma_f32_16x16x16_bf16 v[208:211], v[164:165], v[228:229], v[208:211]
  v_mfma_f32_16x16x16_bf16 v[176:179], v[120:121], v[228:229], v[176:179]
  v_mfma_f32_16x16x16_bf16 v[180:183], v[122:123], v[228:229], v[180:183]
  v_rcp_f32 v233, v208
  v_mfma_f32_16x16x16_bf16 v[184:187], v[124:125], v[228:229], v[184:187]
  v_mul_f32 v176, v176, v233
  v_mul_f32 v177, v177, v233
  v_mfma_f32_16x16x16_bf16 v[188:191], v[126:127], v[228:229], v[188:191]
  v_mul_f32 v178, v178, v233
  v_mul_f32 v179, v179, v233
  v_mfma_f32_16x16x16_bf16 v[192:195], v[128:129], v[228:229], v[192:195]
  v_mul_f32 v180, v180, v233
  v_mul_f32 v181, v181, v233
  v_mfma_f32_16x16x16_bf16 v[196:199], v[130:131], v[228:229], v[196:199]
  v_mul_f32 v182, v182, v233
  v_mul_f32 v183, v183, v233
  v_mfma_f32_16x16x16_bf16 v[200:203], v[132:133], v[228:229], v[200:203]
  v_mul_f32 v184, v184, v233
  v_mul_f32 v185, v185, v233
  v_mfma_f32_16x16x16_bf16 v[204:207], v[134:135], v[228:229], v[204:207]
  v_mul_f32 v186, v186, v233
  v_mul_f32 v187, v187, v233
  v_mul_f32 v188, v188, v233
  v_mul_f32 v189, v189, v233
  v_mul_f32 v190, v190, v233
  v_mul_f32 v191, v191, v233
  v_mul_f32 v192, v192, v233
  v_mul_f32 v193, v193, v233
  v_mul_f32 v194, v194, v233
  v_mul_f32 v195, v195, v233
  v_mul_f32 v196, v196, v233
  v_mul_f32 v197, v197, v233
  v_mul_f32 v198, v198, v233
  v_mul_f32 v199, v199, v233
  v_mul_f32 v200, v200, v233
  v_mul_f32 v201, v201, v233
  v_mul_f32 v202, v202, v233
  v_mul_f32 v203, v203, v233
  v_mul_f32 v204, v204, v233
  v_mul_f32 v205, v205, v233
  v_mul_f32 v206, v206, v233
  v_mul_f32 v207, v207, v233
  v_cvt_pk_bf16_f32 v236, v176, v177
  v_cvt_pk_bf16_f32 v237, v178, v179
  v_cvt_pk_bf16_f32 v238, v180, v181
  v_cvt_pk_bf16_f32 v239, v182, v183
  v_cvt_pk_bf16_f32 v240, v184, v185
  v_cvt_pk_bf16_f32 v241, v186, v187
  v_cvt_pk_bf16_f32 v242, v188, v189
  v_cvt_pk_bf16_f32 v243, v190, v191
  v_cvt_pk_bf16_f32 v244, v192, v193
  v_cvt_pk_bf16_f32 v245, v194, v195
  v_cvt_pk_bf16_f32 v246, v196, v197
  v_cvt_pk_bf16_f32 v247, v198, v199
  v_cvt_pk_bf16_f32 v248, v200, v201
  v_cvt_pk_bf16_f32 v249, v202, v203
  v_cvt_pk_bf16_f32 v250, v204, v205
  v_cvt_pk_bf16_f32 v251, v206, v207
  buffer_store_dwordx4 v[236:239], v171, s[16:19], s27 offen offset:256 sc1
  buffer_store_dwordx4 v[240:243], v171, s[16:19], s27 offen offset:2304 sc1
  buffer_store_dwordx4 v[244:247], v171, s[16:19], s28 offen offset:256 sc1
  buffer_store_dwordx4 v[248:251], v171, s[16:19], s28 offen offset:2304 sc1
  s_waitcnt vmcnt(0)
  s_barrier
  s_cmp_lg_u32 s31, 0
  s_cbranch_scc1 L_t2_next
  s_and_b32 s78, s77, 7
  s_lshr_b32 s78, s78, 1
  s_lshl_b32 s74, s76, 2
  s_add_u32 s74, s74, s78
  s_lshl_b32 s74, s74, 2
  s_add_u32 s74, s74, 115409216
  s_mov_b64 s[66:67], exec
  s_mov_b64 exec, 1
  v_mov_b32 v2, 0
  v_mov_b32 v3, 1
  buffer_atomic_add v3, v2, s[16:19], s74 offen sc1
  s_waitcnt vmcnt(0)
  s_mov_b64 exec, s[66:67]
  s_branch L_t2_next
L_t2_opr:
  s_cmp_eq_u32 s83, 1
  s_cbranch_scc1 L_t2_oprs
  s_sub_u32 s78, s77, 32
  s_mul_i32 s77, s76, 9
  s_add_u32 s77, s77, s78
  s_mov_b32 s90, 0
  s_mul_i32 s34, s77, 7282
  s_lshr_b32 s34, s34, 16
  s_mul_i32 s27, s34, 9
  s_sub_u32 s35, s77, s27
  s_mov_b32 s8, s16
  s_mov_b32 s9, s17
  s_mov_b32 s10, 0x10000000
  s_mov_b32 s11, 0x00020000
  s_mov_b32 s12, s56
  s_mov_b32 s13, s57
  s_mov_b32 s14, 4718592
  s_mov_b32 s15, 0x00020000
  s_lshl_b32 s27, s34, 2
  s_add_u32 s27, s27, s31
  s_mul_i32 s20, s27, 262144
  s_add_u32 s20, s20, 93323264
  s_lshl_b32 s24, s31, 12
  s_lshr_b32 s27, s31, 1
  s_lshl_b32 s27, s27, 5
  s_and_b32 s28, s31, 1
  s_lshl_b32 s28, s28, 3
  s_add_u32 s27, s27, s28
  s_mul_i32 s21, s27, 1152
  s_lshl_b32 s27, s35, 7
  s_add_u32 s21, s21, s27
  s_lshl_b32 s25, s31, 11
  s_add_u32 s25, s25, 16384
  s_mov_b32 s37, 64
  v_and_b32 v1, 63, v0
  s_lshr_b32 s27, s31, 1
  s_lshl_b32 s27, s27, 13
  v_lshlrev_b32 v45, 4, v1
  v_add_u32 v40, s27, v45
  v_lshrrev_b32 v2, 4, v1
  v_and_b32 v3, 15, v1
  v_lshrrev_b32 v4, 2, v3
  v_and_b32 v5, 3, v3
  v_lshrrev_b32 v6, 1, v2
  v_lshlrev_b32 v6, 3, v6
  v_add_u32 v6, v6, v4
  v_lshlrev_b32 v6, 7, v6
  v_and_b32 v7, 1, v2
  v_lshlrev_b32 v7, 1, v7
  v_lshrrev_b32 v8, 1, v5
  v_add_u32 v7, v7, v8
  s_and_b32 s27, s31, 1
  s_lshl_b32 s27, s27, 2
  v_add_u32 v7, s27, v7
  v_lshrrev_b32 v8, 1, v4
  v_lshlrev_b32 v8, 2, v8
  v_xor_b32 v7, v7, v8
  v_lshlrev_b32 v7, 4, v7
  v_and_b32 v8, 1, v5
  v_lshlrev_b32 v8, 3, v8
  v_add3_u32 v6, v6, v7, v8
  v_add_u32 v44, 16384, v6
  v_lshrrev_b32 v4, 3, v1
  v_lshrrev_b32 v5, 2, v4
  v_lshlrev_b32 v5, 4, v5
  v_and_b32 v6, 3, v4
  v_add_u32 v5, v5, v6
  v_mul_u32_u24 v5, 1152, v5
  v_bfe_u32 v6, v4, 1, 1
  v_lshlrev_b32 v6, 2, v6
  v_and_b32 v7, 7, v1
  v_xor_b32 v6, v6, v7
  v_lshlrev_b32 v6, 4, v6
  v_add_u32 v47, v5, v6
  v_and_b32 v1, 63, v0
  s_cmp_eq_u32 s31, 1
  s_cbranch_scc1 L_b_twk1f
  s_mov_b32 s84, s8
  s_mov_b32 s85, s9
  s_mov_b32 s86, s10
  s_mov_b32 s87, 0x00020000
  s_mul_i32 s27, s35, 29
  v_add_u32 v2, s27, v1
  v_lshrrev_b32 v3, 6, v2
  v_mul_u32_u24 v3, 16384, v3
  v_lshlrev_b32 v3, 4, v3
  v_and_b32 v4, 63, v2
  v_lshlrev_b32 v4, 6, v4
  v_add_u32 v3, v3, v4
  v_mov_b32 v5, 0x40000000
  v_cmp_gt_u32 vcc, 29, v1
  s_nop 1
  v_cndmask_b32 v3, v5, v3, vcc
  v_cmp_gt_u32 vcc, 256, v2
  s_nop 1
  v_cndmask_b32 v49, v5, v3, vcc
  s_lshl_b32 s27, s34, 2
  s_mul_i32 s88, s27, 262144
  s_add_u32 s88, s88, 93339648
  s_mov_b32 s89, 4096
  s_cmp_eq_u32 s31, 0
  s_cselect_b32 s88, s88, 0x40000000
  s_cselect_b32 s89, s89, 0
  s_branch L_b_tdk1f
L_b_twk1f:
  s_mov_b32 s84, s12
  s_mov_b32 s85, s13
  s_mov_b32 s86, s14
  s_mov_b32 s87, 0x00020000
  v_lshrrev_b32 v2, 1, v1
  v_mul_u32_u24 v2, 1152, v2
  v_and_b32 v3, 1, v1
  v_lshlrev_b32 v3, 6, v3
  v_add_u32 v49, v2, v3
  s_lshl_b32 s27, s90, 5
  s_add_u32 s27, s27, 256
  s_mul_i32 s88, s27, 1152
  s_lshl_b32 s27, s35, 7
  s_add_u32 s88, s88, s27
  s_mov_b32 s89, 73728
L_b_tdk1f:
  s_mov_b32 s32, 0
  s_mov_b32 s39, 0
  s_add_u32 m0, s24, s32
  s_mov_b32 s27, s20
  buffer_load_dwordx4 v45, s[8:11], s27 offen sc1 lds
  s_add_u32 m0, m0, 1024
  s_add_u32 s27, s27, 1024
  buffer_load_dwordx4 v45, s[8:11], s27 offen sc1 lds
  s_add_u32 m0, m0, 1024
  s_add_u32 s27, s27, 1024
  buffer_load_dwordx4 v45, s[8:11], s27 offen sc1 lds
  s_add_u32 m0, m0, 1024
  s_add_u32 s27, s27, 1024
  buffer_load_dwordx4 v45, s[8:11], s27 offen sc1 lds
  s_add_u32 m0, s25, s32
  s_nop 0
  buffer_load_dwordx4 v47, s[12:15], s21 offen lds
  s_add_u32 m0, m0, 1024
  s_add_u32 s27, s21, 4608
  buffer_load_dwordx4 v47, s[12:15], s27 offen lds
  s_add_u32 s20, s20, 4096
  s_add_u32 s21, s21, 73728
  s_add_u32 s32, s32, 24576
  s_cmp_eq_u32 s32, 98304
  s_cselect_b32 s32, 0, s32
  s_add_u32 m0, s24, s32
  s_mov_b32 s27, s20
  buffer_load_dwordx4 v45, s[8:11], s27 offen sc1 lds
  s_add_u32 m0, m0, 1024
  s_add_u32 s27, s27, 1024
  buffer_load_dwordx4 v45, s[8:11], s27 offen sc1 lds
  s_add_u32 m0, m0, 1024
  s_add_u32 s27, s27, 1024
  buffer_load_dwordx4 v45, s[8:11], s27 offen sc1 lds
  s_add_u32 m0, m0, 1024
  s_add_u32 s27, s27, 1024
  buffer_load_dwordx4 v45, s[8:11], s27 offen sc1 lds
  s_add_u32 m0, s25, s32
  s_nop 0
  buffer_load_dwordx4 v47, s[12:15], s21 offen lds
  s_add_u32 m0, m0, 1024
  s_add_u32 s27, s21, 4608
  buffer_load_dwordx4 v47, s[12:15], s27 offen lds
  s_add_u32 s20, s20, 4096
  s_add_u32 s21, s21, 73728
  s_add_u32 s32, s32, 24576
  s_cmp_eq_u32 s32, 98304
  s_cselect_b32 s32, 0, s32
  s_add_u32 m0, s24, s32
  s_mov_b32 s27, s20
  buffer_load_dwordx4 v45, s[8:11], s27 offen sc1 lds
  s_add_u32 m0, m0, 1024
  s_add_u32 s27, s27, 1024
  buffer_load_dwordx4 v45, s[8:11], s27 offen sc1 lds
  s_add_u32 m0, m0, 1024
  s_add_u32 s27, s27, 1024
  buffer_load_dwordx4 v45, s[8:11], s27 offen sc1 lds
  s_add_u32 m0, m0, 1024
  s_add_u32 s27, s27, 1024
  buffer_load_dwordx4 v45, s[8:11], s27 offen sc1 lds
  s_add_u32 m0, s25, s32
  s_nop 0
  buffer_load_dwordx4 v47, s[12:15], s21 offen lds
  s_add_u32 m0, m0, 1024
  s_add_u32 s27, s21, 4608
  buffer_load_dwordx4 v47, s[12:15], s27 offen lds
  s_add_u32 s20, s20, 4096
  s_add_u32 s21, s21, 73728
  s_add_u32 s32, s32, 24576
  s_cmp_eq_u32 s32, 98304
  s_cselect_b32 s32, 0, s32
  s_add_u32 m0, s24, s32
  s_mov_b32 s27, s20
  buffer_load_dwordx4 v45, s[8:11], s27 offen sc1 lds
  s_add_u32 m0, m0, 1024
  s_add_u32 s27, s27, 1024
  buffer_load_dwordx4 v45, s[8:11], s27 offen sc1 lds
  s_add_u32 m0, m0, 1024
  s_add_u32 s27, s27, 1024
  buffer_load_dwordx4 v45, s[8:11], s27 offen sc1 lds
  s_add_u32 m0, m0, 1024
  s_add_u32 s27, s27, 1024
  buffer_load_dwordx4 v45, s[8:11], s27 offen sc1 lds
  s_add_u32 m0, s25, s32
  s_nop 0
  buffer_load_dwordx4 v47, s[12:15], s21 offen lds
  s_add_u32 m0, m0, 1024
  s_add_u32 s27, s21, 4608
  buffer_load_dwordx4 v47, s[12:15], s27 offen lds
  s_add_u32 s20, s20, 4096
  s_add_u32 s21, s21, 73728
  s_add_u32 s32, s32, 24576
  s_cmp_eq_u32 s32, 98304
  s_cselect_b32 s32, 0, s32
  s_waitcnt vmcnt(18)
  s_barrier
  ds_read_b128 v[16:19], v40 offset:0
  ds_read_b128 v[20:23], v40 offset:4096
  ds_read_b64_tr_b16 v[32:33], v44 offset:0
  ds_read_b64_tr_b16 v[34:35], v44 offset:512
  ds_read_b128 v[24:27], v40 offset:1024
  s_waitcnt lgkmcnt(1)
  v_mfma_f32_32x32x16_bf16 a[0:15], v[32:35], v[16:19], 0
  ds_read_b128 v[28:31], v40 offset:5120
  ds_read_b64_tr_b16 v[36:37], v44 offset:2048
  v_mfma_f32_32x32x16_bf16 a[16:31], v[32:35], v[20:23], 0
  ds_read_b64_tr_b16 v[38:39], v44 offset:2560
  ds_read_b128 v[16:19], v40 offset:2048
  ds_read_b128 v[20:23], v40 offset:6144
  ds_read_b64_tr_b16 v[32:33], v44 offset:4096
  ds_read_b64_tr_b16 v[34:35], v44 offset:4608
  s_waitcnt lgkmcnt(4)
  v_mfma_f32_32x32x16_bf16 a[0:15], v[36:39], v[24:27], a[0:15]
  ds_read_b128 v[24:27], v40 offset:3072
  v_mfma_f32_32x32x16_bf16 a[16:31], v[36:39], v[28:31], a[16:31]
  ds_read_b128 v[28:31], v40 offset:7168
  ds_read_b64_tr_b16 v[36:37], v44 offset:6144
  ds_read_b64_tr_b16 v[38:39], v44 offset:6656
  s_waitcnt lgkmcnt(4)
  v_mfma_f32_32x32x16_bf16 a[0:15], v[32:35], v[16:19], a[0:15]
  v_mfma_f32_32x32x16_bf16 a[16:31], v[32:35], v[20:23], a[16:31]
  s_sub_u32 s26, s37, 4
L_kbk1f:
  s_waitcnt vmcnt(12) lgkmcnt(0)
  s_barrier
  s_add_u32 s39, s39, 24576
  s_cmp_eq_u32 s39, 98304
  s_mov_b32 s38, 24576
  s_cselect_b32 s38, 0xfffee000, s38
  v_add_u32 v40, s38, v40
  v_add_u32 v44, s38, v44
  ds_read_b128 v[16:19], v40 offset:0
  v_mfma_f32_32x32x16_bf16 a[0:15], v[36:39], v[24:27], a[0:15]
  s_cselect_b32 s39, 0, s39
  s_add_u32 m0, s24, s32
  ds_read_b128 v[20:23], v40 offset:4096
  s_mov_b32 s27, s20
  buffer_load_dwordx4 v45, s[8:11], s27 offen sc1 lds
  ds_read_b64_tr_b16 v[32:33], v44 offset:0
  v_mfma_f32_32x32x16_bf16 a[16:31], v[36:39], v[28:31], a[16:31]
  ds_read_b64_tr_b16 v[34:35], v44 offset:512
  s_add_u32 m0, m0, 1024
  ds_read_b128 v[24:27], v40 offset:1024
  s_add_u32 s27, s27, 1024
  buffer_load_dwordx4 v45, s[8:11], s27 offen sc1 lds
  ds_read_b128 v[28:31], v40 offset:5120
  s_add_u32 m0, m0, 1024
  s_add_u32 s27, s27, 1024
  buffer_load_dwordx4 v45, s[8:11], s27 offen sc1 lds
  ds_read_b64_tr_b16 v[36:37], v44 offset:2048
  s_add_u32 m0, m0, 1024
  ds_read_b64_tr_b16 v[38:39], v44 offset:2560
  s_add_u32 s27, s27, 1024
  s_waitcnt lgkmcnt(4)
  v_mfma_f32_32x32x16_bf16 a[0:15], v[32:35], v[16:19], a[0:15]
  ds_read_b128 v[16:19], v40 offset:2048
  buffer_load_dwordx4 v45, s[8:11], s27 offen sc1 lds
  s_add_u32 m0, s25, s32
  v_mfma_f32_32x32x16_bf16 a[16:31], v[32:35], v[20:23], a[16:31]
  ds_read_b128 v[20:23], v40 offset:6144
  ds_read_b64_tr_b16 v[32:33], v44 offset:4096
  ds_read_b64_tr_b16 v[34:35], v44 offset:4608
  s_waitcnt lgkmcnt(4)
  v_mfma_f32_32x32x16_bf16 a[0:15], v[36:39], v[24:27], a[0:15]
  buffer_load_dwordx4 v47, s[12:15], s21 offen lds
  s_add_u32 m0, m0, 1024
  s_add_u32 s27, s21, 4608
  s_add_u32 s20, s20, 4096
  v_mfma_f32_32x32x16_bf16 a[16:31], v[36:39], v[28:31], a[16:31]
  s_add_u32 s21, s21, 73728
  s_add_u32 s32, s32, 24576
  s_cmp_eq_u32 s32, 98304
  s_cselect_b32 s32, 0, s32
  ds_read_b128 v[24:27], v40 offset:3072
  buffer_load_dwordx4 v47, s[12:15], s27 offen lds
  ds_read_b128 v[28:31], v40 offset:7168
  s_waitcnt lgkmcnt(2)
  v_mfma_f32_32x32x16_bf16 a[0:15], v[32:35], v[16:19], a[0:15]
  ds_read_b64_tr_b16 v[36:37], v44 offset:6144
  ds_read_b64_tr_b16 v[38:39], v44 offset:6656
  v_mfma_f32_32x32x16_bf16 a[16:31], v[32:35], v[20:23], a[16:31]
  s_sub_u32 s26, s26, 1
  s_cmp_lg_u32 s26, 0
  s_cbranch_scc1 L_kbk1f
  s_waitcnt vmcnt(12) lgkmcnt(0)
  s_barrier
  s_add_u32 s39, s39, 24576
  s_cmp_eq_u32 s39, 98304
  s_mov_b32 s38, 24576
  s_cselect_b32 s38, 0xfffee000, s38
  v_add_u32 v40, s38, v40
  v_add_u32 v44, s38, v44
  ds_read_b128 v[16:19], v40 offset:0
  v_mfma_f32_32x32x16_bf16 a[0:15], v[36:39], v[24:27], a[0:15]
  s_cselect_b32 s39, 0, s39
  ds_read_b128 v[20:23], v40 offset:4096
  ds_read_b64_tr_b16 v[32:33], v44 offset:0
  v_mfma_f32_32x32x16_bf16 a[16:31], v[36:39], v[28:31], a[16:31]
  ds_read_b64_tr_b16 v[34:35], v44 offset:512
  ds_read_b128 v[24:27], v40 offset:1024
  ds_read_b128 v[28:31], v40 offset:5120
  ds_read_b64_tr_b16 v[36:37], v44 offset:2048
  ds_read_b64_tr_b16 v[38:39], v44 offset:2560
  s_waitcnt lgkmcnt(4)
  v_mfma_f32_32x32x16_bf16 a[0:15], v[32:35], v[16:19], a[0:15]
  ds_read_b128 v[16:19], v40 offset:2048
  v_mfma_f32_32x32x16_bf16 a[16:31], v[32:35], v[20:23], a[16:31]
  ds_read_b128 v[20:23], v40 offset:6144
  ds_read_b64_tr_b16 v[32:33], v44 offset:4096
  ds_read_b64_tr_b16 v[34:35], v44 offset:4608
  s_waitcnt lgkmcnt(4)
  v_mfma_f32_32x32x16_bf16 a[0:15], v[36:39], v[24:27], a[0:15]
  ds_read_b128 v[24:27], v40 offset:3072
  v_mfma_f32_32x32x16_bf16 a[16:31], v[36:39], v[28:31], a[16:31]
  ds_read_b128 v[28:31], v40 offset:7168
  ds_read_b64_tr_b16 v[36:37], v44 offset:6144
  ds_read_b64_tr_b16 v[38:39], v44 offset:6656
  s_waitcnt lgkmcnt(4)
  v_mfma_f32_32x32x16_bf16 a[0:15], v[32:35], v[16:19], a[0:15]
  v_mfma_f32_32x32x16_bf16 a[16:31], v[32:35], v[20:23], a[16:31]
  s_waitcnt vmcnt(6) lgkmcnt(0)
  s_barrier
  s_add_u32 s39, s39, 24576
  s_cmp_eq_u32 s39, 98304
  s_mov_b32 s38, 24576
  s_cselect_b32 s38, 0xfffee000, s38
  v_add_u32 v40, s38, v40
  v_add_u32 v44, s38, v44
  ds_read_b128 v[16:19], v40 offset:0
  v_mfma_f32_32x32x16_bf16 a[0:15], v[36:39], v[24:27], a[0:15]
  s_cselect_b32 s39, 0, s39
  ds_read_b128 v[20:23], v40 offset:4096
  ds_read_b64_tr_b16 v[32:33], v44 offset:0
  v_mfma_f32_32x32x16_bf16 a[16:31], v[36:39], v[28:31], a[16:31]
  ds_read_b64_tr_b16 v[34:35], v44 offset:512
  ds_read_b128 v[24:27], v40 offset:1024
  ds_read_b128 v[28:31], v40 offset:5120
  ds_read_b64_tr_b16 v[36:37], v44 offset:2048
  ds_read_b64_tr_b16 v[38:39], v44 offset:2560
  s_waitcnt lgkmcnt(4)
  v_mfma_f32_32x32x16_bf16 a[0:15], v[32:35], v[16:19], a[0:15]
  ds_read_b128 v[16:19], v40 offset:2048
  v_mfma_f32_32x32x16_bf16 a[16:31], v[32:35], v[20:23], a[16:31]
  ds_read_b128 v[20:23], v40 offset:6144
  ds_read_b64_tr_b16 v[32:33], v44 offset:4096
  ds_read_b64_tr_b16 v[34:35], v44 offset:4608
  s_waitcnt lgkmcnt(4)
  v_mfma_f32_32x32x16_bf16 a[0:15], v[36:39], v[24:27], a[0:15]
  ds_read_b128 v[24:27], v40 offset:3072
  v_mfma_f32_32x32x16_bf16 a[16:31], v[36:39], v[28:31], a[16:31]
  ds_read_b128 v[28:31], v40 offset:7168
  ds_read_b64_tr_b16 v[36:37], v44 offset:6144
  ds_read_b64_tr_b16 v[38:39], v44 offset:6656
  s_waitcnt lgkmcnt(4)
  v_mfma_f32_32x32x16_bf16 a[0:15], v[32:35], v[16:19], a[0:15]
  v_mfma_f32_32x32x16_bf16 a[16:31], v[32:35], v[20:23], a[16:31]
  s_waitcnt vmcnt(0) lgkmcnt(0)
  s_barrier
  s_add_u32 s39, s39, 24576
  s_cmp_eq_u32 s39, 98304
  s_mov_b32 s38, 24576
  s_cselect_b32 s38, 0xfffee000, s38
  v_add_u32 v40, s38, v40
  v_add_u32 v44, s38, v44
  ds_read_b128 v[16:19], v40 offset:0
  v_mfma_f32_32x32x16_bf16 a[0:15], v[36:39], v[24:27], a[0:15]
  s_cselect_b32 s39, 0, s39
  ds_read_b128 v[20:23], v40 offset:4096
  ds_read_b64_tr_b16 v[32:33], v44 offset:0
  v_mfma_f32_32x32x16_bf16 a[16:31], v[36:39], v[28:31], a[16:31]
  ds_read_b64_tr_b16 v[34:35], v44 offset:512
  ds_read_b128 v[24:27], v40 offset:1024
  ds_read_b128 v[28:31], v40 offset:5120
  ds_read_b64_tr_b16 v[36:37], v44 offset:2048
  ds_read_b64_tr_b16 v[38:39], v44 offset:2560
  s_waitcnt lgkmcnt(4)
  v_mfma_f32_32x32x16_bf16 a[0:15], v[32:35], v[16:19], a[0:15]
  ds_read_b128 v[16:19], v40 offset:2048
  v_mfma_f32_32x32x16_bf16 a[16:31], v[32:35], v[20:23], a[16:31]
  ds_read_b128 v[20:23], v40 offset:6144
  ds_read_b64_tr_b16 v[32:33], v44 offset:4096
  ds_read_b64_tr_b16 v[34:35], v44 offset:4608
  s_waitcnt lgkmcnt(4)
  v_mfma_f32_32x32x16_bf16 a[0:15], v[36:39], v[24:27], a[0:15]
  ds_read_b128 v[24:27], v40 offset:3072
  v_mfma_f32_32x32x16_bf16 a[16:31], v[36:39], v[28:31], a[16:31]
  ds_read_b128 v[28:31], v40 offset:7168
  ds_read_b64_tr_b16 v[36:37], v44 offset:6144
  ds_read_b64_tr_b16 v[38:39], v44 offset:6656
  s_waitcnt lgkmcnt(4)
  v_mfma_f32_32x32x16_bf16 a[0:15], v[32:35], v[16:19], a[0:15]
  v_mfma_f32_32x32x16_bf16 a[16:31], v[32:35], v[20:23], a[16:31]
  s_waitcnt lgkmcnt(0)
  v_mfma_f32_32x32x16_bf16 a[0:15], v[36:39], v[24:27], a[0:15]
  v_mfma_f32_32x32x16_bf16 a[16:31], v[36:39], v[28:31], a[16:31]
  s_lshl_b32 s29, s77, 15
  s_lshl_b32 s27, s31, 13
  s_add_u32 s29, s29, s27
  s_add_u32 s29, s29, 110100480
  v_and_b32 v1, 63, v0
  v_lshlrev_b32 v2, 4, v1
  s_add_u32 s30, s29, 4096
  s_lshl_b32 s27, s34, 7
  s_lshr_b32 s28, s31, 1
  v_and_b32 v3, 31, v1
  buffer_load_dwordx4 v[48:51], v2, s[16:19], s29 offen offset:0 sc1
  s_lshl_b32 s28, s28, 6
  buffer_load_dwordx4 v[52:55], v2, s[16:19], s29 offen offset:1024 sc1
  buffer_load_dwordx4 v[56:59], v2, s[16:19], s29 offen offset:2048 sc1
  s_add_u32 s27, s27, s28
  buffer_load_dwordx4 v[60:63], v2, s[16:19], s29 offen offset:3072 sc1
  v_lshlrev_b32 v4, 2, v3
  buffer_load_dwordx4 v[64:67], v2, s[16:19], s30 offen offset:0 sc1
  s_lshl_b32 s28, s27, 2
  buffer_load_dwordx4 v[68:71], v2, s[16:19], s30 offen offset:1024 sc1
  buffer_load_dwordx4 v[72:75], v2, s[16:19], s30 offen offset:2048 sc1
  s_add_u32 s28, s28, 115343360
  buffer_load_dwordx4 v[76:79], v2, s[16:19], s30 offen offset:3072 sc1
  buffer_load_dword v80, v4, s[16:19], s28 offen sc1
  buffer_load_dword v81, v4, s[16:19], s28 offen offset:128 sc1
  v_accvgpr_read_b32 v84, a0
  v_accvgpr_read_b32 v85, a1
  v_accvgpr_read_b32 v86, a2
  v_accvgpr_read_b32 v87, a3
  v_accvgpr_read_b32 v88, a4
  v_accvgpr_read_b32 v89, a5
  v_accvgpr_read_b32 v90, a6
  v_accvgpr_read_b32 v91, a7
  v_accvgpr_read_b32 v100, a16
  v_accvgpr_read_b32 v101, a17
  v_accvgpr_read_b32 v92, a8
  v_accvgpr_read_b32 v93, a9
  v_accvgpr_read_b32 v94, a10
  v_accvgpr_read_b32 v95, a11
  v_accvgpr_read_b32 v96, a12
  v_accvgpr_read_b32 v97, a13
  v_accvgpr_read_b32 v98, a14
  v_accvgpr_read_b32 v99, a15
  v_accvgpr_read_b32 v102, a18
  v_accvgpr_read_b32 v103, a19
  v_accvgpr_read_b32 v104, a20
  v_accvgpr_read_b32 v105, a21
  v_accvgpr_read_b32 v106, a22
  v_accvgpr_read_b32 v107, a23
  v_accvgpr_read_b32 v108, a24
  v_accvgpr_read_b32 v109, a25
  v_accvgpr_read_b32 v110, a26
  v_accvgpr_read_b32 v111, a27
  v_accvgpr_read_b32 v112, a28
  v_accvgpr_read_b32 v113, a29
  v_accvgpr_read_b32 v114, a30
  v_accvgpr_read_b32 v115, a31
  v_lshrrev_b32 v6, 5, v1
  v_mul_u32_u24 v5, 1152, v3
  v_lshlrev_b32 v6, 4, v6
  s_mul_i32 s27, s27, 1152
  s_lshl_b32 s28, s35, 7
  s_add_u32 s27, s27, s28
  s_and_b32 s28, s31, 1
  v_add_u32 v5, v5, v6
  s_lshl_b32 s28, s28, 6
  s_mov_b32 s8, s60
  s_mov_b32 s9, s61
  s_mov_b32 s10, 2359296
  s_add_u32 s27, s27, s28
  s_add_u32 s28, s27, 36864
  s_waitcnt vmcnt(9)
  v_sub_f32 v84, v84, v48
  v_sub_f32 v85, v85, v49
  v_sub_f32 v86, v86, v50
  v_sub_f32 v87, v87, v51
  s_waitcnt vmcnt(8)
  v_sub_f32 v88, v88, v52
  v_sub_f32 v89, v89, v53
  v_sub_f32 v90, v90, v54
  v_sub_f32 v91, v91, v55
  s_waitcnt vmcnt(7)
  v_sub_f32 v92, v92, v56
  v_sub_f32 v93, v93, v57
  v_sub_f32 v94, v94, v58
  v_sub_f32 v95, v95, v59
  s_waitcnt vmcnt(6)
  v_sub_f32 v96, v96, v60
  v_sub_f32 v97, v97, v61
  v_sub_f32 v98, v98, v62
  v_sub_f32 v99, v99, v63
  s_waitcnt vmcnt(5)
  v_sub_f32 v100, v100, v64
  v_sub_f32 v101, v101, v65
  v_sub_f32 v102, v102, v66
  v_sub_f32 v103, v103, v67
  s_waitcnt vmcnt(4)
  v_sub_f32 v104, v104, v68
  v_sub_f32 v105, v105, v69
  v_sub_f32 v106, v106, v70
  v_sub_f32 v107, v107, v71
  s_waitcnt vmcnt(3)
  v_sub_f32 v108, v108, v72
  v_sub_f32 v109, v109, v73
  v_sub_f32 v110, v110, v74
  v_sub_f32 v111, v111, v75
  s_waitcnt vmcnt(2)
  v_sub_f32 v112, v112, v76
  v_sub_f32 v113, v113, v77
  v_sub_f32 v114, v114, v78
  v_sub_f32 v115, v115, v79
  s_waitcnt vmcnt(1)
  v_fma_f32 v84, v84, v80, v48
  v_fma_f32 v85, v85, v80, v49
  v_fma_f32 v86, v86, v80, v50
  v_fma_f32 v87, v87, v80, v51
  v_fma_f32 v88, v88, v80, v52
  v_fma_f32 v89, v89, v80, v53
  v_fma_f32 v90, v90, v80, v54
  v_fma_f32 v91, v91, v80, v55
  s_waitcnt vmcnt(0)
  v_fma_f32 v100, v100, v81, v64
  v_fma_f32 v101, v101, v81, v65
  v_fma_f32 v92, v92, v80, v56
  v_fma_f32 v93, v93, v80, v57
  v_fma_f32 v94, v94, v80, v58
  v_fma_f32 v95, v95, v80, v59
  v_fma_f32 v96, v96, v80, v60
  v_fma_f32 v97, v97, v80, v61
  v_fma_f32 v98, v98, v80, v62
  v_fma_f32 v99, v99, v80, v63
  v_fma_f32 v102, v102, v81, v66
  v_fma_f32 v103, v103, v81, v67
  v_fma_f32 v104, v104, v81, v68
  v_fma_f32 v105, v105, v81, v69
  v_fma_f32 v106, v106, v81, v70
  v_fma_f32 v107, v107, v81, v71
  v_cvt_pk_bf16_f32 v84, v84, v85
  v_fma_f32 v108, v108, v81, v72
  v_fma_f32 v109, v109, v81, v73
  v_fma_f32 v110, v110, v81, v74
  v_fma_f32 v111, v111, v81, v75
  v_fma_f32 v112, v112, v81, v76
  v_fma_f32 v113, v113, v81, v77
  v_fma_f32 v114, v114, v81, v78
  v_fma_f32 v115, v115, v81, v79
  v_cvt_pk_bf16_f32 v85, v86, v87
  v_cvt_pk_bf16_f32 v86, v88, v89
  v_cvt_pk_bf16_f32 v87, v90, v91
  v_cvt_pk_bf16_f32 v100, v100, v101
  v_cvt_pk_bf16_f32 v88, v92, v93
  v_cvt_pk_bf16_f32 v89, v94, v95
  v_cvt_pk_bf16_f32 v90, v96, v97
  v_cvt_pk_bf16_f32 v91, v98, v99
  v_cvt_pk_bf16_f32 v101, v102, v103
  v_cvt_pk_bf16_f32 v102, v104, v105
  v_cvt_pk_bf16_f32 v103, v106, v107
  v_cvt_pk_bf16_f32 v104, v108, v109
  v_cvt_pk_bf16_f32 v105, v110, v111
  v_cvt_pk_bf16_f32 v106, v112, v113
  v_cvt_pk_bf16_f32 v107, v114, v115
  v_permlane32_swap_b32 v84, v86
  v_permlane32_swap_b32 v85, v87
  v_permlane32_swap_b32 v88, v90
  buffer_store_dwordx4 v[84:87], v5, s[8:11], s27 offen offset:0
  v_permlane32_swap_b32 v89, v91
  v_permlane32_swap_b32 v100, v102
  buffer_store_dwordx4 v[88:91], v5, s[8:11], s27 offen offset:32
  v_permlane32_swap_b32 v101, v103
  v_permlane32_swap_b32 v104, v106
  buffer_store_dwordx4 v[100:103], v5, s[8:11], s28 offen offset:0
  v_permlane32_swap_b32 v105, v107
  buffer_store_dwordx4 v[104:107], v5, s[8:11], s28 offen offset:32
  s_waitcnt vmcnt(0)
  s_barrier
  s_branch L_t2_next
L_t2_oprs:
  s_sub_u32 s78, s77, 32
  s_and_b32 s93, s78, 3
  s_lshr_b32 s78, s78, 2
  s_mul_i32 s77, s76, 9
  s_add_u32 s77, s77, s78
  s_mov_b32 s90, 0
  s_mul_i32 s34, s77, 7282
  s_lshr_b32 s34, s34, 16
  s_mul_i32 s27, s34, 9
  s_sub_u32 s35, s77, s27
  s_mov_b32 s8, s16
  s_mov_b32 s9, s17
  s_mov_b32 s10, 0x10000000
  s_mov_b32 s11, 0x00020000
  s_mov_b32 s12, s56
  s_mov_b32 s13, s57
  s_mov_b32 s14, 4718592
  s_mov_b32 s15, 0x00020000
  s_lshl_b32 s27, s34, 2
  s_add_u32 s27, s27, s31
  s_mul_i32 s20, s27, 262144
  s_add_u32 s20, s20, 93323264
  s_lshl_b32 s24, s31, 12
  s_lshr_b32 s27, s31, 1
  s_lshl_b32 s27, s27, 5
  s_and_b32 s28, s31, 1
  s_lshl_b32 s28, s28, 3
  s_add_u32 s27, s27, s28
  s_mul_i32 s21, s27, 1152
  s_lshl_b32 s27, s35, 7
  s_add_u32 s21, s21, s27
  s_lshl_b32 s25, s31, 11
  s_add_u32 s25, s25, 16384
  s_mov_b32 s37, 16
  s_lshl_b32 s27, s93, 16
  s_add_u32 s20, s20, s27
  s_mul_i32 s27, s93, 1179648
  s_add_u32 s21, s21, s27
  v_and_b32 v1, 63, v0
  s_lshr_b32 s27, s31, 1
  s_lshl_b32 s27, s27, 13
  v_lshlrev_b32 v45, 4, v1
  v_add_u32 v40, s27, v45
  v_lshrrev_b32 v2, 4, v1
  v_and_b32 v3, 15, v1
  v_lshrrev_b32 v4, 2, v3
  v_and_b32 v5, 3, v3
  v_lshrrev_b32 v6, 1, v2
  v_lshlrev_b32 v6, 3, v6
  v_add_u32 v6, v6, v4
  v_lshlrev_b32 v6, 7, v6
  v_and_b32 v7, 1, v2
  v_lshlrev_b32 v7, 1, v7
  v_lshrrev_b32 v8, 1, v5
  v_add_u32 v7, v7, v8
  s_and_b32 s27, s31, 1
  s_lshl_b32 s27, s27, 2
  v_add_u32 v7, s27, v7
  v_lshrrev_b32 v8, 1, v4
  v_lshlrev_b32 v8, 2, v8
  v_xor_b32 v7, v7, v8
  v_lshlrev_b32 v7, 4, v7
  v_and_b32 v8, 1, v5
  v_lshlrev_b32 v8, 3, v8
  v_add3_u32 v6, v6, v7, v8
  v_add_u32 v44, 16384, v6
  v_lshrrev_b32 v4, 3, v1
  v_lshrrev_b32 v5, 2, v4
  v_lshlrev_b32 v5, 4, v5
  v_and_b32 v6, 3, v4
  v_add_u32 v5, v5, v6
  v_mul_u32_u24 v5, 1152, v5
  v_bfe_u32 v6, v4, 1, 1
  v_lshlrev_b32 v6, 2, v6
  v_and_b32 v7, 7, v1
  v_xor_b32 v6, v6, v7
  v_lshlrev_b32 v6, 4, v6
  v_add_u32 v47, v5, v6
  v_and_b32 v1, 63, v0
  s_cmp_eq_u32 s31, 1
  s_cbranch_scc1 L_b_twk1o
  s_mov_b32 s84, s8
  s_mov_b32 s85, s9
  s_mov_b32 s86, s10
  s_mov_b32 s87, 0x00020000
  s_mul_i32 s27, s35, 29
  v_add_u32 v2, s27, v1
  v_lshrrev_b32 v3, 6, v2
  v_mul_u32_u24 v3, 16384, v3
  v_lshlrev_b32 v3, 4, v3
  v_and_b32 v4, 63, v2
  v_lshlrev_b32 v4, 6, v4
  v_add_u32 v3, v3, v4
  v_mov_b32 v5, 0x40000000
  v_cmp_gt_u32 vcc, 29, v1
  s_nop 1
  v_cndmask_b32 v3, v5, v3, vcc
  v_cmp_gt_u32 vcc, 256, v2
  s_nop 1
  v_cndmask_b32 v49, v5, v3, vcc
  s_lshl_b32 s27, s34, 2
  s_mul_i32 s88, s27, 262144
  s_add_u32 s88, s88, 93339648
  s_mov_b32 s89, 4096
  s_cmp_eq_u32 s31, 0
  s_cselect_b32 s88, s88, 0x40000000
  s_cselect_b32 s89, s89, 0
  s_branch L_b_tdk1o
L_b_twk1o:
  s_mov_b32 s84, s12
  s_mov_b32 s85, s13
  s_mov_b32 s86, s14
  s_mov_b32 s87, 0x00020000
  v_lshrrev_b32 v2, 1, v1
  v_mul_u32_u24 v2, 1152, v2
  v_and_b32 v3, 1, v1
  v_lshlrev_b32 v3, 6, v3
  v_add_u32 v49, v2, v3
  s_lshl_b32 s27, s90, 5
  s_add_u32 s27, s27, 256
  s_mul_i32 s88, s27, 1152
  s_lshl_b32 s27, s35, 7
  s_add_u32 s88, s88, s27
  s_mov_b32 s89, 73728
L_b_tdk1o:
  s_mov_b32 s32, 0
  s_mov_b32 s39, 0
  s_add_u32 m0, s24, s32
  s_mov_b32 s27, s20
  buffer_load_dwordx4 v45, s[8:11], s27 offen sc1 lds
  s_add_u32 m0, m0, 1024
  s_add_u32 s27, s27, 1024
  buffer_load_dwordx4 v45, s[8:11], s27 offen sc1 lds
  s_add_u32 m0, m0, 1024
  s_add_u32 s27, s27, 1024
  buffer_load_dwordx4 v45, s[8:11], s27 offen sc1 lds
  s_add_u32 m0, m0, 1024
  s_add_u32 s27, s27, 1024
  buffer_load_dwordx4 v45, s[8:11], s27 offen sc1 lds
  s_add_u32 m0, s25, s32
  s_nop 0
  buffer_load_dwordx4 v47, s[12:15], s21 offen lds
  s_add_u32 m0, m0, 1024
  s_add_u32 s27, s21, 4608
  buffer_load_dwordx4 v47, s[12:15], s27 offen lds
  s_add_u32 s20, s20, 4096
  s_add_u32 s21, s21, 73728
  s_add_u32 s32, s32, 24576
  s_cmp_eq_u32 s32, 98304
  s_cselect_b32 s32, 0, s32
  s_add_u32 m0, s24, s32
  s_mov_b32 s27, s20
  buffer_load_dwordx4 v45, s[8:11], s27 offen sc1 lds
  s_add_u32 m0, m0, 1024
  s_add_u32 s27, s27, 1024
  buffer_load_dwordx4 v45, s[8:11], s27 offen sc1 lds
  s_add_u32 m0, m0, 1024
  s_add_u32 s27, s27, 1024
  buffer_load_dwordx4 v45, s[8:11], s27 offen sc1 lds
  s_add_u32 m0, m0, 1024
  s_add_u32 s27, s27, 1024
  buffer_load_dwordx4 v45, s[8:11], s27 offen sc1 lds
  s_add_u32 m0, s25, s32
  s_nop 0
  buffer_load_dwordx4 v47, s[12:15], s21 offen lds
  s_add_u32 m0, m0, 1024
  s_add_u32 s27, s21, 4608
  buffer_load_dwordx4 v47, s[12:15], s27 offen lds
  s_add_u32 s20, s20, 4096
  s_add_u32 s21, s21, 73728
  s_add_u32 s32, s32, 24576
  s_cmp_eq_u32 s32, 98304
  s_cselect_b32 s32, 0, s32
  s_add_u32 m0, s24, s32
  s_mov_b32 s27, s20
  buffer_load_dwordx4 v45, s[8:11], s27 offen sc1 lds
  s_add_u32 m0, m0, 1024
  s_add_u32 s27, s27, 1024
  buffer_load_dwordx4 v45, s[8:11], s27 offen sc1 lds
  s_add_u32 m0, m0, 1024
  s_add_u32 s27, s27, 1024
  buffer_load_dwordx4 v45, s[8:11], s27 offen sc1 lds
  s_add_u32 m0, m0, 1024
  s_add_u32 s27, s27, 1024
  buffer_load_dwordx4 v45, s[8:11], s27 offen sc1 lds
  s_add_u32 m0, s25, s32
  s_nop 0
  buffer_load_dwordx4 v47, s[12:15], s21 offen lds
  s_add_u32 m0, m0, 1024
  s_add_u32 s27, s21, 4608
  buffer_load_dwordx4 v47, s[12:15], s27 offen lds
  s_add_u32 s20, s20, 4096
  s_add_u32 s21, s21, 73728
  s_add_u32 s32, s32, 24576
  s_cmp_eq_u32 s32, 98304
  s_cselect_b32 s32, 0, s32
  s_add_u32 m0, s24, s32
  s_mov_b32 s27, s20
  buffer_load_dwordx4 v45, s[8:11], s27 offen sc1 lds
  s_add_u32 m0, m0, 1024
  s_add_u32 s27, s27, 1024
  buffer_load_dwordx4 v45, s[8:11], s27 offen sc1 lds
  s_add_u32 m0, m0, 1024
  s_add_u32 s27, s27, 1024
  buffer_load_dwordx4 v45, s[8:11], s27 offen sc1 lds
  s_add_u32 m0, m0, 1024
  s_add_u32 s27, s27, 1024
  buffer_load_dwordx4 v45, s[8:11], s27 offen sc1 lds
  s_add_u32 m0, s25, s32
  s_nop 0
  buffer_load_dwordx4 v47, s[12:15], s21 offen lds
  s_add_u32 m0, m0, 1024
  s_add_u32 s27, s21, 4608
  buffer_load_dwordx4 v47, s[12:15], s27 offen lds
  s_add_u32 s20, s20, 4096
  s_add_u32 s21, s21, 73728
  s_add_u32 s32, s32, 24576
  s_cmp_eq_u32 s32, 98304
  s_cselect_b32 s32, 0, s32
  s_waitcnt vmcnt(18)
  s_barrier
  ds_read_b128 v[16:19], v40 offset:0
  ds_read_b128 v[20:23], v40 offset:4096
  ds_read_b64_tr_b16 v[32:33], v44 offset:0
  ds_read_b64_tr_b16 v[34:35], v44 offset:512
  ds_read_b128 v[24:27], v40 offset:1024
  s_waitcnt lgkmcnt(1)
  v_mfma_f32_32x32x16_bf16 a[0:15], v[32:35], v[16:19], 0
  ds_read_b128 v[28:31], v40 offset:5120
  ds_read_b64_tr_b16 v[36:37], v44 offset:2048
  v_mfma_f32_32x32x16_bf16 a[16:31], v[32:35], v[20:23], 0
  ds_read_b64_tr_b16 v[38:39], v44 offset:2560
  ds_read_b128 v[16:19], v40 offset:2048
  ds_read_b128 v[20:23], v40 offset:6144
  ds_read_b64_tr_b16 v[32:33], v44 offset:4096
  ds_read_b64_tr_b16 v[34:35], v44 offset:4608
  s_waitcnt lgkmcnt(4)
  v_mfma_f32_32x32x16_bf16 a[0:15], v[36:39], v[24:27], a[0:15]
  ds_read_b128 v[24:27], v40 offset:3072
  v_mfma_f32_32x32x16_bf16 a[16:31], v[36:39], v[28:31], a[16:31]
  ds_read_b128 v[28:31], v40 offset:7168
  ds_read_b64_tr_b16 v[36:37], v44 offset:6144
  ds_read_b64_tr_b16 v[38:39], v44 offset:6656
  s_waitcnt lgkmcnt(4)
  v_mfma_f32_32x32x16_bf16 a[0:15], v[32:35], v[16:19], a[0:15]
  v_mfma_f32_32x32x16_bf16 a[16:31], v[32:35], v[20:23], a[16:31]
  s_sub_u32 s26, s37, 4
L_kbk1o:
  s_waitcnt vmcnt(12) lgkmcnt(0)
  s_barrier
  s_add_u32 s39, s39, 24576
  s_cmp_eq_u32 s39, 98304
  s_mov_b32 s38, 24576
  s_cselect_b32 s38, 0xfffee000, s38
  v_add_u32 v40, s38, v40
  v_add_u32 v44, s38, v44
  ds_read_b128 v[16:19], v40 offset:0
  v_mfma_f32_32x32x16_bf16 a[0:15], v[36:39], v[24:27], a[0:15]
  s_cselect_b32 s39, 0, s39
  s_add_u32 m0, s24, s32
  ds_read_b128 v[20:23], v40 offset:4096
  s_mov_b32 s27, s20
  buffer_load_dwordx4 v45, s[8:11], s27 offen sc1 lds
  ds_read_b64_tr_b16 v[32:33], v44 offset:0
  v_mfma_f32_32x32x16_bf16 a[16:31], v[36:39], v[28:31], a[16:31]
  ds_read_b64_tr_b16 v[34:35], v44 offset:512
  s_add_u32 m0, m0, 1024
  ds_read_b128 v[24:27], v40 offset:1024
  s_add_u32 s27, s27, 1024
  buffer_load_dwordx4 v45, s[8:11], s27 offen sc1 lds
  ds_read_b128 v[28:31], v40 offset:5120
  s_add_u32 m0, m0, 1024
  s_add_u32 s27, s27, 1024
  buffer_load_dwordx4 v45, s[8:11], s27 offen sc1 lds
  ds_read_b64_tr_b16 v[36:37], v44 offset:2048
  s_add_u32 m0, m0, 1024
  ds_read_b64_tr_b16 v[38:39], v44 offset:2560
  s_add_u32 s27, s27, 1024
  s_waitcnt lgkmcnt(4)
  v_mfma_f32_32x32x16_bf16 a[0:15], v[32:35], v[16:19], a[0:15]
  ds_read_b128 v[16:19], v40 offset:2048
  buffer_load_dwordx4 v45, s[8:11], s27 offen sc1 lds
  s_add_u32 m0, s25, s32
  v_mfma_f32_32x32x16_bf16 a[16:31], v[32:35], v[20:23], a[16:31]
  ds_read_b128 v[20:23], v40 offset:6144
  ds_read_b64_tr_b16 v[32:33], v44 offset:4096
  ds_read_b64_tr_b16 v[34:35], v44 offset:4608
  s_waitcnt lgkmcnt(4)
  v_mfma_f32_32x32x16_bf16 a[0:15], v[36:39], v[24:27], a[0:15]
  buffer_load_dwordx4 v47, s[12:15], s21 offen lds
  s_add_u32 m0, m0, 1024
  s_add_u32 s27, s21, 4608
  s_add_u32 s20, s20, 4096
  v_mfma_f32_32x32x16_bf16 a[16:31], v[36:39], v[28:31], a[16:31]
  s_add_u32 s21, s21, 73728
  s_add_u32 s32, s32, 24576
  s_cmp_eq_u32 s32, 98304
  s_cselect_b32 s32, 0, s32
  ds_read_b128 v[24:27], v40 offset:3072
  buffer_load_dwordx4 v47, s[12:15], s27 offen lds
  ds_read_b128 v[28:31], v40 offset:7168
  s_waitcnt lgkmcnt(2)
  v_mfma_f32_32x32x16_bf16 a[0:15], v[32:35], v[16:19], a[0:15]
  ds_read_b64_tr_b16 v[36:37], v44 offset:6144
  ds_read_b64_tr_b16 v[38:39], v44 offset:6656
  v_mfma_f32_32x32x16_bf16 a[16:31], v[32:35], v[20:23], a[16:31]
  s_sub_u32 s26, s26, 1
  s_cmp_lg_u32 s26, 0
  s_cbranch_scc1 L_kbk1o
  s_waitcnt vmcnt(12) lgkmcnt(0)
  s_barrier
  s_add_u32 s39, s39, 24576
  s_cmp_eq_u32 s39, 98304
  s_mov_b32 s38, 24576
  s_cselect_b32 s38, 0xfffee000, s38
  v_add_u32 v40, s38, v40
  v_add_u32 v44, s38, v44
  ds_read_b128 v[16:19], v40 offset:0
  v_mfma_f32_32x32x16_bf16 a[0:15], v[36:39], v[24:27], a[0:15]
  s_cselect_b32 s39, 0, s39
  ds_read_b128 v[20:23], v40 offset:4096
  ds_read_b64_tr_b16 v[32:33], v44 offset:0
  v_mfma_f32_32x32x16_bf16 a[16:31], v[36:39], v[28:31], a[16:31]
  ds_read_b64_tr_b16 v[34:35], v44 offset:512
  ds_read_b128 v[24:27], v40 offset:1024
  ds_read_b128 v[28:31], v40 offset:5120
  ds_read_b64_tr_b16 v[36:37], v44 offset:2048
  ds_read_b64_tr_b16 v[38:39], v44 offset:2560
  s_waitcnt lgkmcnt(4)
  v_mfma_f32_32x32x16_bf16 a[0:15], v[32:35], v[16:19], a[0:15]
  ds_read_b128 v[16:19], v40 offset:2048
  v_mfma_f32_32x32x16_bf16 a[16:31], v[32:35], v[20:23], a[16:31]
  ds_read_b128 v[20:23], v40 offset:6144
  ds_read_b64_tr_b16 v[32:33], v44 offset:4096
  ds_read_b64_tr_b16 v[34:35], v44 offset:4608
  s_waitcnt lgkmcnt(4)
  v_mfma_f32_32x32x16_bf16 a[0:15], v[36:39], v[24:27], a[0:15]
  ds_read_b128 v[24:27], v40 offset:3072
  v_mfma_f32_32x32x16_bf16 a[16:31], v[36:39], v[28:31], a[16:31]
  ds_read_b128 v[28:31], v40 offset:7168
  ds_read_b64_tr_b16 v[36:37], v44 offset:6144
  ds_read_b64_tr_b16 v[38:39], v44 offset:6656
  s_waitcnt lgkmcnt(4)
  v_mfma_f32_32x32x16_bf16 a[0:15], v[32:35], v[16:19], a[0:15]
  v_mfma_f32_32x32x16_bf16 a[16:31], v[32:35], v[20:23], a[16:31]
  s_waitcnt vmcnt(6) lgkmcnt(0)
  s_barrier
  s_add_u32 s39, s39, 24576
  s_cmp_eq_u32 s39, 98304
  s_mov_b32 s38, 24576
  s_cselect_b32 s38, 0xfffee000, s38
  v_add_u32 v40, s38, v40
  v_add_u32 v44, s38, v44
  ds_read_b128 v[16:19], v40 offset:0
  v_mfma_f32_32x32x16_bf16 a[0:15], v[36:39], v[24:27], a[0:15]
  s_cselect_b32 s39, 0, s39
  ds_read_b128 v[20:23], v40 offset:4096
  ds_read_b64_tr_b16 v[32:33], v44 offset:0
  v_mfma_f32_32x32x16_bf16 a[16:31], v[36:39], v[28:31], a[16:31]
  ds_read_b64_tr_b16 v[34:35], v44 offset:512
  ds_read_b128 v[24:27], v40 offset:1024
  ds_read_b128 v[28:31], v40 offset:5120
  ds_read_b64_tr_b16 v[36:37], v44 offset:2048
  ds_read_b64_tr_b16 v[38:39], v44 offset:2560
  s_waitcnt lgkmcnt(4)
  v_mfma_f32_32x32x16_bf16 a[0:15], v[32:35], v[16:19], a[0:15]
  ds_read_b128 v[16:19], v40 offset:2048
  v_mfma_f32_32x32x16_bf16 a[16:31], v[32:35], v[20:23], a[16:31]
  ds_read_b128 v[20:23], v40 offset:6144
  ds_read_b64_tr_b16 v[32:33], v44 offset:4096
  ds_read_b64_tr_b16 v[34:35], v44 offset:4608
  s_waitcnt lgkmcnt(4)
  v_mfma_f32_32x32x16_bf16 a[0:15], v[36:39], v[24:27], a[0:15]
  ds_read_b128 v[24:27], v40 offset:3072
  v_mfma_f32_32x32x16_bf16 a[16:31], v[36:39], v[28:31], a[16:31]
  ds_read_b128 v[28:31], v40 offset:7168
  ds_read_b64_tr_b16 v[36:37], v44 offset:6144
  ds_read_b64_tr_b16 v[38:39], v44 offset:6656
  s_waitcnt lgkmcnt(4)
  v_mfma_f32_32x32x16_bf16 a[0:15], v[32:35], v[16:19], a[0:15]
  v_mfma_f32_32x32x16_bf16 a[16:31], v[32:35], v[20:23], a[16:31]
  s_waitcnt vmcnt(0) lgkmcnt(0)
  s_barrier
  s_add_u32 s39, s39, 24576
  s_cmp_eq_u32 s39, 98304
  s_mov_b32 s38, 24576
  s_cselect_b32 s38, 0xfffee000, s38
  v_add_u32 v40, s38, v40
  v_add_u32 v44, s38, v44
  ds_read_b128 v[16:19], v40 offset:0
  v_mfma_f32_32x32x16_bf16 a[0:15], v[36:39], v[24:27], a[0:15]
  s_cselect_b32 s39, 0, s39
  ds_read_b128 v[20:23], v40 offset:4096
  ds_read_b64_tr_b16 v[32:33], v44 offset:0
  v_mfma_f32_32x32x16_bf16 a[16:31], v[36:39], v[28:31], a[16:31]
  ds_read_b64_tr_b16 v[34:35], v44 offset:512
  ds_read_b128 v[24:27], v40 offset:1024
  ds_read_b128 v[28:31], v40 offset:5120
  ds_read_b64_tr_b16 v[36:37], v44 offset:2048
  ds_read_b64_tr_b16 v[38:39], v44 offset:2560
  s_waitcnt lgkmcnt(4)
  v_mfma_f32_32x32x16_bf16 a[0:15], v[32:35], v[16:19], a[0:15]
  ds_read_b128 v[16:19], v40 offset:2048
  v_mfma_f32_32x32x16_bf16 a[16:31], v[32:35], v[20:23], a[16:31]
  ds_read_b128 v[20:23], v40 offset:6144
  ds_read_b64_tr_b16 v[32:33], v44 offset:4096
  ds_read_b64_tr_b16 v[34:35], v44 offset:4608
  s_waitcnt lgkmcnt(4)
  v_mfma_f32_32x32x16_bf16 a[0:15], v[36:39], v[24:27], a[0:15]
  ds_read_b128 v[24:27], v40 offset:3072
  v_mfma_f32_32x32x16_bf16 a[16:31], v[36:39], v[28:31], a[16:31]
  ds_read_b128 v[28:31], v40 offset:7168
  ds_read_b64_tr_b16 v[36:37], v44 offset:6144
  ds_read_b64_tr_b16 v[38:39], v44 offset:6656
  s_waitcnt lgkmcnt(4)
  v_mfma_f32_32x32x16_bf16 a[0:15], v[32:35], v[16:19], a[0:15]
  v_mfma_f32_32x32x16_bf16 a[16:31], v[32:35], v[20:23], a[16:31]
  s_waitcnt lgkmcnt(0)
  v_mfma_f32_32x32x16_bf16 a[0:15], v[36:39], v[24:27], a[0:15]
  v_mfma_f32_32x32x16_bf16 a[16:31], v[36:39], v[28:31], a[16:31]
  s_lshl_b32 s29, s77, 15
  s_lshl_b32 s27, s31, 13
  s_add_u32 s29, s29, s27
  s_add_u32 s29, s29, 110100480
  v_and_b32 v1, 63, v0
  v_lshlrev_b32 v2, 4, v1
  s_add_u32 s30, s29, 4096
  s_lshl_b32 s94, s77, 2
  s_add_u32 s95, s94, s93
  s_lshl_b32 s95, s95, 15
  s_lshl_b32 s27, s31, 13
  s_add_u32 s95, s95, s27
  s_add_u32 s95, s95, 115474432
  s_add_u32 s96, s95, 4096
  s_nop 7
  buffer_store_dwordx4 a[0:3], v2, s[16:19], s95 offen offset:0 sc1
  buffer_store_dwordx4 a[4:7], v2, s[16:19], s95 offen offset:1024 sc1
  buffer_store_dwordx4 a[8:11], v2, s[16:19], s95 offen offset:2048 sc1
  buffer_store_dwordx4 a[12:15], v2, s[16:19], s95 offen offset:3072 sc1
  buffer_store_dwordx4 a[16:19], v2, s[16:19], s96 offen offset:0 sc1
  buffer_store_dwordx4 a[20:23], v2, s[16:19], s96 offen offset:1024 sc1
  buffer_store_dwordx4 a[24:27], v2, s[16:19], s96 offen offset:2048 sc1
  buffer_store_dwordx4 a[28:31], v2, s[16:19], s96 offen offset:3072 sc1
  s_waitcnt vmcnt(0)
  s_barrier
  s_cmp_lg_u32 s31, 0
  s_cbranch_scc1 L_cmb_wk1o
  s_lshl_b32 s97, s77, 2
  s_add_u32 s97, s97, 115409536
  s_mov_b64 s[66:67], exec
  s_mov_b64 exec, 1
  v_mov_b32 v3, 0
  v_mov_b32 v4, 1
  buffer_atomic_add v4, v3, s[16:19], s97 offen sc0 sc1
  s_waitcnt vmcnt(0)
  v_readfirstlane_b32 s97, v4
  s_mov_b64 exec, s[66:67]
  v_mov_b32 v3, 0x27000
  v_mov_b32 v4, s97
  ds_write_b32 v3, v4
  s_waitcnt lgkmcnt(0)
L_cmb_wk1o:
  s_barrier
  v_mov_b32 v3, 0x27000
  ds_read_b32 v4, v3
  s_waitcnt lgkmcnt(0)
  v_readfirstlane_b32 s97, v4
  s_nop 3
  s_barrier
  s_cmp_eq_u32 s97, 3
  s_cbranch_scc0 L_cmb_donek1o
  buffer_load_dwordx4 v[48:51], v2, s[16:19], s29 offen offset:0 sc1
  buffer_load_dwordx4 v[52:55], v2, s[16:19], s29 offen offset:1024 sc1
  s_lshl_b32 s95, s94, 15
  buffer_load_dwordx4 v[56:59], v2, s[16:19], s29 offen offset:2048 sc1
  s_lshl_b32 s27, s31, 13
  buffer_load_dwordx4 v[60:63], v2, s[16:19], s29 offen offset:3072 sc1
  buffer_load_dwordx4 v[64:67], v2, s[16:19], s30 offen offset:0 sc1
  s_add_u32 s95, s95, s27
  buffer_load_dwordx4 v[68:71], v2, s[16:19], s30 offen offset:1024 sc1
  buffer_load_dwordx4 v[72:75], v2, s[16:19], s30 offen offset:2048 sc1
  s_add_u32 s95, s95, 115474432
  buffer_load_dwordx4 v[76:79], v2, s[16:19], s30 offen offset:3072 sc1
  buffer_load_dwordx4 v[116:119], v2, s[16:19], s95 offen offset:0 sc1
  buffer_load_dwordx4 v[120:123], v2, s[16:19], s95 offen offset:1024 sc1
  buffer_load_dwordx4 v[124:127], v2, s[16:19], s95 offen offset:2048 sc1
  buffer_load_dwordx4 v[128:131], v2, s[16:19], s95 offen offset:3072 sc1
  s_add_u32 s95, s95, 4096
  buffer_load_dwordx4 v[132:135], v2, s[16:19], s95 offen offset:0 sc1
  buffer_load_dwordx4 v[136:139], v2, s[16:19], s95 offen offset:1024 sc1
  buffer_load_dwordx4 v[140:143], v2, s[16:19], s95 offen offset:2048 sc1
  buffer_load_dwordx4 v[144:147], v2, s[16:19], s95 offen offset:3072 sc1
  s_add_u32 s95, s95, 28672
  buffer_load_dwordx4 v[148:151], v2, s[16:19], s95 offen offset:0 sc1
  buffer_load_dwordx4 v[152:155], v2, s[16:19], s95 offen offset:1024 sc1
  buffer_load_dwordx4 v[156:159], v2, s[16:19], s95 offen offset:2048 sc1
  buffer_load_dwordx4 v[160:163], v2, s[16:19], s95 offen offset:3072 sc1
  s_add_u32 s95, s95, 4096
  buffer_load_dwordx4 v[164:167], v2, s[16:19], s95 offen offset:0 sc1
  buffer_load_dwordx4 v[168:171], v2, s[16:19], s95 offen offset:1024 sc1
  buffer_load_dwordx4 v[172:175], v2, s[16:19], s95 offen offset:2048 sc1
  buffer_load_dwordx4 v[176:179], v2, s[16:19], s95 offen offset:3072 sc1
  s_add_u32 s95, s95, 28672
  buffer_load_dwordx4 v[180:183], v2, s[16:19], s95 offen offset:0 sc1
  buffer_load_dwordx4 v[184:187], v2, s[16:19], s95 offen offset:1024 sc1
  buffer_load_dwordx4 v[188:191], v2, s[16:19], s95 offen offset:2048 sc1
  buffer_load_dwordx4 v[192:195], v2, s[16:19], s95 offen offset:3072 sc1
  s_add_u32 s95, s95, 4096
  buffer_load_dwordx4 v[196:199], v2, s[16:19], s95 offen offset:0 sc1
  buffer_load_dwordx4 v[200:203], v2, s[16:19], s95 offen offset:1024 sc1
  buffer_load_dwordx4 v[204:207], v2, s[16:19], s95 offen offset:2048 sc1
  buffer_load_dwordx4 v[208:211], v2, s[16:19], s95 offen offset:3072 sc1
  s_add_u32 s95, s95, 28672
  buffer_load_dwordx4 v[212:215], v2, s[16:19], s95 offen offset:0 sc1
  buffer_load_dwordx4 v[216:219], v2, s[16:19], s95 offen offset:1024 sc1
  buffer_load_dwordx4 v[220:223], v2, s[16:19], s95 offen offset:2048 sc1
  buffer_load_dwordx4 v[224:227], v2, s[16:19], s95 offen offset:3072 sc1
  s_add_u32 s95, s95, 4096
  buffer_load_dwordx4 v[228:231], v2, s[16:19], s95 offen offset:0 sc1
  buffer_load_dwordx4 v[232:235], v2, s[16:19], s95 offen offset:1024 sc1
  buffer_load_dwordx4 v[236:239], v2, s[16:19], s95 offen offset:2048 sc1
  s_lshl_b32 s27, s34, 7
  buffer_load_dwordx4 v[240:243], v2, s[16:19], s95 offen offset:3072 sc1
  s_lshr_b32 s28, s31, 1
  v_and_b32 v3, 31, v1
  s_lshl_b32 s28, s28, 6
  s_add_u32 s27, s27, s28
  v_lshlrev_b32 v4, 2, v3
  s_lshl_b32 s28, s27, 2
  s_add_u32 s28, s28, 115343360
  buffer_load_dword v80, v4, s[16:19], s28 offen sc1
  buffer_load_dword v81, v4, s[16:19], s28 offen offset:128 sc1
  s_waitcnt vmcnt(25)
  v_add_f32 v116, v116, v148
  v_add_f32 v117, v117, v149
  v_add_f32 v118, v118, v150
  v_add_f32 v119, v119, v151
  s_waitcnt vmcnt(24)
  v_add_f32 v120, v120, v152
  v_add_f32 v121, v121, v153
  v_add_f32 v122, v122, v154
  v_add_f32 v123, v123, v155
  s_waitcnt vmcnt(21)
  v_add_f32 v132, v132, v164
  v_add_f32 v133, v133, v165
  v_add_f32 v124, v124, v156
  v_add_f32 v125, v125, v157
  v_add_f32 v126, v126, v158
  v_add_f32 v127, v127, v159
  v_add_f32 v128, v128, v160
  v_add_f32 v129, v129, v161
  v_add_f32 v130, v130, v162
  v_add_f32 v131, v131, v163
  v_add_f32 v134, v134, v166
  v_add_f32 v135, v135, v167
  s_waitcnt vmcnt(20)
  v_add_f32 v136, v136, v168
  v_add_f32 v137, v137, v169
  v_add_f32 v138, v138, v170
  v_add_f32 v139, v139, v171
  s_waitcnt vmcnt(19)
  v_add_f32 v140, v140, v172
  v_add_f32 v141, v141, v173
  v_add_f32 v142, v142, v174
  v_add_f32 v143, v143, v175
  s_waitcnt vmcnt(18)
  v_add_f32 v144, v144, v176
  v_add_f32 v145, v145, v177
  v_add_f32 v146, v146, v178
  v_add_f32 v147, v147, v179
  v_lshrrev_b32 v6, 5, v1
  v_mul_u32_u24 v5, 1152, v3
  v_lshlrev_b32 v6, 4, v6
  s_mul_i32 s27, s27, 1152
  s_lshl_b32 s28, s35, 7
  s_add_u32 s27, s27, s28
  s_and_b32 s28, s31, 1
  v_add_u32 v5, v5, v6
  s_lshl_b32 s28, s28, 6
  s_mov_b32 s8, s60
  s_mov_b32 s9, s61
  s_mov_b32 s10, 2359296
  s_add_u32 s27, s27, s28
  s_add_u32 s28, s27, 36864
  s_waitcnt vmcnt(9)
  v_add_f32 v180, v180, v212
  v_add_f32 v181, v181, v213
  v_add_f32 v182, v182, v214
  v_add_f32 v183, v183, v215
  s_waitcnt vmcnt(8)
  v_add_f32 v184, v184, v216
  v_add_f32 v185, v185, v217
  v_add_f32 v186, v186, v218
  v_add_f32 v187, v187, v219
  s_waitcnt vmcnt(7)
  v_add_f32 v188, v188, v220
  v_add_f32 v189, v189, v221
  v_add_f32 v190, v190, v222
  v_add_f32 v191, v191, v223
  s_waitcnt vmcnt(6)
  v_add_f32 v192, v192, v224
  v_add_f32 v193, v193, v225
  v_add_f32 v194, v194, v226
  v_add_f32 v195, v195, v227
  v_add_f32 v84, v116, v180
  s_waitcnt vmcnt(5)
  v_add_f32 v196, v196, v228
  v_add_f32 v197, v197, v229
  v_add_f32 v198, v198, v230
  v_add_f32 v199, v199, v231
  s_waitcnt vmcnt(4)
  v_add_f32 v200, v200, v232
  v_add_f32 v201, v201, v233
  v_add_f32 v202, v202, v234
  v_add_f32 v203, v203, v235
  v_add_f32 v85, v117, v181
  s_waitcnt vmcnt(3)
  v_add_f32 v204, v204, v236
  v_add_f32 v205, v205, v237
  v_add_f32 v206, v206, v238
  v_add_f32 v207, v207, v239
  s_waitcnt vmcnt(2)
  v_add_f32 v208, v208, v240
  v_add_f32 v209, v209, v241
  v_add_f32 v210, v210, v242
  v_add_f32 v211, v211, v243
  v_add_f32 v86, v118, v182
  v_add_f32 v87, v119, v183
  v_add_f32 v88, v120, v184
  v_add_f32 v89, v121, v185
  v_add_f32 v90, v122, v186
  v_add_f32 v91, v123, v187
  v_add_f32 v100, v132, v196
  v_add_f32 v101, v133, v197
  v_add_f32 v92, v124, v188
  v_add_f32 v93, v125, v189
  v_add_f32 v94, v126, v190
  v_add_f32 v95, v127, v191
  v_add_f32 v96, v128, v192
  v_add_f32 v97, v129, v193
  v_add_f32 v98, v130, v194
  v_add_f32 v99, v131, v195
  v_add_f32 v102, v134, v198
  v_add_f32 v103, v135, v199
  v_add_f32 v104, v136, v200
  v_add_f32 v105, v137, v201
  v_add_f32 v106, v138, v202
  v_add_f32 v107, v139, v203
  v_sub_f32 v84, v84, v48
  v_sub_f32 v85, v85, v49
  v_add_f32 v108, v140, v204
  v_add_f32 v109, v141, v205
  v_add_f32 v110, v142, v206
  v_add_f32 v111, v143, v207
  v_add_f32 v112, v144, v208
  v_add_f32 v113, v145, v209
  v_add_f32 v114, v146, v210
  v_add_f32 v115, v147, v211
  v_sub_f32 v86, v86, v50
  v_sub_f32 v87, v87, v51
  v_sub_f32 v88, v88, v52
  v_sub_f32 v89, v89, v53
  v_sub_f32 v90, v90, v54
  v_sub_f32 v91, v91, v55
  v_sub_f32 v100, v100, v64
  v_sub_f32 v101, v101, v65
  v_sub_f32 v92, v92, v56
  v_sub_f32 v93, v93, v57
  v_sub_f32 v94, v94, v58
  v_sub_f32 v95, v95, v59
  v_sub_f32 v96, v96, v60
  v_sub_f32 v97, v97, v61
  v_sub_f32 v98, v98, v62
  v_sub_f32 v99, v99, v63
  v_sub_f32 v102, v102, v66
  v_sub_f32 v103, v103, v67
  v_sub_f32 v104, v104, v68
  v_sub_f32 v105, v105, v69
  v_sub_f32 v106, v106, v70
  v_sub_f32 v107, v107, v71
  s_waitcnt vmcnt(1)
  v_fma_f32 v84, v84, v80, v48
  v_fma_f32 v85, v85, v80, v49
  v_sub_f32 v108, v108, v72
  v_sub_f32 v109, v109, v73
  v_sub_f32 v110, v110, v74
  v_sub_f32 v111, v111, v75
  v_sub_f32 v112, v112, v76
  v_sub_f32 v113, v113, v77
  v_sub_f32 v114, v114, v78
  v_sub_f32 v115, v115, v79
  v_fma_f32 v86, v86, v80, v50
  v_fma_f32 v87, v87, v80, v51
  v_fma_f32 v88, v88, v80, v52
  v_fma_f32 v89, v89, v80, v53
  v_fma_f32 v90, v90, v80, v54
  v_fma_f32 v91, v91, v80, v55
  s_waitcnt vmcnt(0)
  v_fma_f32 v100, v100, v81, v64
  v_fma_f32 v101, v101, v81, v65
  v_fma_f32 v92, v92, v80, v56
  v_fma_f32 v93, v93, v80, v57
  v_fma_f32 v94, v94, v80, v58
  v_fma_f32 v95, v95, v80, v59
  v_fma_f32 v96, v96, v80, v60
  v_fma_f32 v97, v97, v80, v61
  v_fma_f32 v98, v98, v80, v62
  v_fma_f32 v99, v99, v80, v63
  v_fma_f32 v102, v102, v81, v66
  v_fma_f32 v103, v103, v81, v67
  v_fma_f32 v104, v104, v81, v68
  v_fma_f32 v105, v105, v81, v69
  v_fma_f32 v106, v106, v81, v70
  v_fma_f32 v107, v107, v81, v71
  v_cvt_pk_bf16_f32 v84, v84, v85
  v_fma_f32 v108, v108, v81, v72
  v_fma_f32 v109, v109, v81, v73
  v_fma_f32 v110, v110, v81, v74
  v_fma_f32 v111, v111, v81, v75
  v_fma_f32 v112, v112, v81, v76
  v_fma_f32 v113, v113, v81, v77
  v_fma_f32 v114, v114, v81, v78
  v_fma_f32 v115, v115, v81, v79
  v_cvt_pk_bf16_f32 v85, v86, v87
  v_cvt_pk_bf16_f32 v86, v88, v89
  v_cvt_pk_bf16_f32 v87, v90, v91
  v_cvt_pk_bf16_f32 v100, v100, v101
  v_cvt_pk_bf16_f32 v88, v92, v93
  v_cvt_pk_bf16_f32 v89, v94, v95
  v_cvt_pk_bf16_f32 v90, v96, v97
  v_cvt_pk_bf16_f32 v91, v98, v99
  v_cvt_pk_bf16_f32 v101, v102, v103
  v_cvt_pk_bf16_f32 v102, v104, v105
  v_cvt_pk_bf16_f32 v103, v106, v107
  v_cvt_pk_bf16_f32 v104, v108, v109
  v_cvt_pk_bf16_f32 v105, v110, v111
  v_cvt_pk_bf16_f32 v106, v112, v113
  v_cvt_pk_bf16_f32 v107, v114, v115
  v_permlane32_swap_b32 v84, v86
  v_permlane32_swap_b32 v85, v87
  v_permlane32_swap_b32 v88, v90
  buffer_store_dwordx4 v[84:87], v5, s[8:11], s27 offen offset:0
  v_permlane32_swap_b32 v89, v91
  v_permlane32_swap_b32 v100, v102
  buffer_store_dwordx4 v[88:91], v5, s[8:11], s27 offen offset:32
  v_permlane32_swap_b32 v101, v103
  v_permlane32_swap_b32 v104, v106
  buffer_store_dwordx4 v[100:103], v5, s[8:11], s28 offen offset:0
  v_permlane32_swap_b32 v105, v107
  buffer_store_dwordx4 v[104:107], v5, s[8:11], s28 offen offset:32
  s_waitcnt vmcnt(0)
L_cmb_donek1o:
  s_barrier
  s_branch L_t2_next
L_chain:
  s_load_dwordx2 s[74:75], s[0:1], 8
  s_mov_b32 s4, s16
  s_mov_b32 s5, s17
  s_mov_b32 s6, 0x10000000
  s_mov_b32 s7, 0x00020000
  s_mov_b32 s76, s42
  s_mov_b32 s77, s43
  s_mov_b32 s78, s44
  s_mov_b32 s79, s45
  s_mov_b32 s80, s46
  s_mov_b32 s81, s47
  s_mov_b32 s82, s56
  s_mov_b32 s83, s57
  s_mov_b32 s8, s69
  s_waitcnt lgkmcnt(0)
  v_lshrrev_b32 v10, 6, v0
  v_and_b32 v11, 63, v0
  s_nop 0
  v_readfirstlane_b32 s9, v10
  v_lshlrev_b32 v0, 4, v11
  v_lshrrev_b32 v12, 4, v11
  v_and_b32 v13, 15, v11
  v_and_b32 v14, 1, v11
  v_mov_b32 v15, 0x4444
  v_mov_b32 v16, 0xeeee
  v_cmp_eq_u32 vcc, 1, v14
  s_nop 1
  v_cndmask_b32 v1, v15, v16, vcc
  s_mul_i32 s21, s9, 34816
  s_add_u32 s21, s21, 24576
  v_add_u32 v2, s21, v0
  v_lshlrev_b32 v14, 2, v12
  v_sub_u32 v14, v13, v14
  v_mov_b32 v15, 0x3f80
  v_mov_b32 v16, 0x3f800000
  v_cmp_eq_u32 vcc, 0, v14
  s_nop 1
  v_cndmask_b32 v17, 0, v15, vcc
  v_cmp_eq_u32 vcc, 1, v14
  s_nop 1
  v_cndmask_b32 v4, v17, v16, vcc
  v_cmp_eq_u32 vcc, 2, v14
  s_nop 1
  v_cndmask_b32 v17, 0, v15, vcc
  v_cmp_eq_u32 vcc, 3, v14
  s_nop 1
  v_cndmask_b32 v5, v17, v16, vcc
  v_lshrrev_b32 v14, 2, v13
  v_lshlrev_b32 v14, 1, v14
  v_and_b32 v15, 1, v13
  v_add_u32 v14, v14, v15
  v_mul_u32_u24 v14, 288, v14
  v_lshlrev_b32 v15, 3, v12
  s_lshl_b32 s21, s9, 6
  s_add_u32 s21, s21, 17408
  v_add3_u32 v14, v14, v15, s21
  v_lshlrev_b32 v15, 3, v11
  v_add_u32 v15, 20224, v15
  v_and_b32 v16, 2, v13
  v_cmp_eq_u32 vcc, 2, v16
  s_nop 1
  v_cndmask_b32 v3, v15, v14, vcc
  v_lshrrev_b32 v14, 1, v13
  v_mul_u32_u24 v14, 288, v14
  v_lshlrev_b32 v15, 5, v12
  v_and_b32 v16, 1, v13
  v_lshlrev_b32 v16, 4, v16
  v_add3_u32 v14, v14, v15, v16
  v_add_u32 v6, 17408, v14
  v_lshlrev_b32 v14, 5, v12
  v_lshrrev_b32 v15, 2, v13
  v_lshlrev_b32 v15, 8, v15
  v_and_b32 v16, 2, v13
  v_lshlrev_b32 v16, 3, v16
  v_add3_u32 v14, v14, v15, v16
  v_and_b32 v16, 1, v13
  v_lshlrev_b32 v16, 3, v16
  v_add_u32 v14, v14, v16
  v_mov_b32 v15, 1073741824
  v_cmp_gt_u32 vcc, 2, v12
  s_nop 1
  v_cndmask_b32 v7, v15, v14, vcc
  v_mul_u32_u24 v14, 9216, v12
  v_lshlrev_b32 v15, 4, v13
  v_add_u32 v8, v14, v15
  v_and_b32 v14, 15, v11
  v_lshlrev_b32 v14, 6, v14
  v_and_b32 v15, 16, v11
  v_lshlrev_b32 v15, 8, v15
  v_add_u32 v15, v14, v15
  v_and_b32 v16, 31, v11
  v_lshlrev_b32 v16, 6, v16
  s_lshl_b32 s21, s9, 10
  s_add_u32 s21, s21, 16777216
  v_add_u32 v16, s21, v16
  v_cmp_gt_u32 vcc, 32, v11
  s_nop 1
  v_cndmask_b32 v9, v16, v15, vcc
  s_mov_b32 s20, 0x3e0293ee
  s_mov_b32 s34, 0xcccccccc
  s_mov_b32 s35, 0xcccccccc
  s_lshl_b32 s37, s9, 8
  s_lshl_b32 s59, s9, 2
  s_lshl_b32 s25, s9, 10
  s_lshl_b32 s27, s9, 8
  s_add_u32 s27, s27, 8192
  s_mov_b32 s10, 0
  s_mov_b32 s39, 0
  s_mov_b32 s38, 63
  s_mov_b32 s30, 200000
  s_mov_b32 m0, 19968
  s_mul_i32 s21, s8, 9216
  s_lshl_b32 s22, s9, 11
  s_add_u32 s11, s21, s22
  s_add_u32 s11, s11, 0
  s_lshl_b32 s22, s9, 8
  s_add_u32 s33, s21, s22
  s_add_u32 s33, s33, 8192
  s_mov_b32 s12, 851968
  s_mov_b32 s13, 861184
  s_lshl_b32 s21, s8, 13
  s_lshl_b32 s22, s9, 10
  s_add_u32 s16, s21, s22
  s_add_u32 s17, s16, s22
  s_add_u32 s16, s16, 1048576
  s_add_u32 s17, s17, 17825792
  s_lshl_b32 s21, s8, 12
  s_add_u32 s18, s21, s22
  s_add_u32 s18, s18, 34603008
  s_add_u32 s19, s21, s22
  s_add_u32 s19, s19, 42991616
  s_mov_b32 s55, 1073741824
  s_mov_b32 s56, 1073741824
  s_lshr_b32 s22, s8, 2
  s_and_b32 s23, s8, 3
  s_lshl_b32 s22, s22, 10
  s_lshl_b32 s24, s23, 8
  s_add_u32 s28, s22, s24
  s_add_u32 s28, s28, 0
  s_lshl_b32 s24, s23, 6
  s_add_u32 s29, s22, s24
  s_cmp_eq_u32 s9, 1
  s_cbranch_scc0 L_setup_no8
  s_lshr_b32 s22, s8, 3
  s_and_b32 s23, s8, 7
  s_lshl_b32 s24, s22, 8
  s_lshl_b32 s21, s23, 5
  s_add_u32 s28, s24, s21
  s_add_u32 s28, s28, 8192
  v_lshrrev_b32 v14, 1, v11
  v_mul_u32_u24 v14, 9216, v14
  v_and_b32 v15, 1, v11
  v_lshlrev_b32 v15, 4, v15
  v_add_u32 v8, v14, v15
  s_lshl_b32 s24, s22, 2
  s_add_u32 s29, s24, 8192
  s_lshl_b32 s23, s23, 1
  v_add_u32 v14, s23, v13
  v_and_b32 v15, 3, v14
  v_lshlrev_b32 v15, 4, v15
  v_lshrrev_b32 v16, 2, v14
  v_lshlrev_b32 v16, 2, v16
  v_add3_u32 v14, v15, v16, v12
  v_lshlrev_b32 v14, 4, v14
  v_mov_b32 v15, 1073741824
  v_cmp_gt_u32 vcc, 2, v12
  s_nop 1
  v_cndmask_b32 v14, v15, v14, vcc
  v_cmp_gt_u32 vcc, 2, v13
  s_nop 1
  v_cndmask_b32 v7, v15, v14, vcc
L_setup_no8:
  s_mov_b32 s58, 1073741824
  s_cmp_eq_u32 s9, 3
  s_cbranch_scc0 L_setup_no3
  v_mov_b32 v15, 1073741824
  v_cmp_eq_u32 vcc, 0, v11
  s_nop 1
  v_cndmask_b32 v7, v15, 0, vcc
  v_mov_b32 v8, 1
L_setup_no3:
  v_and_b32 v18, 1, v13
  v_lshlrev_b32 v18, 4, v18
  v_mov_b32 v19, 0x3f80
  v_lshlrev_b32 v19, v18, v19
  v_lshrrev_b32 v18, 1, v13
  v_cmp_eq_u32 vcc, 0, v18
  s_nop 1
  v_cndmask_b32 v14, 0, v19, vcc
  v_cmp_eq_u32 vcc, 1, v18
  s_nop 1
  v_cndmask_b32 v15, 0, v19, vcc
  v_cmp_eq_u32 vcc, 2, v18
  s_nop 1
  v_cndmask_b32 v16, 0, v19, vcc
  v_cmp_eq_u32 vcc, 3, v18
  s_nop 1
  v_cndmask_b32 v17, 0, v19, vcc
  v_lshlrev_b32 v18, 4, v13
  ds_write_b128 v18, v[14:17] offset:19712
  v_mov_b32 v14, 0x3f803f80
  v_mov_b32 v15, 0x3f803f80
  v_mov_b32 v16, 0x3f803f80
  v_mov_b32 v17, 0x3f803f80
  ds_write_b128 v0, v[14:17] offset:20864
  v_mov_b32 v14, 0x3f80
  v_mov_b32 v15, 0x3f80
  ds_write_b128 v0, v[14:17] offset:21888
  s_cmp_lg_u32 s9, 0
  s_cbranch_scc1 L_cp_nomix
  s_lshl_b32 s73, 1, s68
  s_mov_b64 s[66:67], exec
  s_mov_b64 exec, 1
  v_mov_b32 v20, 44
  v_mov_b32 v21, s73
  global_atomic_or v20, v21, s[62:63] sc1
  s_mov_b64 exec, s[66:67]
L_cp_nomix:
  v_mov_b32 v20, -1
  v_mov_b32 v21, -1
  v_mov_b32 v22, -1
  v_mov_b32 v23, -1
  s_mul_i32 s21, s8, 9216
  s_add_u32 s21, s21, 0
  s_lshl_b32 s22, s9, 10
  s_add_u32 s21, s21, s22
  s_add_u32 s23, s21, 0
  buffer_store_dwordx4 v[20:23], v0, s[4:7], s23 offen sc1
  s_add_u32 s23, s21, 4096
  buffer_store_dwordx4 v[20:23], v0, s[4:7], s23 offen sc1
  s_sub_u32 s23, s21, s22
  s_add_u32 s23, s23, 8192
  buffer_store_dwordx4 v[20:23], v0, s[4:7], s23 offen sc1
  s_add_u32 s23, s21, 524288
  buffer_store_dwordx4 v[20:23], v0, s[4:7], s23 offen sc1
  s_add_u32 s23, s21, 528384
  buffer_store_dwordx4 v[20:23], v0, s[4:7], s23 offen sc1
  s_sub_u32 s23, s21, s22
  s_add_u32 s23, s23, 532480
  buffer_store_dwordx4 v[20:23], v0, s[4:7], s23 offen sc1
  s_cmp_eq_u32 s8, 31
  s_cbranch_scc0 L_cp_noflags
  v_mov_b32 v24, 0
  v_mov_b32 v25, 0
  v_mov_b32 v26, 0
  v_mov_b32 v27, 0
  s_lshl_b32 s23, s9, 10
  s_add_u32 s23, s23, 115408896
  buffer_store_dwordx4 v[24:27], v0, s[4:7], s23 offen sc1
L_cp_noflags:
  s_cmp_lg_u32 s9, 0
  s_cbranch_scc1 L_cp_img_done
  s_cmp_lt_u32 s8, 9
  s_cbranch_scc1 L_cp_img0
  s_cmp_ge_u32 s8, 27
  s_cbranch_scc1 L_cp_img_done
  s_lshl_b32 s23, s8, 10
  s_add_u32 s23, s23, 851968
  buffer_store_dwordx4 v[20:23], v0, s[4:7], s23 offen sc1
  s_branch L_cp_img_done
L_cp_img0:
  s_mov_b32 s84, s74
  s_mov_b32 s85, s75
  s_mov_b32 s86, 9216
  s_mov_b32 s87, 0x00020000
  v_lshrrev_b32 v24, 1, v13
  v_mul_u32_u24 v24, 1152, v24
  v_lshlrev_b32 v25, 3, v12
  v_and_b32 v26, 1, v13
  v_lshlrev_b32 v26, 2, v26
  v_add3_u32 v24, v24, v25, v26
  s_lshl_b32 s23, s8, 7
  s_cmp_eq_u32 s8, 8
  s_cbranch_scc1 L_cp_img8
  buffer_load_ushort v32, v24, s[84:87], s23 offen offset:0
  buffer_load_ushort v33, v24, s[84:87], s23 offen offset:32
  buffer_load_ushort v34, v24, s[84:87], s23 offen offset:64
  buffer_load_ushort v35, v24, s[84:87], s23 offen offset:96
  buffer_load_ushort v36, v24, s[84:87], s23 offen offset:2
  buffer_load_ushort v37, v24, s[84:87], s23 offen offset:34
  buffer_load_ushort v38, v24, s[84:87], s23 offen offset:66
  buffer_load_ushort v39, v24, s[84:87], s23 offen offset:98
  s_branch L_cp_img_st
L_cp_img8:
  s_waitcnt vmcnt(7)
  buffer_load_ushort v32, v24, s[84:87], s23 offen offset:0
  s_waitcnt vmcnt(7)
  buffer_load_ushort v33, v24, s[84:87], s23 offen offset:2
  s_waitcnt vmcnt(7)
  buffer_load_ushort v34, v24, s[84:87], s23 offen offset:32
  s_waitcnt vmcnt(7)
  buffer_load_ushort v35, v24, s[84:87], s23 offen offset:34
  s_waitcnt vmcnt(7)
  buffer_load_ushort v36, v24, s[84:87], s23 offen offset:64
  s_waitcnt vmcnt(7)
  buffer_load_ushort v37, v24, s[84:87], s23 offen offset:66
  s_waitcnt vmcnt(7)
  buffer_load_ushort v38, v24, s[84:87], s23 offen offset:96
  s_waitcnt vmcnt(7)
  buffer_load_ushort v39, v24, s[84:87], s23 offen offset:98
L_cp_img_st:
  s_lshl_b32 s23, s8, 10
  s_add_u32 s23, s23, 851968
  s_waitcnt vmcnt(0)
  v_lshl_or_b32 v28, v33, 16, v32
  v_lshl_or_b32 v29, v35, 16, v34
  v_lshl_or_b32 v30, v37, 16, v36
  v_lshl_or_b32 v31, v39, 16, v38
  buffer_store_dwordx4 v[28:31], v0, s[4:7], s23 offen sc1
L_cp_img_done:
  v_lshrrev_b32 v25, 4, v11
  v_and_b32 v26, 15, v11
  s_and_b32 s96, s9, 1
  s_lshl_b32 s96, s96, 2
  v_add_u32 v27, s96, v25
  v_and_b32 v27, 7, v27
  v_lshlrev_b32 v27, 1, v27
  v_xor_b32 v27, v26, v27
  v_lshlrev_b32 v27, 4, v27
  v_and_b32 v28, 1, v25
  v_lshlrev_b32 v28, 4, v28
  v_lshrrev_b32 v29, 1, v25
  v_lshl_add_u32 v28, v29, 1, v28
  v_lshlrev_b32 v28, 13, v28
  v_add_u32 v20, v28, v27
  v_lshlrev_b32 v28, 13, v25
  v_add_u32 v21, v28, v27
  v_bfe_u32 v28, v11, 2, 2
  v_and_b32 v29, 3, v11
  v_and_b32 v30, 1, v25
  v_lshlrev_b32 v30, 2, v30
  v_add_u32 v30, v30, v28
  v_and_b32 v30, 7, v30
  s_lshl_b32 s96, s9, 1
  v_xor_b32 v31, s96, v30
  v_xor_b32 v32, 1, v31
  v_lshrrev_b32 v33, 1, v29
  v_and_b32 v34, 1, v29
  v_lshlrev_b32 v34, 3, v34
  v_lshlrev_b32 v35, 10, v25
  v_lshl_add_u32 v35, v28, 8, v35
  v_add_u32 v35, v35, v34
  v_add_u32 v35, 24576, v35
  v_lshl_add_u32 v31, v31, 1, v33
  v_lshl_add_u32 v22, v31, 4, v35
  v_lshl_add_u32 v32, v32, 1, v33
  v_lshl_add_u32 v23, v32, 4, v35
  v_add_u32 v24, 0x10000, v22
  v_add_u32 v36, 0x10000, v23
  s_lshl_b32 s89, s8, 8
  s_lshr_b32 s96, s9, 1
  s_lshl_b32 s96, s96, 2
  s_and_b32 s97, s9, 1
  s_add_u32 s90, s96, s97
  s_lshl_b32 s90, s90, 13
  s_add_u32 s90, s90, s89
  s_lshl_b32 s97, s97, 5
  s_add_u32 s91, s96, s97
  s_lshl_b32 s91, s91, 13
  s_add_u32 s91, s91, s89
  s_lshl_b32 s88, s9, 10
  s_add_u32 s88, s88, 24576
  s_mov_b32 s86, 4718592
  s_mov_b32 s87, 0x00020000
  v_and_b32 v46, 15, v11
  v_and_b32 v47, 48, v11
  s_and_b32 s96, s9, 1
  s_lshl_b32 s96, s96, 2
  s_add_u32 s97, s96, 0
  s_and_b32 s97, s97, 7
  s_lshl_b32 s97, s97, 1
  v_xor_b32 v48, s97, v46
  v_or_b32 v48, v48, v47
  v_lshlrev_b32 v40, 4, v48
  s_add_u32 s97, s96, 1
  s_and_b32 s97, s97, 7
  s_lshl_b32 s97, s97, 1
  v_xor_b32 v48, s97, v46
  v_or_b32 v48, v48, v47
  v_lshlrev_b32 v41, 4, v48
  s_add_u32 s97, s96, 2
  s_and_b32 s97, s97, 7
  s_lshl_b32 s97, s97, 1
  v_xor_b32 v48, s97, v46
  v_or_b32 v48, v48, v47
  v_lshlrev_b32 v42, 4, v48
  s_add_u32 s97, s96, 3
  s_and_b32 s97, s97, 7
  s_lshl_b32 s97, s97, 1
  v_xor_b32 v48, s97, v46
  v_or_b32 v48, v48, v47
  v_lshlrev_b32 v43, 4, v48
  v_lshrrev_b32 v46, 4, v11
  v_bfe_u32 v47, v11, 2, 2
  v_and_b32 v48, 1, v46
  v_lshlrev_b32 v48, 2, v48
  v_add_u32 v48, v48, v47
  v_and_b32 v48, 7, v48
  v_lshlrev_b32 v48, 5, v48
  v_lshlrev_b32 v49, 12, v46
  v_lshl_add_u32 v49, v47, 10, v49
  v_add_u32 v49, v49, v48
  v_bfe_u32 v48, v11, 1, 1
  v_lshl_add_u32 v49, v48, 4, v49
  v_and_b32 v48, 1, v11
  v_lshl_add_u32 v49, v48, 3, v49
  s_lshl_b32 s96, s9, 8
  s_add_u32 s96, s96, 24576
  v_add_u32 v44, s96, v49
  v_add_u32 v45, 0x10000, v44
  s_lshl_b32 s96, s8, 7
  s_lshr_b32 s97, s9, 1
  s_lshl_b32 s97, s97, 4
  s_add_u32 s96, s96, s97
  s_and_b32 s97, s9, 1
  s_lshl_b32 s97, s97, 2
  s_add_u32 s96, s96, s97
  s_mul_i32 s98, s96, 1152
  s_mov_b32 s92, s82
  s_mov_b32 s93, s83
  s_mov_b32 s94, 4718592
  s_mov_b32 s95, 0x00020000
  s_lshl_b32 s99, s9, 12
  s_add_u32 s99, s99, 24576
  s_cmp_eq_u32 s9, 0
  s_cbranch_scc1 L_cw0
  s_cmp_eq_u32 s9, 1
  s_cbranch_scc1 L_cw1
  s_cmp_eq_u32 s9, 2
  s_cbranch_scc1 L_cw2
  s_branch L_cw3
L_cw0:
  s_mov_b32 s84, s76
  s_mov_b32 s85, s77
  s_add_u32 m0, s88, 0
  s_add_u32 s97, s90, 0
  buffer_load_dwordx4 v20, s[84:87], s97 offen lds
  s_add_u32 m0, s88, 4096
  s_add_u32 s97, s90, 262144
  buffer_load_dwordx4 v20, s[84:87], s97 offen lds
  s_add_u32 m0, s88, 8192
  s_add_u32 s97, s90, 65536
  buffer_load_dwordx4 v20, s[84:87], s97 offen lds
  s_add_u32 m0, s88, 12288
  s_add_u32 s97, s90, 327680
  buffer_load_dwordx4 v20, s[84:87], s97 offen lds
  s_add_u32 m0, s88, 16384
  s_add_u32 s97, s90, 524288
  buffer_load_dwordx4 v20, s[84:87], s97 offen lds
  s_add_u32 m0, s88, 20480
  s_add_u32 s97, s90, 786432
  buffer_load_dwordx4 v20, s[84:87], s97 offen lds
  s_add_u32 m0, s88, 24576
  s_add_u32 s97, s90, 589824
  buffer_load_dwordx4 v20, s[84:87], s97 offen lds
  s_add_u32 m0, s88, 28672
  s_add_u32 s97, s90, 851968
  buffer_load_dwordx4 v20, s[84:87], s97 offen lds
  s_add_u32 m0, s88, 32768
  s_add_u32 s97, s90, 1048576
  buffer_load_dwordx4 v20, s[84:87], s97 offen lds
  s_add_u32 m0, s88, 36864
  s_add_u32 s97, s90, 1310720
  buffer_load_dwordx4 v20, s[84:87], s97 offen lds
  s_add_u32 m0, s88, 40960
  s_add_u32 s97, s90, 1114112
  buffer_load_dwordx4 v20, s[84:87], s97 offen lds
  s_add_u32 m0, s88, 45056
  s_add_u32 s97, s90, 1376256
  buffer_load_dwordx4 v20, s[84:87], s97 offen lds
  s_add_u32 m0, s88, 49152
  s_add_u32 s97, s90, 1572864
  buffer_load_dwordx4 v20, s[84:87], s97 offen lds
  s_add_u32 m0, s88, 53248
  s_add_u32 s97, s90, 1835008
  buffer_load_dwordx4 v20, s[84:87], s97 offen lds
  s_add_u32 m0, s88, 57344
  s_add_u32 s97, s90, 1638400
  buffer_load_dwordx4 v20, s[84:87], s97 offen lds
  s_add_u32 m0, s88, 61440
  s_add_u32 s97, s90, 1900544
  buffer_load_dwordx4 v20, s[84:87], s97 offen lds
  s_add_u32 m0, s88, 65536
  s_add_u32 s97, s90, 2097152
  buffer_load_dwordx4 v20, s[84:87], s97 offen lds
  s_add_u32 m0, s88, 69632
  s_add_u32 s97, s90, 2359296
  buffer_load_dwordx4 v20, s[84:87], s97 offen lds
  s_add_u32 m0, s88, 73728
  s_add_u32 s97, s90, 2162688
  buffer_load_dwordx4 v20, s[84:87], s97 offen lds
  s_add_u32 m0, s88, 77824
  s_add_u32 s97, s90, 2424832
  buffer_load_dwordx4 v20, s[84:87], s97 offen lds
  s_add_u32 m0, s88, 81920
  s_add_u32 s97, s90, 2621440
  buffer_load_dwordx4 v20, s[84:87], s97 offen lds
  s_add_u32 m0, s88, 86016
  s_add_u32 s97, s90, 2883584
  buffer_load_dwordx4 v20, s[84:87], s97 offen lds
  s_add_u32 m0, s88, 90112
  s_add_u32 s97, s90, 2686976
  buffer_load_dwordx4 v20, s[84:87], s97 offen lds
  s_add_u32 m0, s88, 94208
  s_add_u32 s97, s90, 2949120
  buffer_load_dwordx4 v20, s[84:87], s97 offen lds
  s_add_u32 m0, s88, 98304
  s_add_u32 s97, s90, 3145728
  buffer_load_dwordx4 v20, s[84:87], s97 offen lds
  s_add_u32 m0, s88, 102400
  s_add_u32 s97, s90, 3407872
  buffer_load_dwordx4 v20, s[84:87], s97 offen lds
  s_add_u32 m0, s88, 106496
  s_add_u32 s97, s90, 3211264
  buffer_load_dwordx4 v20, s[84:87], s97 offen lds
  s_add_u32 m0, s88, 110592
  s_add_u32 s97, s90, 3473408
  buffer_load_dwordx4 v20, s[84:87], s97 offen lds
  s_waitcnt vmcnt(24) lgkmcnt(0)
  s_barrier
  s_add_u32 m0, s88, 114688
  s_add_u32 s97, s90, 3670016
  buffer_load_dwordx4 v20, s[84:87], s97 offen lds
  s_add_u32 m0, s88, 118784
  s_add_u32 s97, s90, 3932160
  buffer_load_dwordx4 v20, s[84:87], s97 offen lds
  s_add_u32 m0, s88, 122880
  s_add_u32 s97, s90, 3735552
  buffer_load_dwordx4 v20, s[84:87], s97 offen lds
  s_add_u32 m0, s88, 126976
  s_add_u32 s97, s90, 3997696
  buffer_load_dwordx4 v20, s[84:87], s97 offen lds
  ds_read_b64_tr_b16 a[0:1], v22 offset:0
  ds_read_b64_tr_b16 a[2:3], v22 offset:4096
  ds_read_b64_tr_b16 a[4:5], v22 offset:8192
  ds_read_b64_tr_b16 a[6:7], v22 offset:12288
  ds_read_b64_tr_b16 a[8:9], v23 offset:0
  ds_read_b64_tr_b16 a[10:11], v23 offset:4096
  ds_read_b64_tr_b16 a[12:13], v23 offset:8192
  ds_read_b64_tr_b16 a[14:15], v23 offset:12288
  s_waitcnt vmcnt(24) lgkmcnt(0)
  s_barrier
  s_add_u32 m0, s88, 0
  s_add_u32 s97, s91, 4194304
  buffer_load_dwordx4 v21, s[84:87], s97 offen lds
  s_add_u32 m0, s88, 4096
  s_add_u32 s97, s91, 4325376
  buffer_load_dwordx4 v21, s[84:87], s97 offen lds
  s_add_u32 m0, s88, 8192
  s_add_u32 s97, s91, 4259840
  buffer_load_dwordx4 v21, s[84:87], s97 offen lds
  s_add_u32 m0, s88, 12288
  s_add_u32 s97, s91, 4390912
  buffer_load_dwordx4 v21, s[84:87], s97 offen lds
  ds_read_b64_tr_b16 a[48:49], v22 offset:16384
  ds_read_b64_tr_b16 a[50:51], v22 offset:20480
  ds_read_b64_tr_b16 a[52:53], v22 offset:24576
  ds_read_b64_tr_b16 a[54:55], v22 offset:28672
  ds_read_b64_tr_b16 a[56:57], v23 offset:16384
  ds_read_b64_tr_b16 a[58:59], v23 offset:20480
  ds_read_b64_tr_b16 a[60:61], v23 offset:24576
  ds_read_b64_tr_b16 a[62:63], v23 offset:28672
  s_waitcnt vmcnt(24) lgkmcnt(0)
  s_barrier
  s_add_u32 m0, s99, 16384
  s_add_u32 s97, s98, 0
  buffer_load_dwordx4 v40, s[92:95], s97 offen lds
  s_add_u32 m0, s99, 17408
  s_add_u32 s97, s98, 1152
  buffer_load_dwordx4 v41, s[92:95], s97 offen lds
  s_add_u32 m0, s99, 18432
  s_add_u32 s97, s98, 9216
  buffer_load_dwordx4 v42, s[92:95], s97 offen lds
  s_add_u32 m0, s99, 19456
  s_add_u32 s97, s98, 10368
  buffer_load_dwordx4 v43, s[92:95], s97 offen lds
  ds_read_b64_tr_b16 a[96:97], v22 offset:32768
  ds_read_b64_tr_b16 a[98:99], v22 offset:36864
  ds_read_b64_tr_b16 a[100:101], v22 offset:40960
  ds_read_b64_tr_b16 a[102:103], v22 offset:45056
  ds_read_b64_tr_b16 a[104:105], v23 offset:32768
  ds_read_b64_tr_b16 a[106:107], v23 offset:36864
  ds_read_b64_tr_b16 a[108:109], v23 offset:40960
  ds_read_b64_tr_b16 a[110:111], v23 offset:45056
  s_waitcnt vmcnt(24) lgkmcnt(0)
  s_barrier
  s_add_u32 m0, s99, 32768
  s_add_u32 s97, s98, 2304
  buffer_load_dwordx4 v40, s[92:95], s97 offen lds
  s_add_u32 m0, s99, 33792
  s_add_u32 s97, s98, 3456
  buffer_load_dwordx4 v41, s[92:95], s97 offen lds
  s_add_u32 m0, s99, 34816
  s_add_u32 s97, s98, 11520
  buffer_load_dwordx4 v42, s[92:95], s97 offen lds
  s_add_u32 m0, s99, 35840
  s_add_u32 s97, s98, 12672
  buffer_load_dwordx4 v43, s[92:95], s97 offen lds
  ds_read_b64_tr_b16 a[144:145], v22 offset:49152
  ds_read_b64_tr_b16 a[146:147], v22 offset:53248
  ds_read_b64_tr_b16 a[148:149], v22 offset:57344
  ds_read_b64_tr_b16 a[150:151], v22 offset:61440
  ds_read_b64_tr_b16 a[152:153], v23 offset:49152
  ds_read_b64_tr_b16 a[154:155], v23 offset:53248
  ds_read_b64_tr_b16 a[156:157], v23 offset:57344
  ds_read_b64_tr_b16 a[158:159], v23 offset:61440
  s_waitcnt vmcnt(24) lgkmcnt(0)
  s_barrier
  s_mov_b32 s84, s80
  s_mov_b32 s85, s81
  s_add_u32 m0, s88, 49152
  s_add_u32 s97, s90, 0
  buffer_load_dwordx4 v20, s[84:87], s97 offen lds
  s_add_u32 m0, s88, 53248
  s_add_u32 s97, s90, 262144
  buffer_load_dwordx4 v20, s[84:87], s97 offen lds
  s_add_u32 m0, s88, 57344
  s_add_u32 s97, s90, 65536
  buffer_load_dwordx4 v20, s[84:87], s97 offen lds
  s_add_u32 m0, s88, 61440
  s_add_u32 s97, s90, 327680
  buffer_load_dwordx4 v20, s[84:87], s97 offen lds
  ds_read_b64_tr_b16 a[32:33], v24 offset:0
  ds_read_b64_tr_b16 a[34:35], v24 offset:4096
  ds_read_b64_tr_b16 a[36:37], v24 offset:8192
  ds_read_b64_tr_b16 a[38:39], v24 offset:12288
  ds_read_b64_tr_b16 a[40:41], v36 offset:0
  ds_read_b64_tr_b16 a[42:43], v36 offset:4096
  ds_read_b64_tr_b16 a[44:45], v36 offset:8192
  ds_read_b64_tr_b16 a[46:47], v36 offset:12288
  s_waitcnt vmcnt(24) lgkmcnt(0)
  s_barrier
  s_add_u32 m0, s88, 65536
  s_add_u32 s97, s90, 524288
  buffer_load_dwordx4 v20, s[84:87], s97 offen lds
  s_add_u32 m0, s88, 69632
  s_add_u32 s97, s90, 786432
  buffer_load_dwordx4 v20, s[84:87], s97 offen lds
  s_add_u32 m0, s88, 73728
  s_add_u32 s97, s90, 589824
  buffer_load_dwordx4 v20, s[84:87], s97 offen lds
  s_add_u32 m0, s88, 77824
  s_add_u32 s97, s90, 851968
  buffer_load_dwordx4 v20, s[84:87], s97 offen lds
  ds_read_b64_tr_b16 a[80:81], v24 offset:16384
  ds_read_b64_tr_b16 a[82:83], v24 offset:20480
  ds_read_b64_tr_b16 a[84:85], v24 offset:24576
  ds_read_b64_tr_b16 a[86:87], v24 offset:28672
  ds_read_b64_tr_b16 a[88:89], v36 offset:16384
  ds_read_b64_tr_b16 a[90:91], v36 offset:20480
  ds_read_b64_tr_b16 a[92:93], v36 offset:24576
  ds_read_b64_tr_b16 a[94:95], v36 offset:28672
  s_waitcnt vmcnt(24) lgkmcnt(0)
  s_barrier
  s_add_u32 m0, s88, 81920
  s_add_u32 s97, s90, 1048576
  buffer_load_dwordx4 v20, s[84:87], s97 offen lds
  s_add_u32 m0, s88, 86016
  s_add_u32 s97, s90, 1310720
  buffer_load_dwordx4 v20, s[84:87], s97 offen lds
  s_add_u32 m0, s88, 90112
  s_add_u32 s97, s90, 1114112
  buffer_load_dwordx4 v20, s[84:87], s97 offen lds
  s_add_u32 m0, s88, 94208
  s_add_u32 s97, s90, 1376256
  buffer_load_dwordx4 v20, s[84:87], s97 offen lds
  ds_read_b64_tr_b16 a[128:129], v24 offset:32768
  ds_read_b64_tr_b16 a[130:131], v24 offset:36864
  ds_read_b64_tr_b16 a[132:133], v24 offset:40960
  ds_read_b64_tr_b16 a[134:135], v24 offset:45056
  ds_read_b64_tr_b16 a[136:137], v36 offset:32768
  ds_read_b64_tr_b16 a[138:139], v36 offset:36864
  ds_read_b64_tr_b16 a[140:141], v36 offset:40960
  ds_read_b64_tr_b16 a[142:143], v36 offset:45056
  s_waitcnt vmcnt(24) lgkmcnt(0)
  s_barrier
  s_add_u32 m0, s88, 98304
  s_add_u32 s97, s90, 1572864
  buffer_load_dwordx4 v20, s[84:87], s97 offen lds
  s_add_u32 m0, s88, 102400
  s_add_u32 s97, s90, 1835008
  buffer_load_dwordx4 v20, s[84:87], s97 offen lds
  s_add_u32 m0, s88, 106496
  s_add_u32 s97, s90, 1638400
  buffer_load_dwordx4 v20, s[84:87], s97 offen lds
  s_add_u32 m0, s88, 110592
  s_add_u32 s97, s90, 1900544
  buffer_load_dwordx4 v20, s[84:87], s97 offen lds
  ds_read_b64_tr_b16 a[176:177], v24 offset:49152
  ds_read_b64_tr_b16 a[178:179], v24 offset:53248
  ds_read_b64_tr_b16 a[180:181], v24 offset:57344
  ds_read_b64_tr_b16 a[182:183], v24 offset:61440
  ds_read_b64_tr_b16 a[184:185], v36 offset:49152
  ds_read_b64_tr_b16 a[186:187], v36 offset:53248
  ds_read_b64_tr_b16 a[188:189], v36 offset:57344
  ds_read_b64_tr_b16 a[190:191], v36 offset:61440
  s_waitcnt vmcnt(24) lgkmcnt(0)
  s_barrier
  s_add_u32 m0, s88, 114688
  s_add_u32 s97, s90, 2097152
  buffer_load_dwordx4 v20, s[84:87], s97 offen lds
  s_add_u32 m0, s88, 118784
  s_add_u32 s97, s90, 2359296
  buffer_load_dwordx4 v20, s[84:87], s97 offen lds
  s_add_u32 m0, s88, 122880
  s_add_u32 s97, s90, 2162688
  buffer_load_dwordx4 v20, s[84:87], s97 offen lds
  s_add_u32 m0, s88, 126976
  s_add_u32 s97, s90, 2424832
  buffer_load_dwordx4 v20, s[84:87], s97 offen lds
  ds_read_b64_tr_b16 a[192:193], v22 offset:0
  ds_read_b64_tr_b16 a[194:195], v22 offset:4096
  ds_read_b64_tr_b16 a[196:197], v22 offset:8192
  ds_read_b64_tr_b16 a[198:199], v22 offset:12288
  ds_read_b64_tr_b16 a[200:201], v23 offset:0
  ds_read_b64_tr_b16 a[202:203], v23 offset:4096
  ds_read_b64_tr_b16 a[204:205], v23 offset:8192
  ds_read_b64_tr_b16 a[206:207], v23 offset:12288
  s_waitcnt vmcnt(24) lgkmcnt(0)
  s_barrier
  s_add_u32 m0, s88, 0
  s_add_u32 s97, s90, 2621440
  buffer_load_dwordx4 v20, s[84:87], s97 offen lds
  s_add_u32 m0, s88, 4096
  s_add_u32 s97, s90, 2883584
  buffer_load_dwordx4 v20, s[84:87], s97 offen lds
  s_add_u32 m0, s88, 8192
  s_add_u32 s97, s90, 2686976
  buffer_load_dwordx4 v20, s[84:87], s97 offen lds
  s_add_u32 m0, s88, 12288
  s_add_u32 s97, s90, 2949120
  buffer_load_dwordx4 v20, s[84:87], s97 offen lds
  v_xor_b32 v50, 0, v44
  ds_read_b64_tr_b16 v[184:185], v50 offset:16384
  v_xor_b32 v50, 32, v44
  ds_read_b64_tr_b16 v[192:193], v50 offset:16384
  v_xor_b32 v50, 64, v44
  ds_read_b64_tr_b16 v[200:201], v50 offset:16384
  v_xor_b32 v50, 96, v44
  ds_read_b64_tr_b16 v[208:209], v50 offset:16384
  v_xor_b32 v50, 128, v44
  ds_read_b64_tr_b16 v[216:217], v50 offset:16384
  v_xor_b32 v50, 160, v44
  ds_read_b64_tr_b16 v[224:225], v50 offset:16384
  v_xor_b32 v50, 192, v44
  ds_read_b64_tr_b16 v[232:233], v50 offset:16384
  v_xor_b32 v50, 224, v44
  ds_read_b64_tr_b16 v[240:241], v50 offset:16384
  s_waitcnt vmcnt(24) lgkmcnt(0)
  s_barrier
  s_add_u32 m0, s88, 16384
  s_add_u32 s97, s90, 3145728
  buffer_load_dwordx4 v20, s[84:87], s97 offen lds
  s_add_u32 m0, s88, 20480
  s_add_u32 s97, s90, 3407872
  buffer_load_dwordx4 v20, s[84:87], s97 offen lds
  s_add_u32 m0, s88, 24576
  s_add_u32 s97, s90, 3211264
  buffer_load_dwordx4 v20, s[84:87], s97 offen lds
  s_add_u32 m0, s88, 28672
  s_add_u32 s97, s90, 3473408
  buffer_load_dwordx4 v20, s[84:87], s97 offen lds
  v_xor_b32 v50, 0, v44
  ds_read_b64_tr_b16 v[186:187], v50 offset:32768
  v_xor_b32 v50, 32, v44
  ds_read_b64_tr_b16 v[194:195], v50 offset:32768
  v_xor_b32 v50, 64, v44
  ds_read_b64_tr_b16 v[202:203], v50 offset:32768
  v_xor_b32 v50, 96, v44
  ds_read_b64_tr_b16 v[210:211], v50 offset:32768
  v_xor_b32 v50, 128, v44
  ds_read_b64_tr_b16 v[218:219], v50 offset:32768
  v_xor_b32 v50, 160, v44
  ds_read_b64_tr_b16 v[226:227], v50 offset:32768
  v_xor_b32 v50, 192, v44
  ds_read_b64_tr_b16 v[234:235], v50 offset:32768
  v_xor_b32 v50, 224, v44
  ds_read_b64_tr_b16 v[242:243], v50 offset:32768
  s_waitcnt vmcnt(24) lgkmcnt(0)
  s_barrier
  s_add_u32 m0, s88, 32768
  s_add_u32 s97, s90, 3670016
  buffer_load_dwordx4 v20, s[84:87], s97 offen lds
  s_add_u32 m0, s88, 36864
  s_add_u32 s97, s90, 3932160
  buffer_load_dwordx4 v20, s[84:87], s97 offen lds
  s_add_u32 m0, s88, 40960
  s_add_u32 s97, s90, 3735552
  buffer_load_dwordx4 v20, s[84:87], s97 offen lds
  s_add_u32 m0, s88, 45056
  s_add_u32 s97, s90, 3997696
  buffer_load_dwordx4 v20, s[84:87], s97 offen lds
  ds_read_b64_tr_b16 a[224:225], v22 offset:49152
  ds_read_b64_tr_b16 a[226:227], v22 offset:53248
  ds_read_b64_tr_b16 a[228:229], v22 offset:57344
  ds_read_b64_tr_b16 a[230:231], v22 offset:61440
  ds_read_b64_tr_b16 a[232:233], v23 offset:49152
  ds_read_b64_tr_b16 a[234:235], v23 offset:53248
  ds_read_b64_tr_b16 a[236:237], v23 offset:57344
  ds_read_b64_tr_b16 a[238:239], v23 offset:61440
  s_waitcnt vmcnt(24) lgkmcnt(0)
  s_barrier
  s_add_u32 m0, s88, 49152
  s_add_u32 s97, s91, 4194304
  buffer_load_dwordx4 v21, s[84:87], s97 offen lds
  s_add_u32 m0, s88, 53248
  s_add_u32 s97, s91, 4325376
  buffer_load_dwordx4 v21, s[84:87], s97 offen lds
  s_add_u32 m0, s88, 57344
  s_add_u32 s97, s91, 4259840
  buffer_load_dwordx4 v21, s[84:87], s97 offen lds
  s_add_u32 m0, s88, 61440
  s_add_u32 s97, s91, 4390912
  buffer_load_dwordx4 v21, s[84:87], s97 offen lds
  ds_read_b64_tr_b16 a[240:241], v24 offset:0
  ds_read_b64_tr_b16 a[242:243], v24 offset:4096
  ds_read_b64_tr_b16 a[244:245], v24 offset:8192
  ds_read_b64_tr_b16 a[246:247], v24 offset:12288
  ds_read_b64_tr_b16 a[248:249], v36 offset:0
  ds_read_b64_tr_b16 a[250:251], v36 offset:4096
  ds_read_b64_tr_b16 a[252:253], v36 offset:8192
  ds_read_b64_tr_b16 a[254:255], v36 offset:12288
  s_waitcnt vmcnt(24) lgkmcnt(0)
  s_barrier
  s_add_u32 m0, s99, 65536
  s_add_u32 s97, s98, 36864
  buffer_load_dwordx4 v40, s[92:95], s97 offen lds
  s_add_u32 m0, s99, 66560
  s_add_u32 s97, s98, 38016
  buffer_load_dwordx4 v41, s[92:95], s97 offen lds
  s_add_u32 m0, s99, 67584
  s_add_u32 s97, s98, 46080
  buffer_load_dwordx4 v42, s[92:95], s97 offen lds
  s_add_u32 m0, s99, 68608
  s_add_u32 s97, s98, 47232
  buffer_load_dwordx4 v43, s[92:95], s97 offen lds
  ds_read_b64_tr_b16 v[72:73], v24 offset:16384
  ds_read_b64_tr_b16 v[74:75], v24 offset:20480
  ds_read_b64_tr_b16 v[76:77], v24 offset:24576
  ds_read_b64_tr_b16 v[78:79], v24 offset:28672
  ds_read_b64_tr_b16 v[80:81], v36 offset:16384
  ds_read_b64_tr_b16 v[82:83], v36 offset:20480
  ds_read_b64_tr_b16 v[84:85], v36 offset:24576
  ds_read_b64_tr_b16 v[86:87], v36 offset:28672
  s_waitcnt vmcnt(24) lgkmcnt(0)
  s_barrier
  s_add_u32 m0, s99, 81920
  s_add_u32 s97, s98, 39168
  buffer_load_dwordx4 v40, s[92:95], s97 offen lds
  s_add_u32 m0, s99, 82944
  s_add_u32 s97, s98, 40320
  buffer_load_dwordx4 v41, s[92:95], s97 offen lds
  s_add_u32 m0, s99, 83968
  s_add_u32 s97, s98, 48384
  buffer_load_dwordx4 v42, s[92:95], s97 offen lds
  s_add_u32 m0, s99, 84992
  s_add_u32 s97, s98, 49536
  buffer_load_dwordx4 v43, s[92:95], s97 offen lds
  ds_read_b64_tr_b16 v[88:89], v24 offset:32768
  ds_read_b64_tr_b16 v[90:91], v24 offset:36864
  ds_read_b64_tr_b16 v[92:93], v24 offset:40960
  ds_read_b64_tr_b16 v[94:95], v24 offset:45056
  ds_read_b64_tr_b16 v[96:97], v36 offset:32768
  ds_read_b64_tr_b16 v[98:99], v36 offset:36864
  ds_read_b64_tr_b16 v[100:101], v36 offset:40960
  ds_read_b64_tr_b16 v[102:103], v36 offset:45056
  s_waitcnt vmcnt(24) lgkmcnt(0)
  s_barrier
  s_mov_b32 s84, s78
  s_mov_b32 s85, s79
  s_add_u32 m0, s88, 98304
  s_add_u32 s97, s90, 0
  buffer_load_dwordx4 v20, s[84:87], s97 offen lds
  s_add_u32 m0, s88, 102400
  s_add_u32 s97, s90, 262144
  buffer_load_dwordx4 v20, s[84:87], s97 offen lds
  s_add_u32 m0, s88, 106496
  s_add_u32 s97, s90, 65536
  buffer_load_dwordx4 v20, s[84:87], s97 offen lds
  s_add_u32 m0, s88, 110592
  s_add_u32 s97, s90, 327680
  buffer_load_dwordx4 v20, s[84:87], s97 offen lds
  ds_read_b64_tr_b16 v[104:105], v24 offset:49152
  ds_read_b64_tr_b16 v[106:107], v24 offset:53248
  ds_read_b64_tr_b16 v[108:109], v24 offset:57344
  ds_read_b64_tr_b16 v[110:111], v24 offset:61440
  ds_read_b64_tr_b16 v[112:113], v36 offset:49152
  ds_read_b64_tr_b16 v[114:115], v36 offset:53248
  ds_read_b64_tr_b16 v[116:117], v36 offset:57344
  ds_read_b64_tr_b16 v[118:119], v36 offset:61440
  s_waitcnt vmcnt(24) lgkmcnt(0)
  s_barrier
  s_add_u32 m0, s88, 114688
  s_add_u32 s97, s90, 524288
  buffer_load_dwordx4 v20, s[84:87], s97 offen lds
  s_add_u32 m0, s88, 118784
  s_add_u32 s97, s90, 786432
  buffer_load_dwordx4 v20, s[84:87], s97 offen lds
  s_add_u32 m0, s88, 122880
  s_add_u32 s97, s90, 589824
  buffer_load_dwordx4 v20, s[84:87], s97 offen lds
  s_add_u32 m0, s88, 126976
  s_add_u32 s97, s90, 851968
  buffer_load_dwordx4 v20, s[84:87], s97 offen lds
  ds_read_b64_tr_b16 v[120:121], v22 offset:0
  ds_read_b64_tr_b16 v[122:123], v22 offset:4096
  ds_read_b64_tr_b16 v[124:125], v22 offset:8192
  ds_read_b64_tr_b16 v[126:127], v22 offset:12288
  ds_read_b64_tr_b16 v[128:129], v23 offset:0
  ds_read_b64_tr_b16 v[130:131], v23 offset:4096
  ds_read_b64_tr_b16 v[132:133], v23 offset:8192
  ds_read_b64_tr_b16 v[134:135], v23 offset:12288
  s_waitcnt vmcnt(24) lgkmcnt(0)
  s_barrier
  s_add_u32 m0, s88, 0
  s_add_u32 s97, s90, 1048576
  buffer_load_dwordx4 v20, s[84:87], s97 offen lds
  s_add_u32 m0, s88, 4096
  s_add_u32 s97, s90, 1310720
  buffer_load_dwordx4 v20, s[84:87], s97 offen lds
  s_add_u32 m0, s88, 8192
  s_add_u32 s97, s90, 1114112
  buffer_load_dwordx4 v20, s[84:87], s97 offen lds
  s_add_u32 m0, s88, 12288
  s_add_u32 s97, s90, 1376256
  buffer_load_dwordx4 v20, s[84:87], s97 offen lds
  ds_read_b64_tr_b16 v[136:137], v22 offset:16384
  ds_read_b64_tr_b16 v[138:139], v22 offset:20480
  ds_read_b64_tr_b16 v[140:141], v22 offset:24576
  ds_read_b64_tr_b16 v[142:143], v22 offset:28672
  ds_read_b64_tr_b16 v[144:145], v23 offset:16384
  ds_read_b64_tr_b16 v[146:147], v23 offset:20480
  ds_read_b64_tr_b16 v[148:149], v23 offset:24576
  ds_read_b64_tr_b16 v[150:151], v23 offset:28672
  s_waitcnt vmcnt(24) lgkmcnt(0)
  s_barrier
  s_add_u32 m0, s88, 16384
  s_add_u32 s97, s90, 1572864
  buffer_load_dwordx4 v20, s[84:87], s97 offen lds
  s_add_u32 m0, s88, 20480
  s_add_u32 s97, s90, 1835008
  buffer_load_dwordx4 v20, s[84:87], s97 offen lds
  s_add_u32 m0, s88, 24576
  s_add_u32 s97, s90, 1638400
  buffer_load_dwordx4 v20, s[84:87], s97 offen lds
  s_add_u32 m0, s88, 28672
  s_add_u32 s97, s90, 1900544
  buffer_load_dwordx4 v20, s[84:87], s97 offen lds
  ds_read_b64_tr_b16 v[152:153], v22 offset:32768
  ds_read_b64_tr_b16 v[154:155], v22 offset:36864
  ds_read_b64_tr_b16 v[156:157], v22 offset:40960
  ds_read_b64_tr_b16 v[158:159], v22 offset:45056
  ds_read_b64_tr_b16 v[160:161], v23 offset:32768
  ds_read_b64_tr_b16 v[162:163], v23 offset:36864
  ds_read_b64_tr_b16 v[164:165], v23 offset:40960
  ds_read_b64_tr_b16 v[166:167], v23 offset:45056
  s_waitcnt vmcnt(24) lgkmcnt(0)
  s_barrier
  s_add_u32 m0, s88, 32768
  s_add_u32 s97, s91, 4194304
  buffer_load_dwordx4 v21, s[84:87], s97 offen lds
  s_add_u32 m0, s88, 36864
  s_add_u32 s97, s91, 4325376
  buffer_load_dwordx4 v21, s[84:87], s97 offen lds
  s_add_u32 m0, s88, 40960
  s_add_u32 s97, s91, 4259840
  buffer_load_dwordx4 v21, s[84:87], s97 offen lds
  s_add_u32 m0, s88, 45056
  s_add_u32 s97, s91, 4390912
  buffer_load_dwordx4 v21, s[84:87], s97 offen lds
  ds_read_b64_tr_b16 v[168:169], v22 offset:49152
  ds_read_b64_tr_b16 v[170:171], v22 offset:53248
  ds_read_b64_tr_b16 v[172:173], v22 offset:57344
  ds_read_b64_tr_b16 v[174:175], v22 offset:61440
  ds_read_b64_tr_b16 v[176:177], v23 offset:49152
  ds_read_b64_tr_b16 v[178:179], v23 offset:53248
  ds_read_b64_tr_b16 v[180:181], v23 offset:57344
  ds_read_b64_tr_b16 v[182:183], v23 offset:61440
  s_waitcnt vmcnt(24) lgkmcnt(0)
  s_barrier
  v_xor_b32 v50, 0, v45
  ds_read_b64_tr_b16 v[188:189], v50 offset:0
  v_xor_b32 v50, 32, v45
  ds_read_b64_tr_b16 v[196:197], v50 offset:0
  v_xor_b32 v50, 64, v45
  ds_read_b64_tr_b16 v[204:205], v50 offset:0
  v_xor_b32 v50, 96, v45
  ds_read_b64_tr_b16 v[212:213], v50 offset:0
  v_xor_b32 v50, 128, v45
  ds_read_b64_tr_b16 v[220:221], v50 offset:0
  v_xor_b32 v50, 160, v45
  ds_read_b64_tr_b16 v[228:229], v50 offset:0
  v_xor_b32 v50, 192, v45
  ds_read_b64_tr_b16 v[236:237], v50 offset:0
  v_xor_b32 v50, 224, v45
  ds_read_b64_tr_b16 v[244:245], v50 offset:0
  s_waitcnt vmcnt(20) lgkmcnt(0)
  s_barrier
  v_xor_b32 v50, 0, v45
  ds_read_b64_tr_b16 v[190:191], v50 offset:16384
  v_xor_b32 v50, 32, v45
  ds_read_b64_tr_b16 v[198:199], v50 offset:16384
  v_xor_b32 v50, 64, v45
  ds_read_b64_tr_b16 v[206:207], v50 offset:16384
  v_xor_b32 v50, 96, v45
  ds_read_b64_tr_b16 v[214:215], v50 offset:16384
  v_xor_b32 v50, 128, v45
  ds_read_b64_tr_b16 v[222:223], v50 offset:16384
  v_xor_b32 v50, 160, v45
  ds_read_b64_tr_b16 v[230:231], v50 offset:16384
  v_xor_b32 v50, 192, v45
  ds_read_b64_tr_b16 v[238:239], v50 offset:16384
  v_xor_b32 v50, 224, v45
  ds_read_b64_tr_b16 v[246:247], v50 offset:16384
  s_waitcnt vmcnt(16) lgkmcnt(0)
  s_barrier
  ds_read_b64_tr_b16 a[16:17], v24 offset:32768
  ds_read_b64_tr_b16 a[18:19], v24 offset:36864
  ds_read_b64_tr_b16 a[20:21], v24 offset:40960
  ds_read_b64_tr_b16 a[22:23], v24 offset:45056
  ds_read_b64_tr_b16 a[24:25], v36 offset:32768
  ds_read_b64_tr_b16 a[26:27], v36 offset:36864
  ds_read_b64_tr_b16 a[28:29], v36 offset:40960
  ds_read_b64_tr_b16 a[30:31], v36 offset:45056
  s_waitcnt vmcnt(12) lgkmcnt(0)
  s_barrier
  ds_read_b64_tr_b16 a[64:65], v24 offset:49152
  ds_read_b64_tr_b16 a[66:67], v24 offset:53248
  ds_read_b64_tr_b16 a[68:69], v24 offset:57344
  ds_read_b64_tr_b16 a[70:71], v24 offset:61440
  ds_read_b64_tr_b16 a[72:73], v36 offset:49152
  ds_read_b64_tr_b16 a[74:75], v36 offset:53248
  ds_read_b64_tr_b16 a[76:77], v36 offset:57344
  ds_read_b64_tr_b16 a[78:79], v36 offset:61440
  s_waitcnt vmcnt(8) lgkmcnt(0)
  s_barrier
  ds_read_b64_tr_b16 a[112:113], v22 offset:0
  ds_read_b64_tr_b16 a[114:115], v22 offset:4096
  ds_read_b64_tr_b16 a[116:117], v22 offset:8192
  ds_read_b64_tr_b16 a[118:119], v22 offset:12288
  ds_read_b64_tr_b16 a[120:121], v23 offset:0
  ds_read_b64_tr_b16 a[122:123], v23 offset:4096
  ds_read_b64_tr_b16 a[124:125], v23 offset:8192
  ds_read_b64_tr_b16 a[126:127], v23 offset:12288
  s_waitcnt vmcnt(4) lgkmcnt(0)
  s_barrier
  ds_read_b64_tr_b16 a[160:161], v22 offset:16384
  ds_read_b64_tr_b16 a[162:163], v22 offset:20480
  ds_read_b64_tr_b16 a[164:165], v22 offset:24576
  ds_read_b64_tr_b16 a[166:167], v22 offset:28672
  ds_read_b64_tr_b16 a[168:169], v23 offset:16384
  ds_read_b64_tr_b16 a[170:171], v23 offset:20480
  ds_read_b64_tr_b16 a[172:173], v23 offset:24576
  ds_read_b64_tr_b16 a[174:175], v23 offset:28672
  s_waitcnt vmcnt(0) lgkmcnt(0)
  s_barrier
  ds_read_b64_tr_b16 a[208:209], v22 offset:32768
  ds_read_b64_tr_b16 a[210:211], v22 offset:36864
  ds_read_b64_tr_b16 a[212:213], v22 offset:40960
  ds_read_b64_tr_b16 a[214:215], v22 offset:45056
  ds_read_b64_tr_b16 a[216:217], v23 offset:32768
  ds_read_b64_tr_b16 a[218:219], v23 offset:36864
  ds_read_b64_tr_b16 a[220:221], v23 offset:40960
  ds_read_b64_tr_b16 a[222:223], v23 offset:45056
  s_waitcnt lgkmcnt(0)
  s_barrier
  s_branch L_cw_done
L_cw1:
  s_mov_b32 s84, s76
  s_mov_b32 s85, s77
  s_add_u32 m0, s88, 0
  s_add_u32 s97, s90, 0
  buffer_load_dwordx4 v20, s[84:87], s97 offen lds
  s_add_u32 m0, s88, 4096
  s_add_u32 s97, s90, 262144
  buffer_load_dwordx4 v20, s[84:87], s97 offen lds
  s_add_u32 m0, s88, 8192
  s_add_u32 s97, s90, 65536
  buffer_load_dwordx4 v20, s[84:87], s97 offen lds
  s_add_u32 m0, s88, 12288
  s_add_u32 s97, s90, 327680
  buffer_load_dwordx4 v20, s[84:87], s97 offen lds
  s_add_u32 m0, s88, 16384
  s_add_u32 s97, s90, 524288
  buffer_load_dwordx4 v20, s[84:87], s97 offen lds
  s_add_u32 m0, s88, 20480
  s_add_u32 s97, s90, 786432
  buffer_load_dwordx4 v20, s[84:87], s97 offen lds
  s_add_u32 m0, s88, 24576
  s_add_u32 s97, s90, 589824
  buffer_load_dwordx4 v20, s[84:87], s97 offen lds
  s_add_u32 m0, s88, 28672
  s_add_u32 s97, s90, 851968
  buffer_load_dwordx4 v20, s[84:87], s97 offen lds
  s_add_u32 m0, s88, 32768
  s_add_u32 s97, s90, 1048576
  buffer_load_dwordx4 v20, s[84:87], s97 offen lds
  s_add_u32 m0, s88, 36864
  s_add_u32 s97, s90, 1310720
  buffer_load_dwordx4 v20, s[84:87], s97 offen lds
  s_add_u32 m0, s88, 40960
  s_add_u32 s97, s90, 1114112
  buffer_load_dwordx4 v20, s[84:87], s97 offen lds
  s_add_u32 m0, s88, 45056
  s_add_u32 s97, s90, 1376256
  buffer_load_dwordx4 v20, s[84:87], s97 offen lds
  s_add_u32 m0, s88, 49152
  s_add_u32 s97, s90, 1572864
  buffer_load_dwordx4 v20, s[84:87], s97 offen lds
  s_add_u32 m0, s88, 53248
  s_add_u32 s97, s90, 1835008
  buffer_load_dwordx4 v20, s[84:87], s97 offen lds
  s_add_u32 m0, s88, 57344
  s_add_u32 s97, s90, 1638400
  buffer_load_dwordx4 v20, s[84:87], s97 offen lds
  s_add_u32 m0, s88, 61440
  s_add_u32 s97, s90, 1900544
  buffer_load_dwordx4 v20, s[84:87], s97 offen lds
  s_add_u32 m0, s88, 65536
  s_add_u32 s97, s90, 2097152
  buffer_load_dwordx4 v20, s[84:87], s97 offen lds
  s_add_u32 m0, s88, 69632
  s_add_u32 s97, s90, 2359296
  buffer_load_dwordx4 v20, s[84:87], s97 offen lds
  s_add_u32 m0, s88, 73728
  s_add_u32 s97, s90, 2162688
  buffer_load_dwordx4 v20, s[84:87], s97 offen lds
  s_add_u32 m0, s88, 77824
  s_add_u32 s97, s90, 2424832
  buffer_load_dwordx4 v20, s[84:87], s97 offen lds
  s_add_u32 m0, s88, 81920
  s_add_u32 s97, s90, 2621440
  buffer_load_dwordx4 v20, s[84:87], s97 offen lds
  s_add_u32 m0, s88, 86016
  s_add_u32 s97, s90, 2883584
  buffer_load_dwordx4 v20, s[84:87], s97 offen lds
  s_add_u32 m0, s88, 90112
  s_add_u32 s97, s90, 2686976
  buffer_load_dwordx4 v20, s[84:87], s97 offen lds
  s_add_u32 m0, s88, 94208
  s_add_u32 s97, s90, 2949120
  buffer_load_dwordx4 v20, s[84:87], s97 offen lds
  s_add_u32 m0, s88, 98304
  s_add_u32 s97, s90, 3145728
  buffer_load_dwordx4 v20, s[84:87], s97 offen lds
  s_add_u32 m0, s88, 102400
  s_add_u32 s97, s90, 3407872
  buffer_load_dwordx4 v20, s[84:87], s97 offen lds
  s_add_u32 m0, s88, 106496
  s_add_u32 s97, s90, 3211264
  buffer_load_dwordx4 v20, s[84:87], s97 offen lds
  s_add_u32 m0, s88, 110592
  s_add_u32 s97, s90, 3473408
  buffer_load_dwordx4 v20, s[84:87], s97 offen lds
  s_waitcnt vmcnt(24) lgkmcnt(0)
  s_barrier
  s_add_u32 m0, s88, 114688
  s_add_u32 s97, s90, 3670016
  buffer_load_dwordx4 v20, s[84:87], s97 offen lds
  s_add_u32 m0, s88, 118784
  s_add_u32 s97, s90, 3932160
  buffer_load_dwordx4 v20, s[84:87], s97 offen lds
  s_add_u32 m0, s88, 122880
  s_add_u32 s97, s90, 3735552
  buffer_load_dwordx4 v20, s[84:87], s97 offen lds
  s_add_u32 m0, s88, 126976
  s_add_u32 s97, s90, 3997696
  buffer_load_dwordx4 v20, s[84:87], s97 offen lds
  ds_read_b64_tr_b16 a[48:49], v22 offset:0
  ds_read_b64_tr_b16 a[50:51], v22 offset:4096
  ds_read_b64_tr_b16 a[52:53], v22 offset:8192
  ds_read_b64_tr_b16 a[54:55], v22 offset:12288
  ds_read_b64_tr_b16 a[56:57], v23 offset:0
  ds_read_b64_tr_b16 a[58:59], v23 offset:4096
  ds_read_b64_tr_b16 a[60:61], v23 offset:8192
  ds_read_b64_tr_b16 a[62:63], v23 offset:12288
  s_waitcnt vmcnt(24) lgkmcnt(0)
  s_barrier
  s_add_u32 m0, s88, 0
  s_add_u32 s97, s91, 4194304
  buffer_load_dwordx4 v21, s[84:87], s97 offen lds
  s_add_u32 m0, s88, 4096
  s_add_u32 s97, s91, 4325376
  buffer_load_dwordx4 v21, s[84:87], s97 offen lds
  s_add_u32 m0, s88, 8192
  s_add_u32 s97, s91, 4259840
  buffer_load_dwordx4 v21, s[84:87], s97 offen lds
  s_add_u32 m0, s88, 12288
  s_add_u32 s97, s91, 4390912
  buffer_load_dwordx4 v21, s[84:87], s97 offen lds
  ds_read_b64_tr_b16 a[0:1], v22 offset:16384
  ds_read_b64_tr_b16 a[2:3], v22 offset:20480
  ds_read_b64_tr_b16 a[4:5], v22 offset:24576
  ds_read_b64_tr_b16 a[6:7], v22 offset:28672
  ds_read_b64_tr_b16 a[8:9], v23 offset:16384
  ds_read_b64_tr_b16 a[10:11], v23 offset:20480
  ds_read_b64_tr_b16 a[12:13], v23 offset:24576
  ds_read_b64_tr_b16 a[14:15], v23 offset:28672
  s_waitcnt vmcnt(24) lgkmcnt(0)
  s_barrier
  s_add_u32 m0, s99, 16384
  s_add_u32 s97, s98, 0
  buffer_load_dwordx4 v40, s[92:95], s97 offen lds
  s_add_u32 m0, s99, 17408
  s_add_u32 s97, s98, 1152
  buffer_load_dwordx4 v41, s[92:95], s97 offen lds
  s_add_u32 m0, s99, 18432
  s_add_u32 s97, s98, 9216
  buffer_load_dwordx4 v42, s[92:95], s97 offen lds
  s_add_u32 m0, s99, 19456
  s_add_u32 s97, s98, 10368
  buffer_load_dwordx4 v43, s[92:95], s97 offen lds
  ds_read_b64_tr_b16 a[144:145], v22 offset:32768
  ds_read_b64_tr_b16 a[146:147], v22 offset:36864
  ds_read_b64_tr_b16 a[148:149], v22 offset:40960
  ds_read_b64_tr_b16 a[150:151], v22 offset:45056
  ds_read_b64_tr_b16 a[152:153], v23 offset:32768
  ds_read_b64_tr_b16 a[154:155], v23 offset:36864
  ds_read_b64_tr_b16 a[156:157], v23 offset:40960
  ds_read_b64_tr_b16 a[158:159], v23 offset:45056
  s_waitcnt vmcnt(24) lgkmcnt(0)
  s_barrier
  s_add_u32 m0, s99, 32768
  s_add_u32 s97, s98, 2304
  buffer_load_dwordx4 v40, s[92:95], s97 offen lds
  s_add_u32 m0, s99, 33792
  s_add_u32 s97, s98, 3456
  buffer_load_dwordx4 v41, s[92:95], s97 offen lds
  s_add_u32 m0, s99, 34816
  s_add_u32 s97, s98, 11520
  buffer_load_dwordx4 v42, s[92:95], s97 offen lds
  s_add_u32 m0, s99, 35840
  s_add_u32 s97, s98, 12672
  buffer_load_dwordx4 v43, s[92:95], s97 offen lds
  ds_read_b64_tr_b16 a[96:97], v22 offset:49152
  ds_read_b64_tr_b16 a[98:99], v22 offset:53248
  ds_read_b64_tr_b16 a[100:101], v22 offset:57344
  ds_read_b64_tr_b16 a[102:103], v22 offset:61440
  ds_read_b64_tr_b16 a[104:105], v23 offset:49152
  ds_read_b64_tr_b16 a[106:107], v23 offset:53248
  ds_read_b64_tr_b16 a[108:109], v23 offset:57344
  ds_read_b64_tr_b16 a[110:111], v23 offset:61440
  s_waitcnt vmcnt(24) lgkmcnt(0)
  s_barrier
  s_mov_b32 s84, s80
  s_mov_b32 s85, s81
  s_add_u32 m0, s88, 49152
  s_add_u32 s97, s90, 0
  buffer_load_dwordx4 v20, s[84:87], s97 offen lds
  s_add_u32 m0, s88, 53248
  s_add_u32 s97, s90, 262144
  buffer_load_dwordx4 v20, s[84:87], s97 offen lds
  s_add_u32 m0, s88, 57344
  s_add_u32 s97, s90, 65536
  buffer_load_dwordx4 v20, s[84:87], s97 offen lds
  s_add_u32 m0, s88, 61440
  s_add_u32 s97, s90, 327680
  buffer_load_dwordx4 v20, s[84:87], s97 offen lds
  ds_read_b64_tr_b16 a[80:81], v24 offset:0
  ds_read_b64_tr_b16 a[82:83], v24 offset:4096
  ds_read_b64_tr_b16 a[84:85], v24 offset:8192
  ds_read_b64_tr_b16 a[86:87], v24 offset:12288
  ds_read_b64_tr_b16 a[88:89], v36 offset:0
  ds_read_b64_tr_b16 a[90:91], v36 offset:4096
  ds_read_b64_tr_b16 a[92:93], v36 offset:8192
  ds_read_b64_tr_b16 a[94:95], v36 offset:12288
  s_waitcnt vmcnt(24) lgkmcnt(0)
  s_barrier
  s_add_u32 m0, s88, 65536
  s_add_u32 s97, s90, 524288
  buffer_load_dwordx4 v20, s[84:87], s97 offen lds
  s_add_u32 m0, s88, 69632
  s_add_u32 s97, s90, 786432
  buffer_load_dwordx4 v20, s[84:87], s97 offen lds
  s_add_u32 m0, s88, 73728
  s_add_u32 s97, s90, 589824
  buffer_load_dwordx4 v20, s[84:87], s97 offen lds
  s_add_u32 m0, s88, 77824
  s_add_u32 s97, s90, 851968
  buffer_load_dwordx4 v20, s[84:87], s97 offen lds
  ds_read_b64_tr_b16 a[32:33], v24 offset:16384
  ds_read_b64_tr_b16 a[34:35], v24 offset:20480
  ds_read_b64_tr_b16 a[36:37], v24 offset:24576
  ds_read_b64_tr_b16 a[38:39], v24 offset:28672
  ds_read_b64_tr_b16 a[40:41], v36 offset:16384
  ds_read_b64_tr_b16 a[42:43], v36 offset:20480
  ds_read_b64_tr_b16 a[44:45], v36 offset:24576
  ds_read_b64_tr_b16 a[46:47], v36 offset:28672
  s_waitcnt vmcnt(24) lgkmcnt(0)
  s_barrier
  s_add_u32 m0, s88, 81920
  s_add_u32 s97, s90, 1048576
  buffer_load_dwordx4 v20, s[84:87], s97 offen lds
  s_add_u32 m0, s88, 86016
  s_add_u32 s97, s90, 1310720
  buffer_load_dwordx4 v20, s[84:87], s97 offen lds
  s_add_u32 m0, s88, 90112
  s_add_u32 s97, s90, 1114112
  buffer_load_dwordx4 v20, s[84:87], s97 offen lds
  s_add_u32 m0, s88, 94208
  s_add_u32 s97, s90, 1376256
  buffer_load_dwordx4 v20, s[84:87], s97 offen lds
  ds_read_b64_tr_b16 a[176:177], v24 offset:32768
  ds_read_b64_tr_b16 a[178:179], v24 offset:36864
  ds_read_b64_tr_b16 a[180:181], v24 offset:40960
  ds_read_b64_tr_b16 a[182:183], v24 offset:45056
  ds_read_b64_tr_b16 a[184:185], v36 offset:32768
  ds_read_b64_tr_b16 a[186:187], v36 offset:36864
  ds_read_b64_tr_b16 a[188:189], v36 offset:40960
  ds_read_b64_tr_b16 a[190:191], v36 offset:45056
  s_waitcnt vmcnt(24) lgkmcnt(0)
  s_barrier
  s_add_u32 m0, s88, 98304
  s_add_u32 s97, s90, 1572864
  buffer_load_dwordx4 v20, s[84:87], s97 offen lds
  s_add_u32 m0, s88, 102400
  s_add_u32 s97, s90, 1835008
  buffer_load_dwordx4 v20, s[84:87], s97 offen lds
  s_add_u32 m0, s88, 106496
  s_add_u32 s97, s90, 1638400
  buffer_load_dwordx4 v20, s[84:87], s97 offen lds
  s_add_u32 m0, s88, 110592
  s_add_u32 s97, s90, 1900544
  buffer_load_dwordx4 v20, s[84:87], s97 offen lds
  ds_read_b64_tr_b16 a[128:129], v24 offset:49152
  ds_read_b64_tr_b16 a[130:131], v24 offset:53248
  ds_read_b64_tr_b16 a[132:133], v24 offset:57344
  ds_read_b64_tr_b16 a[134:135], v24 offset:61440
  ds_read_b64_tr_b16 a[136:137], v36 offset:49152
  ds_read_b64_tr_b16 a[138:139], v36 offset:53248
  ds_read_b64_tr_b16 a[140:141], v36 offset:57344
  ds_read_b64_tr_b16 a[142:143], v36 offset:61440
  s_waitcnt vmcnt(24) lgkmcnt(0)
  s_barrier
  s_add_u32 m0, s88, 114688
  s_add_u32 s97, s90, 2097152
  buffer_load_dwordx4 v20, s[84:87], s97 offen lds
  s_add_u32 m0, s88, 118784
  s_add_u32 s97, s90, 2359296
  buffer_load_dwordx4 v20, s[84:87], s97 offen lds
  s_add_u32 m0, s88, 122880
  s_add_u32 s97, s90, 2162688
  buffer_load_dwordx4 v20, s[84:87], s97 offen lds
  s_add_u32 m0, s88, 126976
  s_add_u32 s97, s90, 2424832
  buffer_load_dwordx4 v20, s[84:87], s97 offen lds
  ds_read_b64_tr_b16 a[192:193], v22 offset:0
  ds_read_b64_tr_b16 a[194:195], v22 offset:4096
  ds_read_b64_tr_b16 a[196:197], v22 offset:8192
  ds_read_b64_tr_b16 a[198:199], v22 offset:12288
  ds_read_b64_tr_b16 a[200:201], v23 offset:0
  ds_read_b64_tr_b16 a[202:203], v23 offset:4096
  ds_read_b64_tr_b16 a[204:205], v23 offset:8192
  ds_read_b64_tr_b16 a[206:207], v23 offset:12288
  s_waitcnt vmcnt(24) lgkmcnt(0)
  s_barrier
  s_add_u32 m0, s88, 0
  s_add_u32 s97, s90, 2621440
  buffer_load_dwordx4 v20, s[84:87], s97 offen lds
  s_add_u32 m0, s88, 4096
  s_add_u32 s97, s90, 2883584
  buffer_load_dwordx4 v20, s[84:87], s97 offen lds
  s_add_u32 m0, s88, 8192
  s_add_u32 s97, s90, 2686976
  buffer_load_dwordx4 v20, s[84:87], s97 offen lds
  s_add_u32 m0, s88, 12288
  s_add_u32 s97, s90, 2949120
  buffer_load_dwordx4 v20, s[84:87], s97 offen lds
  v_xor_b32 v50, 0, v44
  ds_read_b64_tr_b16 v[184:185], v50 offset:16384
  v_xor_b32 v50, 32, v44
  ds_read_b64_tr_b16 v[192:193], v50 offset:16384
  v_xor_b32 v50, 64, v44
  ds_read_b64_tr_b16 v[200:201], v50 offset:16384
  v_xor_b32 v50, 96, v44
  ds_read_b64_tr_b16 v[208:209], v50 offset:16384
  v_xor_b32 v50, 128, v44
  ds_read_b64_tr_b16 v[216:217], v50 offset:16384
  v_xor_b32 v50, 160, v44
  ds_read_b64_tr_b16 v[224:225], v50 offset:16384
  v_xor_b32 v50, 192, v44
  ds_read_b64_tr_b16 v[232:233], v50 offset:16384
  v_xor_b32 v50, 224, v44
  ds_read_b64_tr_b16 v[240:241], v50 offset:16384
  s_waitcnt vmcnt(24) lgkmcnt(0)
  s_barrier
  s_add_u32 m0, s88, 16384
  s_add_u32 s97, s90, 3145728
  buffer_load_dwordx4 v20, s[84:87], s97 offen lds
  s_add_u32 m0, s88, 20480
  s_add_u32 s97, s90, 3407872
  buffer_load_dwordx4 v20, s[84:87], s97 offen lds
  s_add_u32 m0, s88, 24576
  s_add_u32 s97, s90, 3211264
  buffer_load_dwordx4 v20, s[84:87], s97 offen lds
  s_add_u32 m0, s88, 28672
  s_add_u32 s97, s90, 3473408
  buffer_load_dwordx4 v20, s[84:87], s97 offen lds
  v_xor_b32 v50, 0, v44
  ds_read_b64_tr_b16 v[186:187], v50 offset:32768
  v_xor_b32 v50, 32, v44
  ds_read_b64_tr_b16 v[194:195], v50 offset:32768
  v_xor_b32 v50, 64, v44
  ds_read_b64_tr_b16 v[202:203], v50 offset:32768
  v_xor_b32 v50, 96, v44
  ds_read_b64_tr_b16 v[210:211], v50 offset:32768
  v_xor_b32 v50, 128, v44
  ds_read_b64_tr_b16 v[218:219], v50 offset:32768
  v_xor_b32 v50, 160, v44
  ds_read_b64_tr_b16 v[226:227], v50 offset:32768
  v_xor_b32 v50, 192, v44
  ds_read_b64_tr_b16 v[234:235], v50 offset:32768
  v_xor_b32 v50, 224, v44
  ds_read_b64_tr_b16 v[242:243], v50 offset:32768
  s_waitcnt vmcnt(24) lgkmcnt(0)
  s_barrier
  s_add_u32 m0, s88, 32768
  s_add_u32 s97, s90, 3670016
  buffer_load_dwordx4 v20, s[84:87], s97 offen lds
  s_add_u32 m0, s88, 36864
  s_add_u32 s97, s90, 3932160
  buffer_load_dwordx4 v20, s[84:87], s97 offen lds
  s_add_u32 m0, s88, 40960
  s_add_u32 s97, s90, 3735552
  buffer_load_dwordx4 v20, s[84:87], s97 offen lds
  s_add_u32 m0, s88, 45056
  s_add_u32 s97, s90, 3997696
  buffer_load_dwordx4 v20, s[84:87], s97 offen lds
  ds_read_b64_tr_b16 a[224:225], v22 offset:49152
  ds_read_b64_tr_b16 a[226:227], v22 offset:53248
  ds_read_b64_tr_b16 a[228:229], v22 offset:57344
  ds_read_b64_tr_b16 a[230:231], v22 offset:61440
  ds_read_b64_tr_b16 a[232:233], v23 offset:49152
  ds_read_b64_tr_b16 a[234:235], v23 offset:53248
  ds_read_b64_tr_b16 a[236:237], v23 offset:57344
  ds_read_b64_tr_b16 a[238:239], v23 offset:61440
  s_waitcnt vmcnt(24) lgkmcnt(0)
  s_barrier
  s_add_u32 m0, s88, 49152
  s_add_u32 s97, s91, 4194304
  buffer_load_dwordx4 v21, s[84:87], s97 offen lds
  s_add_u32 m0, s88, 53248
  s_add_u32 s97, s91, 4325376
  buffer_load_dwordx4 v21, s[84:87], s97 offen lds
  s_add_u32 m0, s88, 57344
  s_add_u32 s97, s91, 4259840
  buffer_load_dwordx4 v21, s[84:87], s97 offen lds
  s_add_u32 m0, s88, 61440
  s_add_u32 s97, s91, 4390912
  buffer_load_dwordx4 v21, s[84:87], s97 offen lds
  ds_read_b64_tr_b16 a[240:241], v24 offset:0
  ds_read_b64_tr_b16 a[242:243], v24 offset:4096
  ds_read_b64_tr_b16 a[244:245], v24 offset:8192
  ds_read_b64_tr_b16 a[246:247], v24 offset:12288
  ds_read_b64_tr_b16 a[248:249], v36 offset:0
  ds_read_b64_tr_b16 a[250:251], v36 offset:4096
  ds_read_b64_tr_b16 a[252:253], v36 offset:8192
  ds_read_b64_tr_b16 a[254:255], v36 offset:12288
  s_waitcnt vmcnt(24) lgkmcnt(0)
  s_barrier
  s_add_u32 m0, s99, 65536
  s_add_u32 s97, s98, 36864
  buffer_load_dwordx4 v40, s[92:95], s97 offen lds
  s_add_u32 m0, s99, 66560
  s_add_u32 s97, s98, 38016
  buffer_load_dwordx4 v41, s[92:95], s97 offen lds
  s_add_u32 m0, s99, 67584
  s_add_u32 s97, s98, 46080
  buffer_load_dwordx4 v42, s[92:95], s97 offen lds
  s_add_u32 m0, s99, 68608
  s_add_u32 s97, s98, 47232
  buffer_load_dwordx4 v43, s[92:95], s97 offen lds
  ds_read_b64_tr_b16 v[72:73], v24 offset:16384
  ds_read_b64_tr_b16 v[74:75], v24 offset:20480
  ds_read_b64_tr_b16 v[76:77], v24 offset:24576
  ds_read_b64_tr_b16 v[78:79], v24 offset:28672
  ds_read_b64_tr_b16 v[80:81], v36 offset:16384
  ds_read_b64_tr_b16 v[82:83], v36 offset:20480
  ds_read_b64_tr_b16 v[84:85], v36 offset:24576
  ds_read_b64_tr_b16 v[86:87], v36 offset:28672
  s_waitcnt vmcnt(24) lgkmcnt(0)
  s_barrier
  s_add_u32 m0, s99, 81920
  s_add_u32 s97, s98, 39168
  buffer_load_dwordx4 v40, s[92:95], s97 offen lds
  s_add_u32 m0, s99, 82944
  s_add_u32 s97, s98, 40320
  buffer_load_dwordx4 v41, s[92:95], s97 offen lds
  s_add_u32 m0, s99, 83968
  s_add_u32 s97, s98, 48384
  buffer_load_dwordx4 v42, s[92:95], s97 offen lds
  s_add_u32 m0, s99, 84992
  s_add_u32 s97, s98, 49536
  buffer_load_dwordx4 v43, s[92:95], s97 offen lds
  ds_read_b64_tr_b16 v[88:89], v24 offset:32768
  ds_read_b64_tr_b16 v[90:91], v24 offset:36864
  ds_read_b64_tr_b16 v[92:93], v24 offset:40960
  ds_read_b64_tr_b16 v[94:95], v24 offset:45056
  ds_read_b64_tr_b16 v[96:97], v36 offset:32768
  ds_read_b64_tr_b16 v[98:99], v36 offset:36864
  ds_read_b64_tr_b16 v[100:101], v36 offset:40960
  ds_read_b64_tr_b16 v[102:103], v36 offset:45056
  s_waitcnt vmcnt(24) lgkmcnt(0)
  s_barrier
  s_mov_b32 s84, s78
  s_mov_b32 s85, s79
  s_add_u32 m0, s88, 98304
  s_add_u32 s97, s90, 0
  buffer_load_dwordx4 v20, s[84:87], s97 offen lds
  s_add_u32 m0, s88, 102400
  s_add_u32 s97, s90, 262144
  buffer_load_dwordx4 v20, s[84:87], s97 offen lds
  s_add_u32 m0, s88, 106496
  s_add_u32 s97, s90, 65536
  buffer_load_dwordx4 v20, s[84:87], s97 offen lds
  s_add_u32 m0, s88, 110592
  s_add_u32 s97, s90, 327680
  buffer_load_dwordx4 v20, s[84:87], s97 offen lds
  ds_read_b64_tr_b16 v[104:105], v24 offset:49152
  ds_read_b64_tr_b16 v[106:107], v24 offset:53248
  ds_read_b64_tr_b16 v[108:109], v24 offset:57344
  ds_read_b64_tr_b16 v[110:111], v24 offset:61440
  ds_read_b64_tr_b16 v[112:113], v36 offset:49152
  ds_read_b64_tr_b16 v[114:115], v36 offset:53248
  ds_read_b64_tr_b16 v[116:117], v36 offset:57344
  ds_read_b64_tr_b16 v[118:119], v36 offset:61440
  s_waitcnt vmcnt(24) lgkmcnt(0)
  s_barrier
  s_add_u32 m0, s88, 114688
  s_add_u32 s97, s90, 524288
  buffer_load_dwordx4 v20, s[84:87], s97 offen lds
  s_add_u32 m0, s88, 118784
  s_add_u32 s97, s90, 786432
  buffer_load_dwordx4 v20, s[84:87], s97 offen lds
  s_add_u32 m0, s88, 122880
  s_add_u32 s97, s90, 589824
  buffer_load_dwordx4 v20, s[84:87], s97 offen lds
  s_add_u32 m0, s88, 126976
  s_add_u32 s97, s90, 851968
  buffer_load_dwordx4 v20, s[84:87], s97 offen lds
  ds_read_b64_tr_b16 v[120:121], v22 offset:0
  ds_read_b64_tr_b16 v[122:123], v22 offset:4096
  ds_read_b64_tr_b16 v[124:125], v22 offset:8192
  ds_read_b64_tr_b16 v[126:127], v22 offset:12288
  ds_read_b64_tr_b16 v[128:129], v23 offset:0
  ds_read_b64_tr_b16 v[130:131], v23 offset:4096
  ds_read_b64_tr_b16 v[132:133], v23 offset:8192
  ds_read_b64_tr_b16 v[134:135], v23 offset:12288
  s_waitcnt vmcnt(24) lgkmcnt(0)
  s_barrier
  s_add_u32 m0, s88, 0
  s_add_u32 s97, s90, 1048576
  buffer_load_dwordx4 v20, s[84:87], s97 offen lds
  s_add_u32 m0, s88, 4096
  s_add_u32 s97, s90, 1310720
  buffer_load_dwordx4 v20, s[84:87], s97 offen lds
  s_add_u32 m0, s88, 8192
  s_add_u32 s97, s90, 1114112
  buffer_load_dwordx4 v20, s[84:87], s97 offen lds
  s_add_u32 m0, s88, 12288
  s_add_u32 s97, s90, 1376256
  buffer_load_dwordx4 v20, s[84:87], s97 offen lds
  ds_read_b64_tr_b16 v[136:137], v22 offset:16384
  ds_read_b64_tr_b16 v[138:139], v22 offset:20480
  ds_read_b64_tr_b16 v[140:141], v22 offset:24576
  ds_read_b64_tr_b16 v[142:143], v22 offset:28672
  ds_read_b64_tr_b16 v[144:145], v23 offset:16384
  ds_read_b64_tr_b16 v[146:147], v23 offset:20480
  ds_read_b64_tr_b16 v[148:149], v23 offset:24576
  ds_read_b64_tr_b16 v[150:151], v23 offset:28672
  s_waitcnt vmcnt(24) lgkmcnt(0)
  s_barrier
  s_add_u32 m0, s88, 16384
  s_add_u32 s97, s90, 1572864
  buffer_load_dwordx4 v20, s[84:87], s97 offen lds
  s_add_u32 m0, s88, 20480
  s_add_u32 s97, s90, 1835008
  buffer_load_dwordx4 v20, s[84:87], s97 offen lds
  s_add_u32 m0, s88, 24576
  s_add_u32 s97, s90, 1638400
  buffer_load_dwordx4 v20, s[84:87], s97 offen lds
  s_add_u32 m0, s88, 28672
  s_add_u32 s97, s90, 1900544
  buffer_load_dwordx4 v20, s[84:87], s97 offen lds
  ds_read_b64_tr_b16 v[152:153], v22 offset:32768
  ds_read_b64_tr_b16 v[154:155], v22 offset:36864
  ds_read_b64_tr_b16 v[156:157], v22 offset:40960
  ds_read_b64_tr_b16 v[158:159], v22 offset:45056
  ds_read_b64_tr_b16 v[160:161], v23 offset:32768
  ds_read_b64_tr_b16 v[162:163], v23 offset:36864
  ds_read_b64_tr_b16 v[164:165], v23 offset:40960
  ds_read_b64_tr_b16 v[166:167], v23 offset:45056
  s_waitcnt vmcnt(24) lgkmcnt(0)
  s_barrier
  s_add_u32 m0, s88, 32768
  s_add_u32 s97, s91, 4194304
  buffer_load_dwordx4 v21, s[84:87], s97 offen lds
  s_add_u32 m0, s88, 36864
  s_add_u32 s97, s91, 4325376
  buffer_load_dwordx4 v21, s[84:87], s97 offen lds
  s_add_u32 m0, s88, 40960
  s_add_u32 s97, s91, 4259840
  buffer_load_dwordx4 v21, s[84:87], s97 offen lds
  s_add_u32 m0, s88, 45056
  s_add_u32 s97, s91, 4390912
  buffer_load_dwordx4 v21, s[84:87], s97 offen lds
  ds_read_b64_tr_b16 v[168:169], v22 offset:49152
  ds_read_b64_tr_b16 v[170:171], v22 offset:53248
  ds_read_b64_tr_b16 v[172:173], v22 offset:57344
  ds_read_b64_tr_b16 v[174:175], v22 offset:61440
  ds_read_b64_tr_b16 v[176:177], v23 offset:49152
  ds_read_b64_tr_b16 v[178:179], v23 offset:53248
  ds_read_b64_tr_b16 v[180:181], v23 offset:57344
  ds_read_b64_tr_b16 v[182:183], v23 offset:61440
  s_waitcnt vmcnt(24) lgkmcnt(0)
  s_barrier
  v_xor_b32 v50, 0, v45
  ds_read_b64_tr_b16 v[188:189], v50 offset:0
  v_xor_b32 v50, 32, v45
  ds_read_b64_tr_b16 v[196:197], v50 offset:0
  v_xor_b32 v50, 64, v45
  ds_read_b64_tr_b16 v[204:205], v50 offset:0
  v_xor_b32 v50, 96, v45
  ds_read_b64_tr_b16 v[212:213], v50 offset:0
  v_xor_b32 v50, 128, v45
  ds_read_b64_tr_b16 v[220:221], v50 offset:0
  v_xor_b32 v50, 160, v45
  ds_read_b64_tr_b16 v[228:229], v50 offset:0
  v_xor_b32 v50, 192, v45
  ds_read_b64_tr_b16 v[236:237], v50 offset:0
  v_xor_b32 v50, 224, v45
  ds_read_b64_tr_b16 v[244:245], v50 offset:0
  s_waitcnt vmcnt(20) lgkmcnt(0)
  s_barrier
  v_xor_b32 v50, 0, v45
  ds_read_b64_tr_b16 v[190:191], v50 offset:16384
  v_xor_b32 v50, 32, v45
  ds_read_b64_tr_b16 v[198:199], v50 offset:16384
  v_xor_b32 v50, 64, v45
  ds_read_b64_tr_b16 v[206:207], v50 offset:16384
  v_xor_b32 v50, 96, v45
  ds_read_b64_tr_b16 v[214:215], v50 offset:16384
  v_xor_b32 v50, 128, v45
  ds_read_b64_tr_b16 v[222:223], v50 offset:16384
  v_xor_b32 v50, 160, v45
  ds_read_b64_tr_b16 v[230:231], v50 offset:16384
  v_xor_b32 v50, 192, v45
  ds_read_b64_tr_b16 v[238:239], v50 offset:16384
  v_xor_b32 v50, 224, v45
  ds_read_b64_tr_b16 v[246:247], v50 offset:16384
  s_waitcnt vmcnt(16) lgkmcnt(0)
  s_barrier
  ds_read_b64_tr_b16 a[64:65], v24 offset:32768
  ds_read_b64_tr_b16 a[66:67], v24 offset:36864
  ds_read_b64_tr_b16 a[68:69], v24 offset:40960
  ds_read_b64_tr_b16 a[70:71], v24 offset:45056
  ds_read_b64_tr_b16 a[72:73], v36 offset:32768
  ds_read_b64_tr_b16 a[74:75], v36 offset:36864
  ds_read_b64_tr_b16 a[76:77], v36 offset:40960
  ds_read_b64_tr_b16 a[78:79], v36 offset:45056
  s_waitcnt vmcnt(12) lgkmcnt(0)
  s_barrier
  ds_read_b64_tr_b16 a[16:17], v24 offset:49152
  ds_read_b64_tr_b16 a[18:19], v24 offset:53248
  ds_read_b64_tr_b16 a[20:21], v24 offset:57344
  ds_read_b64_tr_b16 a[22:23], v24 offset:61440
  ds_read_b64_tr_b16 a[24:25], v36 offset:49152
  ds_read_b64_tr_b16 a[26:27], v36 offset:53248
  ds_read_b64_tr_b16 a[28:29], v36 offset:57344
  ds_read_b64_tr_b16 a[30:31], v36 offset:61440
  s_waitcnt vmcnt(8) lgkmcnt(0)
  s_barrier
  ds_read_b64_tr_b16 a[160:161], v22 offset:0
  ds_read_b64_tr_b16 a[162:163], v22 offset:4096
  ds_read_b64_tr_b16 a[164:165], v22 offset:8192
  ds_read_b64_tr_b16 a[166:167], v22 offset:12288
  ds_read_b64_tr_b16 a[168:169], v23 offset:0
  ds_read_b64_tr_b16 a[170:171], v23 offset:4096
  ds_read_b64_tr_b16 a[172:173], v23 offset:8192
  ds_read_b64_tr_b16 a[174:175], v23 offset:12288
  s_waitcnt vmcnt(4) lgkmcnt(0)
  s_barrier
  ds_read_b64_tr_b16 a[112:113], v22 offset:16384
  ds_read_b64_tr_b16 a[114:115], v22 offset:20480
  ds_read_b64_tr_b16 a[116:117], v22 offset:24576
  ds_read_b64_tr_b16 a[118:119], v22 offset:28672
  ds_read_b64_tr_b16 a[120:121], v23 offset:16384
  ds_read_b64_tr_b16 a[122:123], v23 offset:20480
  ds_read_b64_tr_b16 a[124:125], v23 offset:24576
  ds_read_b64_tr_b16 a[126:127], v23 offset:28672
  s_waitcnt vmcnt(0) lgkmcnt(0)
  s_barrier
  ds_read_b64_tr_b16 a[208:209], v22 offset:32768
  ds_read_b64_tr_b16 a[210:211], v22 offset:36864
  ds_read_b64_tr_b16 a[212:213], v22 offset:40960
  ds_read_b64_tr_b16 a[214:215], v22 offset:45056
  ds_read_b64_tr_b16 a[216:217], v23 offset:32768
  ds_read_b64_tr_b16 a[218:219], v23 offset:36864
  ds_read_b64_tr_b16 a[220:221], v23 offset:40960
  ds_read_b64_tr_b16 a[222:223], v23 offset:45056
  s_waitcnt lgkmcnt(0)
  s_barrier
  s_branch L_cw_done
L_cw2:
  s_mov_b32 s84, s76
  s_mov_b32 s85, s77
  s_add_u32 m0, s88, 0
  s_add_u32 s97, s90, 0
  buffer_load_dwordx4 v20, s[84:87], s97 offen lds
  s_add_u32 m0, s88, 4096
  s_add_u32 s97, s90, 262144
  buffer_load_dwordx4 v20, s[84:87], s97 offen lds
  s_add_u32 m0, s88, 8192
  s_add_u32 s97, s90, 65536
  buffer_load_dwordx4 v20, s[84:87], s97 offen lds
  s_add_u32 m0, s88, 12288
  s_add_u32 s97, s90, 327680
  buffer_load_dwordx4 v20, s[84:87], s97 offen lds
  s_add_u32 m0, s88, 16384
  s_add_u32 s97, s90, 524288
  buffer_load_dwordx4 v20, s[84:87], s97 offen lds
  s_add_u32 m0, s88, 20480
  s_add_u32 s97, s90, 786432
  buffer_load_dwordx4 v20, s[84:87], s97 offen lds
  s_add_u32 m0, s88, 24576
  s_add_u32 s97, s90, 589824
  buffer_load_dwordx4 v20, s[84:87], s97 offen lds
  s_add_u32 m0, s88, 28672
  s_add_u32 s97, s90, 851968
  buffer_load_dwordx4 v20, s[84:87], s97 offen lds
  s_add_u32 m0, s88, 32768
  s_add_u32 s97, s90, 1048576
  buffer_load_dwordx4 v20, s[84:87], s97 offen lds
  s_add_u32 m0, s88, 36864
  s_add_u32 s97, s90, 1310720
  buffer_load_dwordx4 v20, s[84:87], s97 offen lds
  s_add_u32 m0, s88, 40960
  s_add_u32 s97, s90, 1114112
  buffer_load_dwordx4 v20, s[84:87], s97 offen lds
  s_add_u32 m0, s88, 45056
  s_add_u32 s97, s90, 1376256
  buffer_load_dwordx4 v20, s[84:87], s97 offen lds
  s_add_u32 m0, s88, 49152
  s_add_u32 s97, s90, 1572864
  buffer_load_dwordx4 v20, s[84:87], s97 offen lds
  s_add_u32 m0, s88, 53248
  s_add_u32 s97, s90, 1835008
  buffer_load_dwordx4 v20, s[84:87], s97 offen lds
  s_add_u32 m0, s88, 57344
  s_add_u32 s97, s90, 1638400
  buffer_load_dwordx4 v20, s[84:87], s97 offen lds
  s_add_u32 m0, s88, 61440
  s_add_u32 s97, s90, 1900544
  buffer_load_dwordx4 v20, s[84:87], s97 offen lds
  s_add_u32 m0, s88, 65536
  s_add_u32 s97, s90, 2097152
  buffer_load_dwordx4 v20, s[84:87], s97 offen lds
  s_add_u32 m0, s88, 69632
  s_add_u32 s97, s90, 2359296
  buffer_load_dwordx4 v20, s[84:87], s97 offen lds
  s_add_u32 m0, s88, 73728
  s_add_u32 s97, s90, 2162688
  buffer_load_dwordx4 v20, s[84:87], s97 offen lds
  s_add_u32 m0, s88, 77824
  s_add_u32 s97, s90, 2424832
  buffer_load_dwordx4 v20, s[84:87], s97 offen lds
  s_add_u32 m0, s88, 81920
  s_add_u32 s97, s90, 2621440
  buffer_load_dwordx4 v20, s[84:87], s97 offen lds
  s_add_u32 m0, s88, 86016
  s_add_u32 s97, s90, 2883584
  buffer_load_dwordx4 v20, s[84:87], s97 offen lds
  s_add_u32 m0, s88, 90112
  s_add_u32 s97, s90, 2686976
  buffer_load_dwordx4 v20, s[84:87], s97 offen lds
  s_add_u32 m0, s88, 94208
  s_add_u32 s97, s90, 2949120
  buffer_load_dwordx4 v20, s[84:87], s97 offen lds
  s_add_u32 m0, s88, 98304
  s_add_u32 s97, s90, 3145728
  buffer_load_dwordx4 v20, s[84:87], s97 offen lds
  s_add_u32 m0, s88, 102400
  s_add_u32 s97, s90, 3407872
  buffer_load_dwordx4 v20, s[84:87], s97 offen lds
  s_add_u32 m0, s88, 106496
  s_add_u32 s97, s90, 3211264
  buffer_load_dwordx4 v20, s[84:87], s97 offen lds
  s_add_u32 m0, s88, 110592
  s_add_u32 s97, s90, 3473408
  buffer_load_dwordx4 v20, s[84:87], s97 offen lds
  s_waitcnt vmcnt(24) lgkmcnt(0)
  s_barrier
  s_add_u32 m0, s88, 114688
  s_add_u32 s97, s90, 3670016
  buffer_load_dwordx4 v20, s[84:87], s97 offen lds
  s_add_u32 m0, s88, 118784
  s_add_u32 s97, s90, 3932160
  buffer_load_dwordx4 v20, s[84:87], s97 offen lds
  s_add_u32 m0, s88, 122880
  s_add_u32 s97, s90, 3735552
  buffer_load_dwordx4 v20, s[84:87], s97 offen lds
  s_add_u32 m0, s88, 126976
  s_add_u32 s97, s90, 3997696
  buffer_load_dwordx4 v20, s[84:87], s97 offen lds
  ds_read_b64_tr_b16 a[96:97], v22 offset:0
  ds_read_b64_tr_b16 a[98:99], v22 offset:4096
  ds_read_b64_tr_b16 a[100:101], v22 offset:8192
  ds_read_b64_tr_b16 a[102:103], v22 offset:12288
  ds_read_b64_tr_b16 a[104:105], v23 offset:0
  ds_read_b64_tr_b16 a[106:107], v23 offset:4096
  ds_read_b64_tr_b16 a[108:109], v23 offset:8192
  ds_read_b64_tr_b16 a[110:111], v23 offset:12288
  s_waitcnt vmcnt(24) lgkmcnt(0)
  s_barrier
  s_add_u32 m0, s88, 0
  s_add_u32 s97, s91, 4194304
  buffer_load_dwordx4 v21, s[84:87], s97 offen lds
  s_add_u32 m0, s88, 4096
  s_add_u32 s97, s91, 4325376
  buffer_load_dwordx4 v21, s[84:87], s97 offen lds
  s_add_u32 m0, s88, 8192
  s_add_u32 s97, s91, 4259840
  buffer_load_dwordx4 v21, s[84:87], s97 offen lds
  s_add_u32 m0, s88, 12288
  s_add_u32 s97, s91, 4390912
  buffer_load_dwordx4 v21, s[84:87], s97 offen lds
  ds_read_b64_tr_b16 a[144:145], v22 offset:16384
  ds_read_b64_tr_b16 a[146:147], v22 offset:20480
  ds_read_b64_tr_b16 a[148:149], v22 offset:24576
  ds_read_b64_tr_b16 a[150:151], v22 offset:28672
  ds_read_b64_tr_b16 a[152:153], v23 offset:16384
  ds_read_b64_tr_b16 a[154:155], v23 offset:20480
  ds_read_b64_tr_b16 a[156:157], v23 offset:24576
  ds_read_b64_tr_b16 a[158:159], v23 offset:28672
  s_waitcnt vmcnt(24) lgkmcnt(0)
  s_barrier
  s_add_u32 m0, s99, 16384
  s_add_u32 s97, s98, 0
  buffer_load_dwordx4 v40, s[92:95], s97 offen lds
  s_add_u32 m0, s99, 17408
  s_add_u32 s97, s98, 1152
  buffer_load_dwordx4 v41, s[92:95], s97 offen lds
  s_add_u32 m0, s99, 18432
  s_add_u32 s97, s98, 9216
  buffer_load_dwordx4 v42, s[92:95], s97 offen lds
  s_add_u32 m0, s99, 19456
  s_add_u32 s97, s98, 10368
  buffer_load_dwordx4 v43, s[92:95], s97 offen lds
  ds_read_b64_tr_b16 a[0:1], v22 offset:32768
  ds_read_b64_tr_b16 a[2:3], v22 offset:36864
  ds_read_b64_tr_b16 a[4:5], v22 offset:40960
  ds_read_b64_tr_b16 a[6:7], v22 offset:45056
  ds_read_b64_tr_b16 a[8:9], v23 offset:32768
  ds_read_b64_tr_b16 a[10:11], v23 offset:36864
  ds_read_b64_tr_b16 a[12:13], v23 offset:40960
  ds_read_b64_tr_b16 a[14:15], v23 offset:45056
  s_waitcnt vmcnt(24) lgkmcnt(0)
  s_barrier
  s_add_u32 m0, s99, 32768
  s_add_u32 s97, s98, 2304
  buffer_load_dwordx4 v40, s[92:95], s97 offen lds
  s_add_u32 m0, s99, 33792
  s_add_u32 s97, s98, 3456
  buffer_load_dwordx4 v41, s[92:95], s97 offen lds
  s_add_u32 m0, s99, 34816
  s_add_u32 s97, s98, 11520
  buffer_load_dwordx4 v42, s[92:95], s97 offen lds
  s_add_u32 m0, s99, 35840
  s_add_u32 s97, s98, 12672
  buffer_load_dwordx4 v43, s[92:95], s97 offen lds
  ds_read_b64_tr_b16 a[48:49], v22 offset:49152
  ds_read_b64_tr_b16 a[50:51], v22 offset:53248
  ds_read_b64_tr_b16 a[52:53], v22 offset:57344
  ds_read_b64_tr_b16 a[54:55], v22 offset:61440
  ds_read_b64_tr_b16 a[56:57], v23 offset:49152
  ds_read_b64_tr_b16 a[58:59], v23 offset:53248
  ds_read_b64_tr_b16 a[60:61], v23 offset:57344
  ds_read_b64_tr_b16 a[62:63], v23 offset:61440
  s_waitcnt vmcnt(24) lgkmcnt(0)
  s_barrier
  s_mov_b32 s84, s80
  s_mov_b32 s85, s81
  s_add_u32 m0, s88, 49152
  s_add_u32 s97, s90, 0
  buffer_load_dwordx4 v20, s[84:87], s97 offen lds
  s_add_u32 m0, s88, 53248
  s_add_u32 s97, s90, 262144
  buffer_load_dwordx4 v20, s[84:87], s97 offen lds
  s_add_u32 m0, s88, 57344
  s_add_u32 s97, s90, 65536
  buffer_load_dwordx4 v20, s[84:87], s97 offen lds
  s_add_u32 m0, s88, 61440
  s_add_u32 s97, s90, 327680
  buffer_load_dwordx4 v20, s[84:87], s97 offen lds
  ds_read_b64_tr_b16 a[128:129], v24 offset:0
  ds_read_b64_tr_b16 a[130:131], v24 offset:4096
  ds_read_b64_tr_b16 a[132:133], v24 offset:8192
  ds_read_b64_tr_b16 a[134:135], v24 offset:12288
  ds_read_b64_tr_b16 a[136:137], v36 offset:0
  ds_read_b64_tr_b16 a[138:139], v36 offset:4096
  ds_read_b64_tr_b16 a[140:141], v36 offset:8192
  ds_read_b64_tr_b16 a[142:143], v36 offset:12288
  s_waitcnt vmcnt(24) lgkmcnt(0)
  s_barrier
  s_add_u32 m0, s88, 65536
  s_add_u32 s97, s90, 524288
  buffer_load_dwordx4 v20, s[84:87], s97 offen lds
  s_add_u32 m0, s88, 69632
  s_add_u32 s97, s90, 786432
  buffer_load_dwordx4 v20, s[84:87], s97 offen lds
  s_add_u32 m0, s88, 73728
  s_add_u32 s97, s90, 589824
  buffer_load_dwordx4 v20, s[84:87], s97 offen lds
  s_add_u32 m0, s88, 77824
  s_add_u32 s97, s90, 851968
  buffer_load_dwordx4 v20, s[84:87], s97 offen lds
  ds_read_b64_tr_b16 a[176:177], v24 offset:16384
  ds_read_b64_tr_b16 a[178:179], v24 offset:20480
  ds_read_b64_tr_b16 a[180:181], v24 offset:24576
  ds_read_b64_tr_b16 a[182:183], v24 offset:28672
  ds_read_b64_tr_b16 a[184:185], v36 offset:16384
  ds_read_b64_tr_b16 a[186:187], v36 offset:20480
  ds_read_b64_tr_b16 a[188:189], v36 offset:24576
  ds_read_b64_tr_b16 a[190:191], v36 offset:28672
  s_waitcnt vmcnt(24) lgkmcnt(0)
  s_barrier
  s_add_u32 m0, s88, 81920
  s_add_u32 s97, s90, 1048576
  buffer_load_dwordx4 v20, s[84:87], s97 offen lds
  s_add_u32 m0, s88, 86016
  s_add_u32 s97, s90, 1310720
  buffer_load_dwordx4 v20, s[84:87], s97 offen lds
  s_add_u32 m0, s88, 90112
  s_add_u32 s97, s90, 1114112
  buffer_load_dwordx4 v20, s[84:87], s97 offen lds
  s_add_u32 m0, s88, 94208
  s_add_u32 s97, s90, 1376256
  buffer_load_dwordx4 v20, s[84:87], s97 offen lds
  ds_read_b64_tr_b16 a[32:33], v24 offset:32768
  ds_read_b64_tr_b16 a[34:35], v24 offset:36864
  ds_read_b64_tr_b16 a[36:37], v24 offset:40960
  ds_read_b64_tr_b16 a[38:39], v24 offset:45056
  ds_read_b64_tr_b16 a[40:41], v36 offset:32768
  ds_read_b64_tr_b16 a[42:43], v36 offset:36864
  ds_read_b64_tr_b16 a[44:45], v36 offset:40960
  ds_read_b64_tr_b16 a[46:47], v36 offset:45056
  s_waitcnt vmcnt(24) lgkmcnt(0)
  s_barrier
  s_add_u32 m0, s88, 98304
  s_add_u32 s97, s90, 1572864
  buffer_load_dwordx4 v20, s[84:87], s97 offen lds
  s_add_u32 m0, s88, 102400
  s_add_u32 s97, s90, 1835008
  buffer_load_dwordx4 v20, s[84:87], s97 offen lds
  s_add_u32 m0, s88, 106496
  s_add_u32 s97, s90, 1638400
  buffer_load_dwordx4 v20, s[84:87], s97 offen lds
  s_add_u32 m0, s88, 110592
  s_add_u32 s97, s90, 1900544
  buffer_load_dwordx4 v20, s[84:87], s97 offen lds
  ds_read_b64_tr_b16 a[80:81], v24 offset:49152
  ds_read_b64_tr_b16 a[82:83], v24 offset:53248
  ds_read_b64_tr_b16 a[84:85], v24 offset:57344
  ds_read_b64_tr_b16 a[86:87], v24 offset:61440
  ds_read_b64_tr_b16 a[88:89], v36 offset:49152
  ds_read_b64_tr_b16 a[90:91], v36 offset:53248
  ds_read_b64_tr_b16 a[92:93], v36 offset:57344
  ds_read_b64_tr_b16 a[94:95], v36 offset:61440
  s_waitcnt vmcnt(24) lgkmcnt(0)
  s_barrier
  s_add_u32 m0, s88, 114688
  s_add_u32 s97, s90, 2097152
  buffer_load_dwordx4 v20, s[84:87], s97 offen lds
  s_add_u32 m0, s88, 118784
  s_add_u32 s97, s90, 2359296
  buffer_load_dwordx4 v20, s[84:87], s97 offen lds
  s_add_u32 m0, s88, 122880
  s_add_u32 s97, s90, 2162688
  buffer_load_dwordx4 v20, s[84:87], s97 offen lds
  s_add_u32 m0, s88, 126976
  s_add_u32 s97, s90, 2424832
  buffer_load_dwordx4 v20, s[84:87], s97 offen lds
  ds_read_b64_tr_b16 a[192:193], v22 offset:0
  ds_read_b64_tr_b16 a[194:195], v22 offset:4096
  ds_read_b64_tr_b16 a[196:197], v22 offset:8192
  ds_read_b64_tr_b16 a[198:199], v22 offset:12288
  ds_read_b64_tr_b16 a[200:201], v23 offset:0
  ds_read_b64_tr_b16 a[202:203], v23 offset:4096
  ds_read_b64_tr_b16 a[204:205], v23 offset:8192
  ds_read_b64_tr_b16 a[206:207], v23 offset:12288
  s_waitcnt vmcnt(24) lgkmcnt(0)
  s_barrier
  s_add_u32 m0, s88, 0
  s_add_u32 s97, s90, 2621440
  buffer_load_dwordx4 v20, s[84:87], s97 offen lds
  s_add_u32 m0, s88, 4096
  s_add_u32 s97, s90, 2883584
  buffer_load_dwordx4 v20, s[84:87], s97 offen lds
  s_add_u32 m0, s88, 8192
  s_add_u32 s97, s90, 2686976
  buffer_load_dwordx4 v20, s[84:87], s97 offen lds
  s_add_u32 m0, s88, 12288
  s_add_u32 s97, s90, 2949120
  buffer_load_dwordx4 v20, s[84:87], s97 offen lds
  v_xor_b32 v50, 0, v44
  ds_read_b64_tr_b16 v[184:185], v50 offset:16384
  v_xor_b32 v50, 32, v44
  ds_read_b64_tr_b16 v[192:193], v50 offset:16384
  v_xor_b32 v50, 64, v44
  ds_read_b64_tr_b16 v[200:201], v50 offset:16384
  v_xor_b32 v50, 96, v44
  ds_read_b64_tr_b16 v[208:209], v50 offset:16384
  v_xor_b32 v50, 128, v44
  ds_read_b64_tr_b16 v[216:217], v50 offset:16384
  v_xor_b32 v50, 160, v44
  ds_read_b64_tr_b16 v[224:225], v50 offset:16384
  v_xor_b32 v50, 192, v44
  ds_read_b64_tr_b16 v[232:233], v50 offset:16384
  v_xor_b32 v50, 224, v44
  ds_read_b64_tr_b16 v[240:241], v50 offset:16384
  s_waitcnt vmcnt(24) lgkmcnt(0)
  s_barrier
  s_add_u32 m0, s88, 16384
  s_add_u32 s97, s90, 3145728
  buffer_load_dwordx4 v20, s[84:87], s97 offen lds
  s_add_u32 m0, s88, 20480
  s_add_u32 s97, s90, 3407872
  buffer_load_dwordx4 v20, s[84:87], s97 offen lds
  s_add_u32 m0, s88, 24576
  s_add_u32 s97, s90, 3211264
  buffer_load_dwordx4 v20, s[84:87], s97 offen lds
  s_add_u32 m0, s88, 28672
  s_add_u32 s97, s90, 3473408
  buffer_load_dwordx4 v20, s[84:87], s97 offen lds
  v_xor_b32 v50, 0, v44
  ds_read_b64_tr_b16 v[186:187], v50 offset:32768
  v_xor_b32 v50, 32, v44
  ds_read_b64_tr_b16 v[194:195], v50 offset:32768
  v_xor_b32 v50, 64, v44
  ds_read_b64_tr_b16 v[202:203], v50 offset:32768
  v_xor_b32 v50, 96, v44
  ds_read_b64_tr_b16 v[210:211], v50 offset:32768
  v_xor_b32 v50, 128, v44
  ds_read_b64_tr_b16 v[218:219], v50 offset:32768
  v_xor_b32 v50, 160, v44
  ds_read_b64_tr_b16 v[226:227], v50 offset:32768
  v_xor_b32 v50, 192, v44
  ds_read_b64_tr_b16 v[234:235], v50 offset:32768
  v_xor_b32 v50, 224, v44
  ds_read_b64_tr_b16 v[242:243], v50 offset:32768
  s_waitcnt vmcnt(24) lgkmcnt(0)
  s_barrier
  s_add_u32 m0, s88, 32768
  s_add_u32 s97, s90, 3670016
  buffer_load_dwordx4 v20, s[84:87], s97 offen lds
  s_add_u32 m0, s88, 36864
  s_add_u32 s97, s90, 3932160
  buffer_load_dwordx4 v20, s[84:87], s97 offen lds
  s_add_u32 m0, s88, 40960
  s_add_u32 s97, s90, 3735552
  buffer_load_dwordx4 v20, s[84:87], s97 offen lds
  s_add_u32 m0, s88, 45056
  s_add_u32 s97, s90, 3997696
  buffer_load_dwordx4 v20, s[84:87], s97 offen lds
  ds_read_b64_tr_b16 a[224:225], v22 offset:49152
  ds_read_b64_tr_b16 a[226:227], v22 offset:53248
  ds_read_b64_tr_b16 a[228:229], v22 offset:57344
  ds_read_b64_tr_b16 a[230:231], v22 offset:61440
  ds_read_b64_tr_b16 a[232:233], v23 offset:49152
  ds_read_b64_tr_b16 a[234:235], v23 offset:53248
  ds_read_b64_tr_b16 a[236:237], v23 offset:57344
  ds_read_b64_tr_b16 a[238:239], v23 offset:61440
  s_waitcnt vmcnt(24) lgkmcnt(0)
  s_barrier
  s_add_u32 m0, s88, 49152
  s_add_u32 s97, s91, 4194304
  buffer_load_dwordx4 v21, s[84:87], s97 offen lds
  s_add_u32 m0, s88, 53248
  s_add_u32 s97, s91, 4325376
  buffer_load_dwordx4 v21, s[84:87], s97 offen lds
  s_add_u32 m0, s88, 57344
  s_add_u32 s97, s91, 4259840
  buffer_load_dwordx4 v21, s[84:87], s97 offen lds
  s_add_u32 m0, s88, 61440
  s_add_u32 s97, s91, 4390912
  buffer_load_dwordx4 v21, s[84:87], s97 offen lds
  ds_read_b64_tr_b16 a[240:241], v24 offset:0
  ds_read_b64_tr_b16 a[242:243], v24 offset:4096
  ds_read_b64_tr_b16 a[244:245], v24 offset:8192
  ds_read_b64_tr_b16 a[246:247], v24 offset:12288
  ds_read_b64_tr_b16 a[248:249], v36 offset:0
  ds_read_b64_tr_b16 a[250:251], v36 offset:4096
  ds_read_b64_tr_b16 a[252:253], v36 offset:8192
  ds_read_b64_tr_b16 a[254:255], v36 offset:12288
  s_waitcnt vmcnt(24) lgkmcnt(0)
  s_barrier
  s_add_u32 m0, s99, 65536
  s_add_u32 s97, s98, 36864
  buffer_load_dwordx4 v40, s[92:95], s97 offen lds
  s_add_u32 m0, s99, 66560
  s_add_u32 s97, s98, 38016
  buffer_load_dwordx4 v41, s[92:95], s97 offen lds
  s_add_u32 m0, s99, 67584
  s_add_u32 s97, s98, 46080
  buffer_load_dwordx4 v42, s[92:95], s97 offen lds
  s_add_u32 m0, s99, 68608
  s_add_u32 s97, s98, 47232
  buffer_load_dwordx4 v43, s[92:95], s97 offen lds
  ds_read_b64_tr_b16 v[72:73], v24 offset:16384
  ds_read_b64_tr_b16 v[74:75], v24 offset:20480
  ds_read_b64_tr_b16 v[76:77], v24 offset:24576
  ds_read_b64_tr_b16 v[78:79], v24 offset:28672
  ds_read_b64_tr_b16 v[80:81], v36 offset:16384
  ds_read_b64_tr_b16 v[82:83], v36 offset:20480
  ds_read_b64_tr_b16 v[84:85], v36 offset:24576
  ds_read_b64_tr_b16 v[86:87], v36 offset:28672
  s_waitcnt vmcnt(24) lgkmcnt(0)
  s_barrier
  s_add_u32 m0, s99, 81920
  s_add_u32 s97, s98, 39168
  buffer_load_dwordx4 v40, s[92:95], s97 offen lds
  s_add_u32 m0, s99, 82944
  s_add_u32 s97, s98, 40320
  buffer_load_dwordx4 v41, s[92:95], s97 offen lds
  s_add_u32 m0, s99, 83968
  s_add_u32 s97, s98, 48384
  buffer_load_dwordx4 v42, s[92:95], s97 offen lds
  s_add_u32 m0, s99, 84992
  s_add_u32 s97, s98, 49536
  buffer_load_dwordx4 v43, s[92:95], s97 offen lds
  ds_read_b64_tr_b16 v[88:89], v24 offset:32768
  ds_read_b64_tr_b16 v[90:91], v24 offset:36864
  ds_read_b64_tr_b16 v[92:93], v24 offset:40960
  ds_read_b64_tr_b16 v[94:95], v24 offset:45056
  ds_read_b64_tr_b16 v[96:97], v36 offset:32768
  ds_read_b64_tr_b16 v[98:99], v36 offset:36864
  ds_read_b64_tr_b16 v[100:101], v36 offset:40960
  ds_read_b64_tr_b16 v[102:103], v36 offset:45056
  s_waitcnt vmcnt(24) lgkmcnt(0)
  s_barrier
  s_mov_b32 s84, s78
  s_mov_b32 s85, s79
  s_add_u32 m0, s88, 98304
  s_add_u32 s97, s90, 0
  buffer_load_dwordx4 v20, s[84:87], s97 offen lds
  s_add_u32 m0, s88, 102400
  s_add_u32 s97, s90, 262144
  buffer_load_dwordx4 v20, s[84:87], s97 offen lds
  s_add_u32 m0, s88, 106496
  s_add_u32 s97, s90, 65536
  buffer_load_dwordx4 v20, s[84:87], s97 offen lds
  s_add_u32 m0, s88, 110592
  s_add_u32 s97, s90, 327680
  buffer_load_dwordx4 v20, s[84:87], s97 offen lds
  ds_read_b64_tr_b16 v[104:105], v24 offset:49152
  ds_read_b64_tr_b16 v[106:107], v24 offset:53248
  ds_read_b64_tr_b16 v[108:109], v24 offset:57344
  ds_read_b64_tr_b16 v[110:111], v24 offset:61440
  ds_read_b64_tr_b16 v[112:113], v36 offset:49152
  ds_read_b64_tr_b16 v[114:115], v36 offset:53248
  ds_read_b64_tr_b16 v[116:117], v36 offset:57344
  ds_read_b64_tr_b16 v[118:119], v36 offset:61440
  s_waitcnt vmcnt(24) lgkmcnt(0)
  s_barrier
  s_add_u32 m0, s88, 114688
  s_add_u32 s97, s90, 524288
  buffer_load_dwordx4 v20, s[84:87], s97 offen lds
  s_add_u32 m0, s88, 118784
  s_add_u32 s97, s90, 786432
  buffer_load_dwordx4 v20, s[84:87], s97 offen lds
  s_add_u32 m0, s88, 122880
  s_add_u32 s97, s90, 589824
  buffer_load_dwordx4 v20, s[84:87], s97 offen lds
  s_add_u32 m0, s88, 126976
  s_add_u32 s97, s90, 851968
  buffer_load_dwordx4 v20, s[84:87], s97 offen lds
  ds_read_b64_tr_b16 v[120:121], v22 offset:0
  ds_read_b64_tr_b16 v[122:123], v22 offset:4096
  ds_read_b64_tr_b16 v[124:125], v22 offset:8192
  ds_read_b64_tr_b16 v[126:127], v22 offset:12288
  ds_read_b64_tr_b16 v[128:129], v23 offset:0
  ds_read_b64_tr_b16 v[130:131], v23 offset:4096
  ds_read_b64_tr_b16 v[132:133], v23 offset:8192
  ds_read_b64_tr_b16 v[134:135], v23 offset:12288
  s_waitcnt vmcnt(24) lgkmcnt(0)
  s_barrier
  s_add_u32 m0, s88, 0
  s_add_u32 s97, s90, 1048576
  buffer_load_dwordx4 v20, s[84:87], s97 offen lds
  s_add_u32 m0, s88, 4096
  s_add_u32 s97, s90, 1310720
  buffer_load_dwordx4 v20, s[84:87], s97 offen lds
  s_add_u32 m0, s88, 8192
  s_add_u32 s97, s90, 1114112
  buffer_load_dwordx4 v20, s[84:87], s97 offen lds
  s_add_u32 m0, s88, 12288
  s_add_u32 s97, s90, 1376256
  buffer_load_dwordx4 v20, s[84:87], s97 offen lds
  ds_read_b64_tr_b16 v[136:137], v22 offset:16384
  ds_read_b64_tr_b16 v[138:139], v22 offset:20480
  ds_read_b64_tr_b16 v[140:141], v22 offset:24576
  ds_read_b64_tr_b16 v[142:143], v22 offset:28672
  ds_read_b64_tr_b16 v[144:145], v23 offset:16384
  ds_read_b64_tr_b16 v[146:147], v23 offset:20480
  ds_read_b64_tr_b16 v[148:149], v23 offset:24576
  ds_read_b64_tr_b16 v[150:151], v23 offset:28672
  s_waitcnt vmcnt(24) lgkmcnt(0)
  s_barrier
  s_add_u32 m0, s88, 16384
  s_add_u32 s97, s90, 1572864
  buffer_load_dwordx4 v20, s[84:87], s97 offen lds
  s_add_u32 m0, s88, 20480
  s_add_u32 s97, s90, 1835008
  buffer_load_dwordx4 v20, s[84:87], s97 offen lds
  s_add_u32 m0, s88, 24576
  s_add_u32 s97, s90, 1638400
  buffer_load_dwordx4 v20, s[84:87], s97 offen lds
  s_add_u32 m0, s88, 28672
  s_add_u32 s97, s90, 1900544
  buffer_load_dwordx4 v20, s[84:87], s97 offen lds
  ds_read_b64_tr_b16 v[152:153], v22 offset:32768
  ds_read_b64_tr_b16 v[154:155], v22 offset:36864
  ds_read_b64_tr_b16 v[156:157], v22 offset:40960
  ds_read_b64_tr_b16 v[158:159], v22 offset:45056
  ds_read_b64_tr_b16 v[160:161], v23 offset:32768
  ds_read_b64_tr_b16 v[162:163], v23 offset:36864
  ds_read_b64_tr_b16 v[164:165], v23 offset:40960
  ds_read_b64_tr_b16 v[166:167], v23 offset:45056
  s_waitcnt vmcnt(24) lgkmcnt(0)
  s_barrier
  s_add_u32 m0, s88, 32768
  s_add_u32 s97, s91, 4194304
  buffer_load_dwordx4 v21, s[84:87], s97 offen lds
  s_add_u32 m0, s88, 36864
  s_add_u32 s97, s91, 4325376
  buffer_load_dwordx4 v21, s[84:87], s97 offen lds
  s_add_u32 m0, s88, 40960
  s_add_u32 s97, s91, 4259840
  buffer_load_dwordx4 v21, s[84:87], s97 offen lds
  s_add_u32 m0, s88, 45056
  s_add_u32 s97, s91, 4390912
  buffer_load_dwordx4 v21, s[84:87], s97 offen lds
  ds_read_b64_tr_b16 v[168:169], v22 offset:49152
  ds_read_b64_tr_b16 v[170:171], v22 offset:53248
  ds_read_b64_tr_b16 v[172:173], v22 offset:57344
  ds_read_b64_tr_b16 v[174:175], v22 offset:61440
  ds_read_b64_tr_b16 v[176:177], v23 offset:49152
  ds_read_b64_tr_b16 v[178:179], v23 offset:53248
  ds_read_b64_tr_b16 v[180:181], v23 offset:57344
  ds_read_b64_tr_b16 v[182:183], v23 offset:61440
  s_waitcnt vmcnt(24) lgkmcnt(0)
  s_barrier
  v_xor_b32 v50, 0, v45
  ds_read_b64_tr_b16 v[188:189], v50 offset:0
  v_xor_b32 v50, 32, v45
  ds_read_b64_tr_b16 v[196:197], v50 offset:0
  v_xor_b32 v50, 64, v45
  ds_read_b64_tr_b16 v[204:205], v50 offset:0
  v_xor_b32 v50, 96, v45
  ds_read_b64_tr_b16 v[212:213], v50 offset:0
  v_xor_b32 v50, 128, v45
  ds_read_b64_tr_b16 v[220:221], v50 offset:0
  v_xor_b32 v50, 160, v45
  ds_read_b64_tr_b16 v[228:229], v50 offset:0
  v_xor_b32 v50, 192, v45
  ds_read_b64_tr_b16 v[236:237], v50 offset:0
  v_xor_b32 v50, 224, v45
  ds_read_b64_tr_b16 v[244:245], v50 offset:0
  s_waitcnt vmcnt(20) lgkmcnt(0)
  s_barrier
  v_xor_b32 v50, 0, v45
  ds_read_b64_tr_b16 v[190:191], v50 offset:16384
  v_xor_b32 v50, 32, v45
  ds_read_b64_tr_b16 v[198:199], v50 offset:16384
  v_xor_b32 v50, 64, v45
  ds_read_b64_tr_b16 v[206:207], v50 offset:16384
  v_xor_b32 v50, 96, v45
  ds_read_b64_tr_b16 v[214:215], v50 offset:16384
  v_xor_b32 v50, 128, v45
  ds_read_b64_tr_b16 v[222:223], v50 offset:16384
  v_xor_b32 v50, 160, v45
  ds_read_b64_tr_b16 v[230:231], v50 offset:16384
  v_xor_b32 v50, 192, v45
  ds_read_b64_tr_b16 v[238:239], v50 offset:16384
  v_xor_b32 v50, 224, v45
  ds_read_b64_tr_b16 v[246:247], v50 offset:16384
  s_waitcnt vmcnt(16) lgkmcnt(0)
  s_barrier
  ds_read_b64_tr_b16 a[112:113], v24 offset:32768
  ds_read_b64_tr_b16 a[114:115], v24 offset:36864
  ds_read_b64_tr_b16 a[116:117], v24 offset:40960
  ds_read_b64_tr_b16 a[118:119], v24 offset:45056
  ds_read_b64_tr_b16 a[120:121], v36 offset:32768
  ds_read_b64_tr_b16 a[122:123], v36 offset:36864
  ds_read_b64_tr_b16 a[124:125], v36 offset:40960
  ds_read_b64_tr_b16 a[126:127], v36 offset:45056
  s_waitcnt vmcnt(12) lgkmcnt(0)
  s_barrier
  ds_read_b64_tr_b16 a[160:161], v24 offset:49152
  ds_read_b64_tr_b16 a[162:163], v24 offset:53248
  ds_read_b64_tr_b16 a[164:165], v24 offset:57344
  ds_read_b64_tr_b16 a[166:167], v24 offset:61440
  ds_read_b64_tr_b16 a[168:169], v36 offset:49152
  ds_read_b64_tr_b16 a[170:171], v36 offset:53248
  ds_read_b64_tr_b16 a[172:173], v36 offset:57344
  ds_read_b64_tr_b16 a[174:175], v36 offset:61440
  s_waitcnt vmcnt(8) lgkmcnt(0)
  s_barrier
  ds_read_b64_tr_b16 a[16:17], v22 offset:0
  ds_read_b64_tr_b16 a[18:19], v22 offset:4096
  ds_read_b64_tr_b16 a[20:21], v22 offset:8192
  ds_read_b64_tr_b16 a[22:23], v22 offset:12288
  ds_read_b64_tr_b16 a[24:25], v23 offset:0
  ds_read_b64_tr_b16 a[26:27], v23 offset:4096
  ds_read_b64_tr_b16 a[28:29], v23 offset:8192
  ds_read_b64_tr_b16 a[30:31], v23 offset:12288
  s_waitcnt vmcnt(4) lgkmcnt(0)
  s_barrier
  ds_read_b64_tr_b16 a[64:65], v22 offset:16384
  ds_read_b64_tr_b16 a[66:67], v22 offset:20480
  ds_read_b64_tr_b16 a[68:69], v22 offset:24576
  ds_read_b64_tr_b16 a[70:71], v22 offset:28672
  ds_read_b64_tr_b16 a[72:73], v23 offset:16384
  ds_read_b64_tr_b16 a[74:75], v23 offset:20480
  ds_read_b64_tr_b16 a[76:77], v23 offset:24576
  ds_read_b64_tr_b16 a[78:79], v23 offset:28672
  s_waitcnt vmcnt(0) lgkmcnt(0)
  s_barrier
  ds_read_b64_tr_b16 a[208:209], v22 offset:32768
  ds_read_b64_tr_b16 a[210:211], v22 offset:36864
  ds_read_b64_tr_b16 a[212:213], v22 offset:40960
  ds_read_b64_tr_b16 a[214:215], v22 offset:45056
  ds_read_b64_tr_b16 a[216:217], v23 offset:32768
  ds_read_b64_tr_b16 a[218:219], v23 offset:36864
  ds_read_b64_tr_b16 a[220:221], v23 offset:40960
  ds_read_b64_tr_b16 a[222:223], v23 offset:45056
  s_waitcnt lgkmcnt(0)
  s_barrier
  s_branch L_cw_done
L_cw3:
  s_mov_b32 s84, s76
  s_mov_b32 s85, s77
  s_add_u32 m0, s88, 0
  s_add_u32 s97, s90, 0
  buffer_load_dwordx4 v20, s[84:87], s97 offen lds
  s_add_u32 m0, s88, 4096
  s_add_u32 s97, s90, 262144
  buffer_load_dwordx4 v20, s[84:87], s97 offen lds
  s_add_u32 m0, s88, 8192
  s_add_u32 s97, s90, 65536
  buffer_load_dwordx4 v20, s[84:87], s97 offen lds
  s_add_u32 m0, s88, 12288
  s_add_u32 s97, s90, 327680
  buffer_load_dwordx4 v20, s[84:87], s97 offen lds
  s_add_u32 m0, s88, 16384
  s_add_u32 s97, s90, 524288
  buffer_load_dwordx4 v20, s[84:87], s97 offen lds
  s_add_u32 m0, s88, 20480
  s_add_u32 s97, s90, 786432
  buffer_load_dwordx4 v20, s[84:87], s97 offen lds
  s_add_u32 m0, s88, 24576
  s_add_u32 s97, s90, 589824
  buffer_load_dwordx4 v20, s[84:87], s97 offen lds
  s_add_u32 m0, s88, 28672
  s_add_u32 s97, s90, 851968
  buffer_load_dwordx4 v20, s[84:87], s97 offen lds
  s_add_u32 m0, s88, 32768
  s_add_u32 s97, s90, 1048576
  buffer_load_dwordx4 v20, s[84:87], s97 offen lds
  s_add_u32 m0, s88, 36864
  s_add_u32 s97, s90, 1310720
  buffer_load_dwordx4 v20, s[84:87], s97 offen lds
  s_add_u32 m0, s88, 40960
  s_add_u32 s97, s90, 1114112
  buffer_load_dwordx4 v20, s[84:87], s97 offen lds
  s_add_u32 m0, s88, 45056
  s_add_u32 s97, s90, 1376256
  buffer_load_dwordx4 v20, s[84:87], s97 offen lds
  s_add_u32 m0, s88, 49152
  s_add_u32 s97, s90, 1572864
  buffer_load_dwordx4 v20, s[84:87], s97 offen lds
  s_add_u32 m0, s88, 53248
  s_add_u32 s97, s90, 1835008
  buffer_load_dwordx4 v20, s[84:87], s97 offen lds
  s_add_u32 m0, s88, 57344
  s_add_u32 s97, s90, 1638400
  buffer_load_dwordx4 v20, s[84:87], s97 offen lds
  s_add_u32 m0, s88, 61440
  s_add_u32 s97, s90, 1900544
  buffer_load_dwordx4 v20, s[84:87], s97 offen lds
  s_add_u32 m0, s88, 65536
  s_add_u32 s97, s90, 2097152
  buffer_load_dwordx4 v20, s[84:87], s97 offen lds
  s_add_u32 m0, s88, 69632
  s_add_u32 s97, s90, 2359296
  buffer_load_dwordx4 v20, s[84:87], s97 offen lds
  s_add_u32 m0, s88, 73728
  s_add_u32 s97, s90, 2162688
  buffer_load_dwordx4 v20, s[84:87], s97 offen lds
  s_add_u32 m0, s88, 77824
  s_add_u32 s97, s90, 2424832
  buffer_load_dwordx4 v20, s[84:87], s97 offen lds
  s_add_u32 m0, s88, 81920
  s_add_u32 s97, s90, 2621440
  buffer_load_dwordx4 v20, s[84:87], s97 offen lds
  s_add_u32 m0, s88, 86016
  s_add_u32 s97, s90, 2883584
  buffer_load_dwordx4 v20, s[84:87], s97 offen lds
  s_add_u32 m0, s88, 90112
  s_add_u32 s97, s90, 2686976
  buffer_load_dwordx4 v20, s[84:87], s97 offen lds
  s_add_u32 m0, s88, 94208
  s_add_u32 s97, s90, 2949120
  buffer_load_dwordx4 v20, s[84:87], s97 offen lds
  s_add_u32 m0, s88, 98304
  s_add_u32 s97, s90, 3145728
  buffer_load_dwordx4 v20, s[84:87], s97 offen lds
  s_add_u32 m0, s88, 102400
  s_add_u32 s97, s90, 3407872
  buffer_load_dwordx4 v20, s[84:87], s97 offen lds
  s_add_u32 m0, s88, 106496
  s_add_u32 s97, s90, 3211264
  buffer_load_dwordx4 v20, s[84:87], s97 offen lds
  s_add_u32 m0, s88, 110592
  s_add_u32 s97, s90, 3473408
  buffer_load_dwordx4 v20, s[84:87], s97 offen lds
  s_waitcnt vmcnt(24) lgkmcnt(0)
  s_barrier
  s_add_u32 m0, s88, 114688
  s_add_u32 s97, s90, 3670016
  buffer_load_dwordx4 v20, s[84:87], s97 offen lds
  s_add_u32 m0, s88, 118784
  s_add_u32 s97, s90, 3932160
  buffer_load_dwordx4 v20, s[84:87], s97 offen lds
  s_add_u32 m0, s88, 122880
  s_add_u32 s97, s90, 3735552
  buffer_load_dwordx4 v20, s[84:87], s97 offen lds
  s_add_u32 m0, s88, 126976
  s_add_u32 s97, s90, 3997696
  buffer_load_dwordx4 v20, s[84:87], s97 offen lds
  ds_read_b64_tr_b16 a[144:145], v22 offset:0
  ds_read_b64_tr_b16 a[146:147], v22 offset:4096
  ds_read_b64_tr_b16 a[148:149], v22 offset:8192
  ds_read_b64_tr_b16 a[150:151], v22 offset:12288
  ds_read_b64_tr_b16 a[152:153], v23 offset:0
  ds_read_b64_tr_b16 a[154:155], v23 offset:4096
  ds_read_b64_tr_b16 a[156:157], v23 offset:8192
  ds_read_b64_tr_b16 a[158:159], v23 offset:12288
  s_waitcnt vmcnt(24) lgkmcnt(0)
  s_barrier
  s_add_u32 m0, s88, 0
  s_add_u32 s97, s91, 4194304
  buffer_load_dwordx4 v21, s[84:87], s97 offen lds
  s_add_u32 m0, s88, 4096
  s_add_u32 s97, s91, 4325376
  buffer_load_dwordx4 v21, s[84:87], s97 offen lds
  s_add_u32 m0, s88, 8192
  s_add_u32 s97, s91, 4259840
  buffer_load_dwordx4 v21, s[84:87], s97 offen lds
  s_add_u32 m0, s88, 12288
  s_add_u32 s97, s91, 4390912
  buffer_load_dwordx4 v21, s[84:87], s97 offen lds
  ds_read_b64_tr_b16 a[96:97], v22 offset:16384
  ds_read_b64_tr_b16 a[98:99], v22 offset:20480
  ds_read_b64_tr_b16 a[100:101], v22 offset:24576
  ds_read_b64_tr_b16 a[102:103], v22 offset:28672
  ds_read_b64_tr_b16 a[104:105], v23 offset:16384
  ds_read_b64_tr_b16 a[106:107], v23 offset:20480
  ds_read_b64_tr_b16 a[108:109], v23 offset:24576
  ds_read_b64_tr_b16 a[110:111], v23 offset:28672
  s_waitcnt vmcnt(24) lgkmcnt(0)
  s_barrier
  s_add_u32 m0, s99, 16384
  s_add_u32 s97, s98, 0
  buffer_load_dwordx4 v40, s[92:95], s97 offen lds
  s_add_u32 m0, s99, 17408
  s_add_u32 s97, s98, 1152
  buffer_load_dwordx4 v41, s[92:95], s97 offen lds
  s_add_u32 m0, s99, 18432
  s_add_u32 s97, s98, 9216
  buffer_load_dwordx4 v42, s[92:95], s97 offen lds
  s_add_u32 m0, s99, 19456
  s_add_u32 s97, s98, 10368
  buffer_load_dwordx4 v43, s[92:95], s97 offen lds
  ds_read_b64_tr_b16 a[48:49], v22 offset:32768
  ds_read_b64_tr_b16 a[50:51], v22 offset:36864
  ds_read_b64_tr_b16 a[52:53], v22 offset:40960
  ds_read_b64_tr_b16 a[54:55], v22 offset:45056
  ds_read_b64_tr_b16 a[56:57], v23 offset:32768
  ds_read_b64_tr_b16 a[58:59], v23 offset:36864
  ds_read_b64_tr_b16 a[60:61], v23 offset:40960
  ds_read_b64_tr_b16 a[62:63], v23 offset:45056
  s_waitcnt vmcnt(24) lgkmcnt(0)
  s_barrier
  s_add_u32 m0, s99, 32768
  s_add_u32 s97, s98, 2304
  buffer_load_dwordx4 v40, s[92:95], s97 offen lds
  s_add_u32 m0, s99, 33792
  s_add_u32 s97, s98, 3456
  buffer_load_dwordx4 v41, s[92:95], s97 offen lds
  s_add_u32 m0, s99, 34816
  s_add_u32 s97, s98, 11520
  buffer_load_dwordx4 v42, s[92:95], s97 offen lds
  s_add_u32 m0, s99, 35840
  s_add_u32 s97, s98, 12672
  buffer_load_dwordx4 v43, s[92:95], s97 offen lds
  ds_read_b64_tr_b16 a[0:1], v22 offset:49152
  ds_read_b64_tr_b16 a[2:3], v22 offset:53248
  ds_read_b64_tr_b16 a[4:5], v22 offset:57344
  ds_read_b64_tr_b16 a[6:7], v22 offset:61440
  ds_read_b64_tr_b16 a[8:9], v23 offset:49152
  ds_read_b64_tr_b16 a[10:11], v23 offset:53248
  ds_read_b64_tr_b16 a[12:13], v23 offset:57344
  ds_read_b64_tr_b16 a[14:15], v23 offset:61440
  s_waitcnt vmcnt(24) lgkmcnt(0)
  s_barrier
  s_mov_b32 s84, s80
  s_mov_b32 s85, s81
  s_add_u32 m0, s88, 49152
  s_add_u32 s97, s90, 0
  buffer_load_dwordx4 v20, s[84:87], s97 offen lds
  s_add_u32 m0, s88, 53248
  s_add_u32 s97, s90, 262144
  buffer_load_dwordx4 v20, s[84:87], s97 offen lds
  s_add_u32 m0, s88, 57344
  s_add_u32 s97, s90, 65536
  buffer_load_dwordx4 v20, s[84:87], s97 offen lds
  s_add_u32 m0, s88, 61440
  s_add_u32 s97, s90, 327680
  buffer_load_dwordx4 v20, s[84:87], s97 offen lds
  ds_read_b64_tr_b16 a[176:177], v24 offset:0
  ds_read_b64_tr_b16 a[178:179], v24 offset:4096
  ds_read_b64_tr_b16 a[180:181], v24 offset:8192
  ds_read_b64_tr_b16 a[182:183], v24 offset:12288
  ds_read_b64_tr_b16 a[184:185], v36 offset:0
  ds_read_b64_tr_b16 a[186:187], v36 offset:4096
  ds_read_b64_tr_b16 a[188:189], v36 offset:8192
  ds_read_b64_tr_b16 a[190:191], v36 offset:12288
  s_waitcnt vmcnt(24) lgkmcnt(0)
  s_barrier
  s_add_u32 m0, s88, 65536
  s_add_u32 s97, s90, 524288
  buffer_load_dwordx4 v20, s[84:87], s97 offen lds
  s_add_u32 m0, s88, 69632
  s_add_u32 s97, s90, 786432
  buffer_load_dwordx4 v20, s[84:87], s97 offen lds
  s_add_u32 m0, s88, 73728
  s_add_u32 s97, s90, 589824
  buffer_load_dwordx4 v20, s[84:87], s97 offen lds
  s_add_u32 m0, s88, 77824
  s_add_u32 s97, s90, 851968
  buffer_load_dwordx4 v20, s[84:87], s97 offen lds
  ds_read_b64_tr_b16 a[128:129], v24 offset:16384
  ds_read_b64_tr_b16 a[130:131], v24 offset:20480
  ds_read_b64_tr_b16 a[132:133], v24 offset:24576
  ds_read_b64_tr_b16 a[134:135], v24 offset:28672
  ds_read_b64_tr_b16 a[136:137], v36 offset:16384
  ds_read_b64_tr_b16 a[138:139], v36 offset:20480
  ds_read_b64_tr_b16 a[140:141], v36 offset:24576
  ds_read_b64_tr_b16 a[142:143], v36 offset:28672
  s_waitcnt vmcnt(24) lgkmcnt(0)
  s_barrier
  s_add_u32 m0, s88, 81920
  s_add_u32 s97, s90, 1048576
  buffer_load_dwordx4 v20, s[84:87], s97 offen lds
  s_add_u32 m0, s88, 86016
  s_add_u32 s97, s90, 1310720
  buffer_load_dwordx4 v20, s[84:87], s97 offen lds
  s_add_u32 m0, s88, 90112
  s_add_u32 s97, s90, 1114112
  buffer_load_dwordx4 v20, s[84:87], s97 offen lds
  s_add_u32 m0, s88, 94208
  s_add_u32 s97, s90, 1376256
  buffer_load_dwordx4 v20, s[84:87], s97 offen lds
  ds_read_b64_tr_b16 a[80:81], v24 offset:32768
  ds_read_b64_tr_b16 a[82:83], v24 offset:36864
  ds_read_b64_tr_b16 a[84:85], v24 offset:40960
  ds_read_b64_tr_b16 a[86:87], v24 offset:45056
  ds_read_b64_tr_b16 a[88:89], v36 offset:32768
  ds_read_b64_tr_b16 a[90:91], v36 offset:36864
  ds_read_b64_tr_b16 a[92:93], v36 offset:40960
  ds_read_b64_tr_b16 a[94:95], v36 offset:45056
  s_waitcnt vmcnt(24) lgkmcnt(0)
  s_barrier
  s_add_u32 m0, s88, 98304
  s_add_u32 s97, s90, 1572864
  buffer_load_dwordx4 v20, s[84:87], s97 offen lds
  s_add_u32 m0, s88, 102400
  s_add_u32 s97, s90, 1835008
  buffer_load_dwordx4 v20, s[84:87], s97 offen lds
  s_add_u32 m0, s88, 106496
  s_add_u32 s97, s90, 1638400
  buffer_load_dwordx4 v20, s[84:87], s97 offen lds
  s_add_u32 m0, s88, 110592
  s_add_u32 s97, s90, 1900544
  buffer_load_dwordx4 v20, s[84:87], s97 offen lds
  ds_read_b64_tr_b16 a[32:33], v24 offset:49152
  ds_read_b64_tr_b16 a[34:35], v24 offset:53248
  ds_read_b64_tr_b16 a[36:37], v24 offset:57344
  ds_read_b64_tr_b16 a[38:39], v24 offset:61440
  ds_read_b64_tr_b16 a[40:41], v36 offset:49152
  ds_read_b64_tr_b16 a[42:43], v36 offset:53248
  ds_read_b64_tr_b16 a[44:45], v36 offset:57344
  ds_read_b64_tr_b16 a[46:47], v36 offset:61440
  s_waitcnt vmcnt(24) lgkmcnt(0)
  s_barrier
  s_add_u32 m0, s88, 114688
  s_add_u32 s97, s90, 2097152
  buffer_load_dwordx4 v20, s[84:87], s97 offen lds
  s_add_u32 m0, s88, 118784
  s_add_u32 s97, s90, 2359296
  buffer_load_dwordx4 v20, s[84:87], s97 offen lds
  s_add_u32 m0, s88, 122880
  s_add_u32 s97, s90, 2162688
  buffer_load_dwordx4 v20, s[84:87], s97 offen lds
  s_add_u32 m0, s88, 126976
  s_add_u32 s97, s90, 2424832
  buffer_load_dwordx4 v20, s[84:87], s97 offen lds
  ds_read_b64_tr_b16 a[192:193], v22 offset:0
  ds_read_b64_tr_b16 a[194:195], v22 offset:4096
  ds_read_b64_tr_b16 a[196:197], v22 offset:8192
  ds_read_b64_tr_b16 a[198:199], v22 offset:12288
  ds_read_b64_tr_b16 a[200:201], v23 offset:0
  ds_read_b64_tr_b16 a[202:203], v23 offset:4096
  ds_read_b64_tr_b16 a[204:205], v23 offset:8192
  ds_read_b64_tr_b16 a[206:207], v23 offset:12288
  s_waitcnt vmcnt(24) lgkmcnt(0)
  s_barrier
  s_add_u32 m0, s88, 0
  s_add_u32 s97, s90, 2621440
  buffer_load_dwordx4 v20, s[84:87], s97 offen lds
  s_add_u32 m0, s88, 4096
  s_add_u32 s97, s90, 2883584
  buffer_load_dwordx4 v20, s[84:87], s97 offen lds
  s_add_u32 m0, s88, 8192
  s_add_u32 s97, s90, 2686976
  buffer_load_dwordx4 v20, s[84:87], s97 offen lds
  s_add_u32 m0, s88, 12288
  s_add_u32 s97, s90, 2949120
  buffer_load_dwordx4 v20, s[84:87], s97 offen lds
  v_xor_b32 v50, 0, v44
  ds_read_b64_tr_b16 v[184:185], v50 offset:16384
  v_xor_b32 v50, 32, v44
  ds_read_b64_tr_b16 v[192:193], v50 offset:16384
  v_xor_b32 v50, 64, v44
  ds_read_b64_tr_b16 v[200:201], v50 offset:16384
  v_xor_b32 v50, 96, v44
  ds_read_b64_tr_b16 v[208:209], v50 offset:16384
  v_xor_b32 v50, 128, v44
  ds_read_b64_tr_b16 v[216:217], v50 offset:16384
  v_xor_b32 v50, 160, v44
  ds_read_b64_tr_b16 v[224:225], v50 offset:16384
  v_xor_b32 v50, 192, v44
  ds_read_b64_tr_b16 v[232:233], v50 offset:16384
  v_xor_b32 v50, 224, v44
  ds_read_b64_tr_b16 v[240:241], v50 offset:16384
  s_waitcnt vmcnt(24) lgkmcnt(0)
  s_barrier
  s_add_u32 m0, s88, 16384
  s_add_u32 s97, s90, 3145728
  buffer_load_dwordx4 v20, s[84:87], s97 offen lds
  s_add_u32 m0, s88, 20480
  s_add_u32 s97, s90, 3407872
  buffer_load_dwordx4 v20, s[84:87], s97 offen lds
  s_add_u32 m0, s88, 24576
  s_add_u32 s97, s90, 3211264
  buffer_load_dwordx4 v20, s[84:87], s97 offen lds
  s_add_u32 m0, s88, 28672
  s_add_u32 s97, s90, 3473408
  buffer_load_dwordx4 v20, s[84:87], s97 offen lds
  v_xor_b32 v50, 0, v44
  ds_read_b64_tr_b16 v[186:187], v50 offset:32768
  v_xor_b32 v50, 32, v44
  ds_read_b64_tr_b16 v[194:195], v50 offset:32768
  v_xor_b32 v50, 64, v44
  ds_read_b64_tr_b16 v[202:203], v50 offset:32768
  v_xor_b32 v50, 96, v44
  ds_read_b64_tr_b16 v[210:211], v50 offset:32768
  v_xor_b32 v50, 128, v44
  ds_read_b64_tr_b16 v[218:219], v50 offset:32768
  v_xor_b32 v50, 160, v44
  ds_read_b64_tr_b16 v[226:227], v50 offset:32768
  v_xor_b32 v50, 192, v44
  ds_read_b64_tr_b16 v[234:235], v50 offset:32768
  v_xor_b32 v50, 224, v44
  ds_read_b64_tr_b16 v[242:243], v50 offset:32768
  s_waitcnt vmcnt(24) lgkmcnt(0)
  s_barrier
  s_add_u32 m0, s88, 32768
  s_add_u32 s97, s90, 3670016
  buffer_load_dwordx4 v20, s[84:87], s97 offen lds
  s_add_u32 m0, s88, 36864
  s_add_u32 s97, s90, 3932160
  buffer_load_dwordx4 v20, s[84:87], s97 offen lds
  s_add_u32 m0, s88, 40960
  s_add_u32 s97, s90, 3735552
  buffer_load_dwordx4 v20, s[84:87], s97 offen lds
  s_add_u32 m0, s88, 45056
  s_add_u32 s97, s90, 3997696
  buffer_load_dwordx4 v20, s[84:87], s97 offen lds
  ds_read_b64_tr_b16 a[224:225], v22 offset:49152
  ds_read_b64_tr_b16 a[226:227], v22 offset:53248
  ds_read_b64_tr_b16 a[228:229], v22 offset:57344
  ds_read_b64_tr_b16 a[230:231], v22 offset:61440
  ds_read_b64_tr_b16 a[232:233], v23 offset:49152
  ds_read_b64_tr_b16 a[234:235], v23 offset:53248
  ds_read_b64_tr_b16 a[236:237], v23 offset:57344
  ds_read_b64_tr_b16 a[238:239], v23 offset:61440
  s_waitcnt vmcnt(24) lgkmcnt(0)
  s_barrier
  s_add_u32 m0, s88, 49152
  s_add_u32 s97, s91, 4194304
  buffer_load_dwordx4 v21, s[84:87], s97 offen lds
  s_add_u32 m0, s88, 53248
  s_add_u32 s97, s91, 4325376
  buffer_load_dwordx4 v21, s[84:87], s97 offen lds
  s_add_u32 m0, s88, 57344
  s_add_u32 s97, s91, 4259840
  buffer_load_dwordx4 v21, s[84:87], s97 offen lds
  s_add_u32 m0, s88, 61440
  s_add_u32 s97, s91, 4390912
  buffer_load_dwordx4 v21, s[84:87], s97 offen lds
  ds_read_b64_tr_b16 a[240:241], v24 offset:0
  ds_read_b64_tr_b16 a[242:243], v24 offset:4096
  ds_read_b64_tr_b16 a[244:245], v24 offset:8192
  ds_read_b64_tr_b16 a[246:247], v24 offset:12288
  ds_read_b64_tr_b16 a[248:249], v36 offset:0
  ds_read_b64_tr_b16 a[250:251], v36 offset:4096
  ds_read_b64_tr_b16 a[252:253], v36 offset:8192
  ds_read_b64_tr_b16 a[254:255], v36 offset:12288
  s_waitcnt vmcnt(24) lgkmcnt(0)
  s_barrier
  s_add_u32 m0, s99, 65536
  s_add_u32 s97, s98, 36864
  buffer_load_dwordx4 v40, s[92:95], s97 offen lds
  s_add_u32 m0, s99, 66560
  s_add_u32 s97, s98, 38016
  buffer_load_dwordx4 v41, s[92:95], s97 offen lds
  s_add_u32 m0, s99, 67584
  s_add_u32 s97, s98, 46080
  buffer_load_dwordx4 v42, s[92:95], s97 offen lds
  s_add_u32 m0, s99, 68608
  s_add_u32 s97, s98, 47232
  buffer_load_dwordx4 v43, s[92:95], s97 offen lds
  ds_read_b64_tr_b16 v[72:73], v24 offset:16384
  ds_read_b64_tr_b16 v[74:75], v24 offset:20480
  ds_read_b64_tr_b16 v[76:77], v24 offset:24576
  ds_read_b64_tr_b16 v[78:79], v24 offset:28672
  ds_read_b64_tr_b16 v[80:81], v36 offset:16384
  ds_read_b64_tr_b16 v[82:83], v36 offset:20480
  ds_read_b64_tr_b16 v[84:85], v36 offset:24576
  ds_read_b64_tr_b16 v[86:87], v36 offset:28672
  s_waitcnt vmcnt(24) lgkmcnt(0)
  s_barrier
  s_add_u32 m0, s99, 81920
  s_add_u32 s97, s98, 39168
  buffer_load_dwordx4 v40, s[92:95], s97 offen lds
  s_add_u32 m0, s99, 82944
  s_add_u32 s97, s98, 40320
  buffer_load_dwordx4 v41, s[92:95], s97 offen lds
  s_add_u32 m0, s99, 83968
  s_add_u32 s97, s98, 48384
  buffer_load_dwordx4 v42, s[92:95], s97 offen lds
  s_add_u32 m0, s99, 84992
  s_add_u32 s97, s98, 49536
  buffer_load_dwordx4 v43, s[92:95], s97 offen lds
  ds_read_b64_tr_b16 v[88:89], v24 offset:32768
  ds_read_b64_tr_b16 v[90:91], v24 offset:36864
  ds_read_b64_tr_b16 v[92:93], v24 offset:40960
  ds_read_b64_tr_b16 v[94:95], v24 offset:45056
  ds_read_b64_tr_b16 v[96:97], v36 offset:32768
  ds_read_b64_tr_b16 v[98:99], v36 offset:36864
  ds_read_b64_tr_b16 v[100:101], v36 offset:40960
  ds_read_b64_tr_b16 v[102:103], v36 offset:45056
  s_waitcnt vmcnt(24) lgkmcnt(0)
  s_barrier
  s_mov_b32 s84, s78
  s_mov_b32 s85, s79
  s_add_u32 m0, s88, 98304
  s_add_u32 s97, s90, 0
  buffer_load_dwordx4 v20, s[84:87], s97 offen lds
  s_add_u32 m0, s88, 102400
  s_add_u32 s97, s90, 262144
  buffer_load_dwordx4 v20, s[84:87], s97 offen lds
  s_add_u32 m0, s88, 106496
  s_add_u32 s97, s90, 65536
  buffer_load_dwordx4 v20, s[84:87], s97 offen lds
  s_add_u32 m0, s88, 110592
  s_add_u32 s97, s90, 327680
  buffer_load_dwordx4 v20, s[84:87], s97 offen lds
  ds_read_b64_tr_b16 v[104:105], v24 offset:49152
  ds_read_b64_tr_b16 v[106:107], v24 offset:53248
  ds_read_b64_tr_b16 v[108:109], v24 offset:57344
  ds_read_b64_tr_b16 v[110:111], v24 offset:61440
  ds_read_b64_tr_b16 v[112:113], v36 offset:49152
  ds_read_b64_tr_b16 v[114:115], v36 offset:53248
  ds_read_b64_tr_b16 v[116:117], v36 offset:57344
  ds_read_b64_tr_b16 v[118:119], v36 offset:61440
  s_waitcnt vmcnt(24) lgkmcnt(0)
  s_barrier
  s_add_u32 m0, s88, 114688
  s_add_u32 s97, s90, 524288
  buffer_load_dwordx4 v20, s[84:87], s97 offen lds
  s_add_u32 m0, s88, 118784
  s_add_u32 s97, s90, 786432
  buffer_load_dwordx4 v20, s[84:87], s97 offen lds
  s_add_u32 m0, s88, 122880
  s_add_u32 s97, s90, 589824
  buffer_load_dwordx4 v20, s[84:87], s97 offen lds
  s_add_u32 m0, s88, 126976
  s_add_u32 s97, s90, 851968
  buffer_load_dwordx4 v20, s[84:87], s97 offen lds
  ds_read_b64_tr_b16 v[120:121], v22 offset:0
  ds_read_b64_tr_b16 v[122:123], v22 offset:4096
  ds_read_b64_tr_b16 v[124:125], v22 offset:8192
  ds_read_b64_tr_b16 v[126:127], v22 offset:12288
  ds_read_b64_tr_b16 v[128:129], v23 offset:0
  ds_read_b64_tr_b16 v[130:131], v23 offset:4096
  ds_read_b64_tr_b16 v[132:133], v23 offset:8192
  ds_read_b64_tr_b16 v[134:135], v23 offset:12288
  s_waitcnt vmcnt(24) lgkmcnt(0)
  s_barrier
  s_add_u32 m0, s88, 0
  s_add_u32 s97, s90, 1048576
  buffer_load_dwordx4 v20, s[84:87], s97 offen lds
  s_add_u32 m0, s88, 4096
  s_add_u32 s97, s90, 1310720
  buffer_load_dwordx4 v20, s[84:87], s97 offen lds
  s_add_u32 m0, s88, 8192
  s_add_u32 s97, s90, 1114112
  buffer_load_dwordx4 v20, s[84:87], s97 offen lds
  s_add_u32 m0, s88, 12288
  s_add_u32 s97, s90, 1376256
  buffer_load_dwordx4 v20, s[84:87], s97 offen lds
  ds_read_b64_tr_b16 v[136:137], v22 offset:16384
  ds_read_b64_tr_b16 v[138:139], v22 offset:20480
  ds_read_b64_tr_b16 v[140:141], v22 offset:24576
  ds_read_b64_tr_b16 v[142:143], v22 offset:28672
  ds_read_b64_tr_b16 v[144:145], v23 offset:16384
  ds_read_b64_tr_b16 v[146:147], v23 offset:20480
  ds_read_b64_tr_b16 v[148:149], v23 offset:24576
  ds_read_b64_tr_b16 v[150:151], v23 offset:28672
  s_waitcnt vmcnt(24) lgkmcnt(0)
  s_barrier
  s_add_u32 m0, s88, 16384
  s_add_u32 s97, s90, 1572864
  buffer_load_dwordx4 v20, s[84:87], s97 offen lds
  s_add_u32 m0, s88, 20480
  s_add_u32 s97, s90, 1835008
  buffer_load_dwordx4 v20, s[84:87], s97 offen lds
  s_add_u32 m0, s88, 24576
  s_add_u32 s97, s90, 1638400
  buffer_load_dwordx4 v20, s[84:87], s97 offen lds
  s_add_u32 m0, s88, 28672
  s_add_u32 s97, s90, 1900544
  buffer_load_dwordx4 v20, s[84:87], s97 offen lds
  ds_read_b64_tr_b16 v[152:153], v22 offset:32768
  ds_read_b64_tr_b16 v[154:155], v22 offset:36864
  ds_read_b64_tr_b16 v[156:157], v22 offset:40960
  ds_read_b64_tr_b16 v[158:159], v22 offset:45056
  ds_read_b64_tr_b16 v[160:161], v23 offset:32768
  ds_read_b64_tr_b16 v[162:163], v23 offset:36864
  ds_read_b64_tr_b16 v[164:165], v23 offset:40960
  ds_read_b64_tr_b16 v[166:167], v23 offset:45056
  s_waitcnt vmcnt(24) lgkmcnt(0)
  s_barrier
  s_add_u32 m0, s88, 32768
  s_add_u32 s97, s91, 4194304
  buffer_load_dwordx4 v21, s[84:87], s97 offen lds
  s_add_u32 m0, s88, 36864
  s_add_u32 s97, s91, 4325376
  buffer_load_dwordx4 v21, s[84:87], s97 offen lds
  s_add_u32 m0, s88, 40960
  s_add_u32 s97, s91, 4259840
  buffer_load_dwordx4 v21, s[84:87], s97 offen lds
  s_add_u32 m0, s88, 45056
  s_add_u32 s97, s91, 4390912
  buffer_load_dwordx4 v21, s[84:87], s97 offen lds
  ds_read_b64_tr_b16 v[168:169], v22 offset:49152
  ds_read_b64_tr_b16 v[170:171], v22 offset:53248
  ds_read_b64_tr_b16 v[172:173], v22 offset:57344
  ds_read_b64_tr_b16 v[174:175], v22 offset:61440
  ds_read_b64_tr_b16 v[176:177], v23 offset:49152
  ds_read_b64_tr_b16 v[178:179], v23 offset:53248
  ds_read_b64_tr_b16 v[180:181], v23 offset:57344
  ds_read_b64_tr_b16 v[182:183], v23 offset:61440
  s_waitcnt vmcnt(24) lgkmcnt(0)
  s_barrier
  v_xor_b32 v50, 0, v45
  ds_read_b64_tr_b16 v[188:189], v50 offset:0
  v_xor_b32 v50, 32, v45
  ds_read_b64_tr_b16 v[196:197], v50 offset:0
  v_xor_b32 v50, 64, v45
  ds_read_b64_tr_b16 v[204:205], v50 offset:0
  v_xor_b32 v50, 96, v45
  ds_read_b64_tr_b16 v[212:213], v50 offset:0
  v_xor_b32 v50, 128, v45
  ds_read_b64_tr_b16 v[220:221], v50 offset:0
  v_xor_b32 v50, 160, v45
  ds_read_b64_tr_b16 v[228:229], v50 offset:0
  v_xor_b32 v50, 192, v45
  ds_read_b64_tr_b16 v[236:237], v50 offset:0
  v_xor_b32 v50, 224, v45
  ds_read_b64_tr_b16 v[244:245], v50 offset:0
  s_waitcnt vmcnt(20) lgkmcnt(0)
  s_barrier
  v_xor_b32 v50, 0, v45
  ds_read_b64_tr_b16 v[190:191], v50 offset:16384
  v_xor_b32 v50, 32, v45
  ds_read_b64_tr_b16 v[198:199], v50 offset:16384
  v_xor_b32 v50, 64, v45
  ds_read_b64_tr_b16 v[206:207], v50 offset:16384
  v_xor_b32 v50, 96, v45
  ds_read_b64_tr_b16 v[214:215], v50 offset:16384
  v_xor_b32 v50, 128, v45
  ds_read_b64_tr_b16 v[222:223], v50 offset:16384
  v_xor_b32 v50, 160, v45
  ds_read_b64_tr_b16 v[230:231], v50 offset:16384
  v_xor_b32 v50, 192, v45
  ds_read_b64_tr_b16 v[238:239], v50 offset:16384
  v_xor_b32 v50, 224, v45
  ds_read_b64_tr_b16 v[246:247], v50 offset:16384
  s_waitcnt vmcnt(16) lgkmcnt(0)
  s_barrier
  ds_read_b64_tr_b16 a[160:161], v24 offset:32768
  ds_read_b64_tr_b16 a[162:163], v24 offset:36864
  ds_read_b64_tr_b16 a[164:165], v24 offset:40960
  ds_read_b64_tr_b16 a[166:167], v24 offset:45056
  ds_read_b64_tr_b16 a[168:169], v36 offset:32768
  ds_read_b64_tr_b16 a[170:171], v36 offset:36864
  ds_read_b64_tr_b16 a[172:173], v36 offset:40960
  ds_read_b64_tr_b16 a[174:175], v36 offset:45056
  s_waitcnt vmcnt(12) lgkmcnt(0)
  s_barrier
  ds_read_b64_tr_b16 a[112:113], v24 offset:49152
  ds_read_b64_tr_b16 a[114:115], v24 offset:53248
  ds_read_b64_tr_b16 a[116:117], v24 offset:57344
  ds_read_b64_tr_b16 a[118:119], v24 offset:61440
  ds_read_b64_tr_b16 a[120:121], v36 offset:49152
  ds_read_b64_tr_b16 a[122:123], v36 offset:53248
  ds_read_b64_tr_b16 a[124:125], v36 offset:57344
  ds_read_b64_tr_b16 a[126:127], v36 offset:61440
  s_waitcnt vmcnt(8) lgkmcnt(0)
  s_barrier
  ds_read_b64_tr_b16 a[64:65], v22 offset:0
  ds_read_b64_tr_b16 a[66:67], v22 offset:4096
  ds_read_b64_tr_b16 a[68:69], v22 offset:8192
  ds_read_b64_tr_b16 a[70:71], v22 offset:12288
  ds_read_b64_tr_b16 a[72:73], v23 offset:0
  ds_read_b64_tr_b16 a[74:75], v23 offset:4096
  ds_read_b64_tr_b16 a[76:77], v23 offset:8192
  ds_read_b64_tr_b16 a[78:79], v23 offset:12288
  s_waitcnt vmcnt(4) lgkmcnt(0)
  s_barrier
  ds_read_b64_tr_b16 a[16:17], v22 offset:16384
  ds_read_b64_tr_b16 a[18:19], v22 offset:20480
  ds_read_b64_tr_b16 a[20:21], v22 offset:24576
  ds_read_b64_tr_b16 a[22:23], v22 offset:28672
  ds_read_b64_tr_b16 a[24:25], v23 offset:16384
  ds_read_b64_tr_b16 a[26:27], v23 offset:20480
  ds_read_b64_tr_b16 a[28:29], v23 offset:24576
  ds_read_b64_tr_b16 a[30:31], v23 offset:28672
  s_waitcnt vmcnt(0) lgkmcnt(0)
  s_barrier
  ds_read_b64_tr_b16 a[208:209], v22 offset:32768
  ds_read_b64_tr_b16 a[210:211], v22 offset:36864
  ds_read_b64_tr_b16 a[212:213], v22 offset:40960
  ds_read_b64_tr_b16 a[214:215], v22 offset:45056
  ds_read_b64_tr_b16 a[216:217], v23 offset:32768
  ds_read_b64_tr_b16 a[218:219], v23 offset:36864
  ds_read_b64_tr_b16 a[220:221], v23 offset:40960
  ds_read_b64_tr_b16 a[222:223], v23 offset:45056
  s_waitcnt lgkmcnt(0)
  s_barrier
L_cw_done:
  v_lshrrev_b32 v25, 4, v11
  v_bfe_u32 v26, v11, 2, 2
  v_and_b32 v27, 3, v11
  v_lshrrev_b32 v28, 1, v25
  v_and_b32 v29, 1, v25
  v_lshrrev_b32 v30, 1, v26
  v_and_b32 v31, 1, v26
  v_lshlrev_b32 v32, 1, v29
  v_xor_b32 v27, v27, v32
  v_lshlrev_b32 v27, 4, v27
  v_lshlrev_b32 v32, 2, v28
  v_add_u32 v32, v32, v29
  v_lshl_add_u32 v32, v31, 4, v32
  v_lshl_add_u32 v32, v30, 1, v32
  v_lshlrev_b32 v32, 13, v32
  v_add_u32 v20, v32, v27
  v_lshlrev_b32 v32, 5, v29
  v_lshl_add_u32 v32, v28, 2, v32
  v_add_u32 v32, v32, v26
  v_lshlrev_b32 v32, 13, v32
  v_add_u32 v21, v32, v27
  v_lshlrev_b32 v32, 4, v28
  v_lshl_add_u32 v32, v29, 2, v32
  v_lshl_add_u32 v32, v30, 3, v32
  v_add_u32 v32, v32, v31
  v_mul_u32_u24 v32, 1152, v32
  v_add_u32 v22, v32, v27
  s_mul_i32 s88, s9, 34816
  s_add_u32 s88, s88, 24576
  v_lshlrev_b32 v23, 8, v25
  v_lshl_add_u32 v23, v26, 6, v23
  v_lshl_add_u32 v23, v29, 5, v23
  v_and_b32 v32, 3, v11
  v_lshl_add_u32 v23, v32, 3, v23
  v_add_u32 v23, s88, v23
  v_xor_b32 v24, 32, v23
  v_lshrrev_b32 v35, 5, v11
  v_bfe_u32 v36, v11, 3, 2
  v_bfe_u32 v37, v11, 1, 2
  v_and_b32 v38, 1, v11
  v_lshlrev_b32 v38, 4, v38
  v_lshlrev_b32 v33, 1, v35
  v_lshrrev_b32 v39, 1, v36
  v_lshl_add_u32 v33, v39, 4, v33
  v_and_b32 v39, 1, v36
  v_lshl_add_u32 v33, v39, 2, v33
  v_lshrrev_b32 v39, 1, v37
  v_lshl_add_u32 v33, v39, 3, v33
  v_and_b32 v39, 1, v37
  v_add_u32 v33, v33, v39
  v_mul_u32_u24 v33, 1152, v33
  v_add_u32 v33, v33, v38
  v_lshlrev_b32 v34, 3, v11
  v_add_u32 v34, s88, v34
  s_lshl_b32 s89, s8, 8
  s_lshl_b32 s90, s9, 6
  s_add_u32 s89, s89, s90
  s_mul_i32 s90, s8, 147456
  s_mov_b32 s86, 4718592
  s_mov_b32 s87, 0x00020000
  s_mov_b32 s94, 4718592
  s_mov_b32 s95, 0x00020000
  s_mov_b32 s92, s82
  s_mov_b32 s93, s83
  s_lshl_b32 s91, s9, 5
  s_add_u32 s91, s91, 1024
  s_add_u32 s91, s91, s90
  s_add_u32 m0, s88, 32768
  s_add_u32 s97, s91, 0
  buffer_load_dwordx4 v33, s[92:95], s97 offen lds
  s_add_u32 m0, s88, 33792
  s_add_u32 s97, s91, 36864
  buffer_load_dwordx4 v33, s[92:95], s97 offen lds
  s_mov_b32 s84, s78
  s_mov_b32 s85, s79
  s_xor_b32 s91, s9, 0
  s_or_b32 s91, s91, 4
  s_lshl_b32 s91, s91, 19
  s_add_u32 s91, s91, s89
  s_add_u32 m0, s88, 0
  s_add_u32 s97, s91, 0
  buffer_load_dwordx4 v20, s[84:87], s97 offen lds
  s_add_u32 m0, s88, 1024
  s_add_u32 s97, s91, 262144
  buffer_load_dwordx4 v20, s[84:87], s97 offen lds
  s_add_u32 m0, s88, 2048
  s_add_u32 s97, s91, 65536
  buffer_load_dwordx4 v20, s[84:87], s97 offen lds
  s_add_u32 m0, s88, 3072
  s_add_u32 s97, s91, 327680
  buffer_load_dwordx4 v20, s[84:87], s97 offen lds
  s_xor_b32 s91, s9, 1
  s_or_b32 s91, s91, 4
  s_lshl_b32 s91, s91, 19
  s_add_u32 s91, s91, s89
  s_add_u32 m0, s88, 4096
  s_add_u32 s97, s91, 0
  buffer_load_dwordx4 v20, s[84:87], s97 offen lds
  s_add_u32 m0, s88, 5120
  s_add_u32 s97, s91, 262144
  buffer_load_dwordx4 v20, s[84:87], s97 offen lds
  s_add_u32 m0, s88, 6144
  s_add_u32 s97, s91, 65536
  buffer_load_dwordx4 v20, s[84:87], s97 offen lds
  s_add_u32 m0, s88, 7168
  s_add_u32 s97, s91, 327680
  buffer_load_dwordx4 v20, s[84:87], s97 offen lds
  s_xor_b32 s91, s9, 2
  s_or_b32 s91, s91, 4
  s_lshl_b32 s91, s91, 19
  s_add_u32 s91, s91, s89
  s_add_u32 m0, s88, 8192
  s_add_u32 s97, s91, 0
  buffer_load_dwordx4 v20, s[84:87], s97 offen lds
  s_add_u32 m0, s88, 9216
  s_add_u32 s97, s91, 262144
  buffer_load_dwordx4 v20, s[84:87], s97 offen lds
  s_add_u32 m0, s88, 10240
  s_add_u32 s97, s91, 65536
  buffer_load_dwordx4 v20, s[84:87], s97 offen lds
  s_add_u32 m0, s88, 11264
  s_add_u32 s97, s91, 327680
  buffer_load_dwordx4 v20, s[84:87], s97 offen lds
  s_xor_b32 s91, s9, 3
  s_or_b32 s91, s91, 4
  s_lshl_b32 s91, s91, 19
  s_add_u32 s91, s91, s89
  s_add_u32 m0, s88, 12288
  s_add_u32 s97, s91, 0
  buffer_load_dwordx4 v20, s[84:87], s97 offen lds
  s_add_u32 m0, s88, 13312
  s_add_u32 s97, s91, 262144
  buffer_load_dwordx4 v20, s[84:87], s97 offen lds
  s_add_u32 m0, s88, 14336
  s_add_u32 s97, s91, 65536
  buffer_load_dwordx4 v20, s[84:87], s97 offen lds
  s_add_u32 m0, s88, 15360
  s_add_u32 s97, s91, 327680
  buffer_load_dwordx4 v20, s[84:87], s97 offen lds
  s_lshl_b32 s91, s9, 8
  s_add_u32 s91, s91, 73728
  s_add_u32 s91, s91, s90
  s_add_u32 m0, s88, 16384
  s_add_u32 s97, s91, 0
  buffer_load_dwordx4 v22, s[92:95], s97 offen lds
  s_add_u32 m0, s88, 17408
  s_add_u32 s97, s91, 2304
  buffer_load_dwordx4 v22, s[92:95], s97 offen lds
  s_add_u32 m0, s88, 18432
  s_add_u32 s97, s91, 36864
  buffer_load_dwordx4 v22, s[92:95], s97 offen lds
  s_add_u32 m0, s88, 19456
  s_add_u32 s97, s91, 39168
  buffer_load_dwordx4 v22, s[92:95], s97 offen lds
  s_lshl_b32 s91, s9, 8
  s_add_u32 s91, s91, 73792
  s_add_u32 s91, s91, s90
  s_add_u32 m0, s88, 20480
  s_add_u32 s97, s91, 0
  buffer_load_dwordx4 v22, s[92:95], s97 offen lds
  s_add_u32 m0, s88, 21504
  s_add_u32 s97, s91, 2304
  buffer_load_dwordx4 v22, s[92:95], s97 offen lds
  s_add_u32 m0, s88, 22528
  s_add_u32 s97, s91, 36864
  buffer_load_dwordx4 v22, s[92:95], s97 offen lds
  s_add_u32 m0, s88, 23552
  s_add_u32 s97, s91, 39168
  buffer_load_dwordx4 v22, s[92:95], s97 offen lds
  s_lshl_b32 s91, s9, 8
  s_add_u32 s91, s91, 73856
  s_add_u32 s91, s91, s90
  s_add_u32 m0, s88, 24576
  s_add_u32 s97, s91, 0
  buffer_load_dwordx4 v22, s[92:95], s97 offen lds
  s_add_u32 m0, s88, 25600
  s_add_u32 s97, s91, 2304
  buffer_load_dwordx4 v22, s[92:95], s97 offen lds
  s_add_u32 m0, s88, 26624
  s_add_u32 s97, s91, 36864
  buffer_load_dwordx4 v22, s[92:95], s97 offen lds
  s_add_u32 m0, s88, 27648
  s_add_u32 s97, s91, 39168
  buffer_load_dwordx4 v22, s[92:95], s97 offen lds
  s_lshl_b32 s91, s9, 8
  s_add_u32 s91, s91, 73920
  s_add_u32 s91, s91, s90
  s_add_u32 m0, s88, 28672
  s_add_u32 s97, s91, 0
  buffer_load_dwordx4 v22, s[92:95], s97 offen lds
  s_add_u32 m0, s88, 29696
  s_add_u32 s97, s91, 2304
  buffer_load_dwordx4 v22, s[92:95], s97 offen lds
  s_add_u32 m0, s88, 30720
  s_add_u32 s97, s91, 36864
  buffer_load_dwordx4 v22, s[92:95], s97 offen lds
  s_add_u32 m0, s88, 31744
  s_add_u32 s97, s91, 39168
  buffer_load_dwordx4 v22, s[92:95], s97 offen lds
  s_waitcnt vmcnt(32)
  s_barrier
  s_cmp_lg_u32 s9, 0
  s_cbranch_scc1 L_cp_noinit
  s_mov_b64 s[66:67], exec
  s_mov_b64 exec, 1
  v_mov_b32 v60, 40
  v_mov_b32 v61, 1
  global_atomic_add v60, v61, s[62:63] sc1
  s_mov_b64 exec, s[66:67]
L_cp_noinit:
  ds_read_b64_tr_b16 v[248:249], v34 offset:32768
  ds_read_b64_tr_b16 v[250:251], v34 offset:33280
  ds_read_b64_tr_b16 v[252:253], v34 offset:33792
  ds_read_b64_tr_b16 v[254:255], v34 offset:34304
  s_waitcnt lgkmcnt(0)
  s_lshl_b32 s91, s9, 5
  s_add_u32 s91, s91, 74752
  s_add_u32 s91, s91, s90
  s_add_u32 m0, s88, 32768
  s_add_u32 s97, s91, 0
  buffer_load_dwordx4 v33, s[92:95], s97 offen lds
  s_add_u32 m0, s88, 33792
  s_add_u32 s97, s91, 36864
  buffer_load_dwordx4 v33, s[92:95], s97 offen lds
  s_waitcnt vmcnt(30)
  ds_read_b64_tr_b16 v[40:41], v23 offset:0
  ds_read_b64_tr_b16 v[42:43], v23 offset:1024
  ds_read_b64_tr_b16 v[44:45], v23 offset:2048
  ds_read_b64_tr_b16 v[46:47], v23 offset:3072
  ds_read_b64_tr_b16 v[48:49], v24 offset:0
  ds_read_b64_tr_b16 v[50:51], v24 offset:1024
  ds_read_b64_tr_b16 v[52:53], v24 offset:2048
  ds_read_b64_tr_b16 v[54:55], v24 offset:3072
  s_waitcnt lgkmcnt(0)
  ds_write_b128 v2, v[40:43] offset:0
  ds_write_b128 v2, v[44:47] offset:1024
  ds_write_b128 v2, v[48:51] offset:2048
  ds_write_b128 v2, v[52:55] offset:3072
  s_waitcnt vmcnt(26)
  ds_read_b64_tr_b16 v[40:41], v23 offset:4096
  ds_read_b64_tr_b16 v[42:43], v23 offset:5120
  ds_read_b64_tr_b16 v[44:45], v23 offset:6144
  ds_read_b64_tr_b16 v[46:47], v23 offset:7168
  ds_read_b64_tr_b16 v[48:49], v24 offset:4096
  ds_read_b64_tr_b16 v[50:51], v24 offset:5120
  ds_read_b64_tr_b16 v[52:53], v24 offset:6144
  ds_read_b64_tr_b16 v[54:55], v24 offset:7168
  s_waitcnt lgkmcnt(0)
  ds_write_b128 v2, v[40:43] offset:4096
  ds_write_b128 v2, v[44:47] offset:5120
  ds_write_b128 v2, v[48:51] offset:6144
  ds_write_b128 v2, v[52:55] offset:7168
  s_waitcnt vmcnt(22)
  ds_read_b64_tr_b16 v[40:41], v23 offset:8192
  ds_read_b64_tr_b16 v[42:43], v23 offset:9216
  ds_read_b64_tr_b16 v[44:45], v23 offset:10240
  ds_read_b64_tr_b16 v[46:47], v23 offset:11264
  ds_read_b64_tr_b16 v[48:49], v24 offset:8192
  ds_read_b64_tr_b16 v[50:51], v24 offset:9216
  ds_read_b64_tr_b16 v[52:53], v24 offset:10240
  ds_read_b64_tr_b16 v[54:55], v24 offset:11264
  s_waitcnt lgkmcnt(0)
  ds_write_b128 v2, v[40:43] offset:8192
  ds_write_b128 v2, v[44:47] offset:9216
  ds_write_b128 v2, v[48:51] offset:10240
  ds_write_b128 v2, v[52:55] offset:11264
  s_waitcnt vmcnt(18)
  ds_read_b64_tr_b16 v[40:41], v23 offset:12288
  ds_read_b64_tr_b16 v[42:43], v23 offset:13312
  ds_read_b64_tr_b16 v[44:45], v23 offset:14336
  ds_read_b64_tr_b16 v[46:47], v23 offset:15360
  ds_read_b64_tr_b16 v[48:49], v24 offset:12288
  ds_read_b64_tr_b16 v[50:51], v24 offset:13312
  ds_read_b64_tr_b16 v[52:53], v24 offset:14336
  ds_read_b64_tr_b16 v[54:55], v24 offset:15360
  s_waitcnt lgkmcnt(0)
  ds_write_b128 v2, v[40:43] offset:12288
  ds_write_b128 v2, v[44:47] offset:13312
  ds_write_b128 v2, v[48:51] offset:14336
  ds_write_b128 v2, v[52:55] offset:15360
  s_waitcnt vmcnt(14)
  ds_read_b64_tr_b16 v[40:41], v23 offset:16384
  ds_read_b64_tr_b16 v[42:43], v23 offset:17408
  ds_read_b64_tr_b16 v[44:45], v23 offset:18432
  ds_read_b64_tr_b16 v[46:47], v23 offset:19456
  ds_read_b64_tr_b16 v[48:49], v24 offset:16384
  ds_read_b64_tr_b16 v[50:51], v24 offset:17408
  ds_read_b64_tr_b16 v[52:53], v24 offset:18432
  ds_read_b64_tr_b16 v[54:55], v24 offset:19456
  s_waitcnt lgkmcnt(0)
  ds_write_b128 v2, v[40:43] offset:16384
  ds_write_b128 v2, v[44:47] offset:17408
  ds_write_b128 v2, v[48:51] offset:18432
  ds_write_b128 v2, v[52:55] offset:19456
  s_waitcnt vmcnt(10)
  ds_read_b64_tr_b16 v[40:41], v23 offset:20480
  ds_read_b64_tr_b16 v[42:43], v23 offset:21504
  ds_read_b64_tr_b16 v[44:45], v23 offset:22528
  ds_read_b64_tr_b16 v[46:47], v23 offset:23552
  ds_read_b64_tr_b16 v[48:49], v24 offset:20480
  ds_read_b64_tr_b16 v[50:51], v24 offset:21504
  ds_read_b64_tr_b16 v[52:53], v24 offset:22528
  ds_read_b64_tr_b16 v[54:55], v24 offset:23552
  s_waitcnt lgkmcnt(0)
  ds_write_b128 v2, v[40:43] offset:20480
  ds_write_b128 v2, v[44:47] offset:21504
  ds_write_b128 v2, v[48:51] offset:22528
  ds_write_b128 v2, v[52:55] offset:23552
  s_waitcnt vmcnt(6)
  ds_read_b64_tr_b16 v[40:41], v23 offset:24576
  ds_read_b64_tr_b16 v[42:43], v23 offset:25600
  ds_read_b64_tr_b16 v[44:45], v23 offset:26624
  ds_read_b64_tr_b16 v[46:47], v23 offset:27648
  ds_read_b64_tr_b16 v[48:49], v24 offset:24576
  ds_read_b64_tr_b16 v[50:51], v24 offset:25600
  ds_read_b64_tr_b16 v[52:53], v24 offset:26624
  ds_read_b64_tr_b16 v[54:55], v24 offset:27648
  s_waitcnt lgkmcnt(0)
  ds_write_b128 v2, v[40:43] offset:24576
  ds_write_b128 v2, v[44:47] offset:25600
  ds_write_b128 v2, v[48:51] offset:26624
  ds_write_b128 v2, v[52:55] offset:27648
  s_waitcnt vmcnt(2)
  ds_read_b64_tr_b16 v[40:41], v23 offset:28672
  ds_read_b64_tr_b16 v[42:43], v23 offset:29696
  ds_read_b64_tr_b16 v[44:45], v23 offset:30720
  ds_read_b64_tr_b16 v[46:47], v23 offset:31744
  ds_read_b64_tr_b16 v[48:49], v24 offset:28672
  ds_read_b64_tr_b16 v[50:51], v24 offset:29696
  ds_read_b64_tr_b16 v[52:53], v24 offset:30720
  ds_read_b64_tr_b16 v[54:55], v24 offset:31744
  s_waitcnt lgkmcnt(0)
  ds_write_b128 v2, v[40:43] offset:28672
  ds_write_b128 v2, v[44:47] offset:29696
  ds_write_b128 v2, v[48:51] offset:30720
  ds_write_b128 v2, v[52:55] offset:31744
  s_waitcnt vmcnt(0)
  ds_read_b64_tr_b16 v[40:41], v34 offset:32768
  ds_read_b64_tr_b16 v[42:43], v34 offset:33280
  ds_read_b64_tr_b16 v[44:45], v34 offset:33792
  ds_read_b64_tr_b16 v[46:47], v34 offset:34304
  s_waitcnt lgkmcnt(0)
  ds_write_b128 v2, v[40:43] offset:32768
  ds_write_b128 v2, v[44:47] offset:33792
  s_waitcnt lgkmcnt(0)
  s_mov_b32 m0, 19968
  s_barrier
  s_cmp_lg_u32 s9, 0
  s_cbranch_scc1 L_cp_nowr
  s_mov_b64 s[66:67], exec
  s_mov_b64 exec, 1
  v_mov_b32 v20, 56
  v_mov_b32 v21, 1
  global_atomic_add v20, v21, s[62:63] sc1
  s_mov_b64 exec, s[66:67]
L_cp_nowr:
  s_cmp_lg_u32 s9, 0
  s_cbranch_scc1 L_cp_w2
  s_mov_b32 s31, 0
L_cp_poll:
  v_mov_b32 v20, 40
  v_mov_b32 v21, 96
  global_load_dwordx2 v[22:23], v20, s[62:63] sc1
  global_load_dword v24, v21, s[62:63] sc1
  s_waitcnt vmcnt(0)
  v_readfirstlane_b32 s73, v22
  v_readfirstlane_b32 s72, v23
  v_readfirstlane_b32 s71, v24
  s_add_u32 s31, s31, 1
  s_cmp_gt_u32 s31, 400000
  s_cbranch_scc1 L_cp_go
  s_cmp_lt_u32 s73, 32
  s_cbranch_scc1 L_cp_again
  s_cmp_ge_u32 s71, 32
  s_cbranch_scc1 L_cp_go
L_cp_again:
  s_sleep 4
  s_branch L_cp_poll
L_cp_go:
  v_mov_b32 v20, 0
  v_mov_b32 v21, s72
  ds_write_b32 v20, v21 offset:19968
  s_waitcnt lgkmcnt(0)
L_cp_w2:
  s_barrier
  v_mov_b32 v20, 0
  ds_read_b32 v21, v20 offset:19968
  s_waitcnt lgkmcnt(0)
  v_readfirstlane_b32 s72, v21
  s_nop 3
  s_barrier
  s_add_u32 s16, s16, 0
  s_add_u32 s17, s17, 0
  s_add_u32 s21, s16, 4096
  s_add_u32 s22, s17, 1024
  buffer_load_dwordx4 v[54:57], v0, s[4:7], s16 offen
  buffer_load_dwordx4 v[58:61], v0, s[4:7], s21 offen
  buffer_load_dwordx4 v[62:65], v0, s[4:7], s17 offen
  buffer_load_dwordx4 v[66:69], v0, s[4:7], s22 offen
  v_mov_b64 v[38:39], 0
  v_mov_b64 v[40:41], 0
  v_mov_b64 v[42:43], 0
  v_mov_b64 v[44:45], 0
  v_mov_b64 v[46:47], 0
  v_mov_b64 v[48:49], 0
  v_mov_b64 v[50:51], 0
  v_mov_b64 v[52:53], 0
  ds_read_b128 v[22:25], v2 offset:0
  ds_read_b128 v[26:29], v2 offset:1024
  ds_read_b128 v[30:33], v2 offset:2048
  ds_read_b128 v[34:37], v2 offset:3072
  v_add_u32 v70, s25, v0
  v_lshrrev_b32 v19, 2, v0
  v_add_u32 v71, s37, v19
  s_mov_b32 s31, 0
  s_add_u32 s21, s12, s25
  s_add_u32 s22, s21, 4096
  s_add_u32 s23, s12, s27
  buffer_load_dwordx4 v[10:13], v0, s[4:7], s21 offen sc1
  buffer_load_dwordx4 v[14:17], v0, s[4:7], s22 offen sc1
  buffer_load_dword v18, v19, s[4:7], s23 offen sc1
  s_waitcnt vmcnt(0)
  s_sub_u32 s73, s72, 1
  s_and_b32 s73, s73, s72
  s_cmp_eq_u32 s73, 0
  s_cbranch_scc0 L_steps
L_stepf:
  s_waitcnt vmcnt(0)
L_gchkf:
  v_max3_u32 v20, v10, v11, v12
  v_max3_u32 v21, v13, v14, v15
  v_max3_u32 v20, v20, v16, v17
  v_max3_u32 v20, v20, v21, v18
  v_cmp_eq_u32 vcc, -1, v20
  s_cbranch_vccnz L_gretryf
L_gokf:
  ds_write_b128 v70, v[10:13]
  ds_write_b128 v70, v[14:17] offset:4096
  ds_write_b32 v71, v18 offset:8192
  v_smfmac_f32_16x16x64_bf16 v[38:41], v[10:13], a[0:7], v1
  v_smfmac_f32_16x16x64_bf16 v[42:45], v[10:13], a[8:15], v1
  v_smfmac_f32_16x16x64_bf16 v[46:49], v[10:13], a[16:23], v1
  v_smfmac_f32_16x16x64_bf16 v[50:53], v[10:13], a[24:31], v1
  s_waitcnt lgkmcnt(0)
  s_barrier
  v_xor_b32 v71, 1024, v70
  ds_read_b128 v[18:21], v71 offset:0
  v_smfmac_f32_16x16x64_bf16 v[46:49], v[14:17], v[22:29], v1
  s_mov_b64 vcc, s[34:35]
  s_add_u32 s24, s16, 262144
  ds_read_b128 v[10:13], v71 offset:4096
  v_smfmac_f32_16x16x64_bf16 v[50:53], v[14:17], v[30:37], v1
  buffer_load_dword v9, s[4:7], s24 offen lds
  ds_read_b128 v[22:25], v2 offset:4096
  v_xor_b32 v71, 2048, v70
  v_smfmac_f32_16x16x64_bf16 v[38:41], v[14:17], a[32:39], v1
  buffer_atomic_add v8, v7, s[4:7], s58 offen sc1
  ds_read_b128 v[26:29], v2 offset:5120
  v_smfmac_f32_16x16x64_bf16 v[42:45], v[14:17], a[40:47], v1
  ds_read_b128 v[30:33], v2 offset:6144
  ds_read_b128 v[34:37], v2 offset:7168
  s_waitcnt lgkmcnt(5)
  v_smfmac_f32_16x16x64_bf16 v[46:49], v[18:21], a[64:71], v1
  ds_read_b128 v[14:17], v71 offset:0
  v_smfmac_f32_16x16x64_bf16 v[50:53], v[18:21], a[72:79], v1
  v_smfmac_f32_16x16x64_bf16 v[38:41], v[18:21], a[48:55], v1
  v_smfmac_f32_16x16x64_bf16 v[42:45], v[18:21], a[56:63], v1
  ds_read_b128 v[18:21], v71 offset:4096
  v_xor_b32 v71, 3072, v70
  s_waitcnt lgkmcnt(4)
  v_smfmac_f32_16x16x64_bf16 v[46:49], v[10:13], v[22:29], v1
  ds_read_b128 v[22:25], v2 offset:8192
  s_waitcnt lgkmcnt(3)
  v_smfmac_f32_16x16x64_bf16 v[50:53], v[10:13], v[30:37], v1
  ds_read_b128 v[26:29], v2 offset:9216
  v_smfmac_f32_16x16x64_bf16 v[38:41], v[10:13], a[80:87], v1
  ds_read_b128 v[30:33], v2 offset:10240
  v_smfmac_f32_16x16x64_bf16 v[42:45], v[10:13], a[88:95], v1
  ds_read_b128 v[34:37], v2 offset:11264
  s_waitcnt lgkmcnt(5)
  v_smfmac_f32_16x16x64_bf16 v[46:49], v[14:17], a[112:119], v1
  ds_read_b128 v[10:13], v71 offset:0
  v_smfmac_f32_16x16x64_bf16 v[50:53], v[14:17], a[120:127], v1
  v_smfmac_f32_16x16x64_bf16 v[38:41], v[14:17], a[96:103], v1
  v_smfmac_f32_16x16x64_bf16 v[42:45], v[14:17], a[104:111], v1
  ds_read_b128 v[14:17], v71 offset:4096
  s_waitcnt lgkmcnt(4)
  v_smfmac_f32_16x16x64_bf16 v[46:49], v[18:21], v[22:29], v1
  ds_read_b128 v[22:25], v2 offset:12288
  s_waitcnt lgkmcnt(3)
  v_smfmac_f32_16x16x64_bf16 v[50:53], v[18:21], v[30:37], v1
  ds_read_b128 v[26:29], v2 offset:13312
  v_smfmac_f32_16x16x64_bf16 v[38:41], v[18:21], a[128:135], v1
  ds_read_b128 v[30:33], v2 offset:14336
  v_smfmac_f32_16x16x64_bf16 v[42:45], v[18:21], a[136:143], v1
  ds_read_b128 v[34:37], v2 offset:15360
  s_waitcnt lgkmcnt(5)
  v_smfmac_f32_16x16x64_bf16 v[38:41], v[10:13], a[144:151], v1
  ds_read_b128 v[18:21], v0 offset:8192
  v_smfmac_f32_16x16x64_bf16 v[42:45], v[10:13], a[152:159], v1
  v_smfmac_f32_16x16x64_bf16 v[46:49], v[10:13], a[160:167], v1
  v_smfmac_f32_16x16x64_bf16 v[50:53], v[10:13], a[168:175], v1
  ds_read_b128 v[10:13], v0 offset:0
  s_waitcnt lgkmcnt(6)
  v_smfmac_f32_16x16x64_bf16 v[38:41], v[14:17], a[176:183], v1
  v_smfmac_f32_16x16x64_bf16 v[42:45], v[14:17], a[184:191], v1
  s_waitcnt lgkmcnt(4)
  v_smfmac_f32_16x16x64_bf16 v[46:49], v[14:17], v[22:29], v1
  v_mov_b64 v[22:23], 0
  s_waitcnt lgkmcnt(2)
  v_smfmac_f32_16x16x64_bf16 v[50:53], v[14:17], v[30:37], v1
  ds_read_b128 v[14:17], v0 offset:1024
  v_add_u32 v35, s59, v0
  s_waitcnt lgkmcnt(2)
  v_smfmac_f32_16x16x64_bf16 v[38:41], v[18:21], a[192:199], v1
  v_mov_b64 v[24:25], 0
  v_smfmac_f32_16x16x64_bf16 v[42:45], v[18:21], a[200:207], v1
  v_mov_b64 v[26:27], 0
  v_smfmac_f32_16x16x64_bf16 v[46:49], v[18:21], a[208:215], v1
  v_add_f32 v38, v38, v39
  v_smfmac_f32_16x16x64_bf16 v[50:53], v[18:21], a[216:223], v1
  ds_read_b128 v[18:21], v0 offset:2048
  v_add_f32 v40, v40, v41
  v_add_f32 v42, v42, v43
  s_nop 0
  v_add_f32 v46, v46, v47
  v_add_f32 v48, v48, v49
  v_add_f32 v44, v44, v45
  v_cvt_pk_bf16_f32 v46, v46, v48
  v_add_f32 v50, v50, v51
  v_add_f32 v52, v52, v53
  v_cvt_pk_bf16_f32 v47, v38, v40
  v_cvt_pk_bf16_f32 v50, v50, v52
  v_cvt_pk_bf16_f32 v51, v42, v44
  v_mfma_f32_16x16x16_bf16 v[38:41], v[46:47], v[4:5], 0
  v_mov_b64 v[28:29], 0
  v_mfma_f32_16x16x16_bf16 v[42:45], v[50:51], v[4:5], 0
  s_waitcnt lgkmcnt(2)
  v_smfmac_f32_16x16x64_bf16 v[22:25], v[10:13], a[224:231], v1
  v_cvt_pk_bf16_f32 v30, v38, v39
  v_cvt_pk_bf16_f32 v31, v40, v41
  s_nop 1
  v_cvt_pk_bf16_f32 v32, v42, v43
  v_cvt_pk_bf16_f32 v33, v44, v45
  v_smfmac_f32_16x16x64_bf16 v[26:29], v[10:13], a[232:239], v1
  ds_read_b128 v[10:13], v0 offset:3072
  v_mfma_f32_16x16x32_bf16 v[50:53], v[54:57], v[30:33], 0
  v_mfma_f32_16x16x32_bf16 v[38:41], v[58:61], v[30:33], 0
  v_mfma_f32_16x16x32_bf16 v[46:49], v[30:33], v[30:33], 0
  s_waitcnt lgkmcnt(2)
  v_smfmac_f32_16x16x64_bf16 v[22:25], v[14:17], a[240:247], v1
  v_cndmask_b32_dpp v42, v38, v50, vcc quad_perm:[2,3,2,3] row_mask:0xf bank_mask:0xf
  v_cndmask_b32_dpp v43, v39, v51, vcc quad_perm:[2,3,2,3] row_mask:0xf bank_mask:0xf
  v_cndmask_b32_dpp v44, v40, v52, vcc quad_perm:[2,3,2,3] row_mask:0xf bank_mask:0xf
  v_cndmask_b32_dpp v45, v41, v53, vcc quad_perm:[2,3,2,3] row_mask:0xf bank_mask:0xf
  v_cndmask_b32_dpp v34, v47, v46, vcc quad_perm:[2,3,2,3] row_mask:0xf bank_mask:0xf
  ds_write_b128 v70, v[42:45] offset:9216
  v_smfmac_f32_16x16x64_bf16 v[26:29], v[14:17], a[248:255], v1
  ds_write_b32 v35, v34 offset:13312
  buffer_store_dwordx4 v[30:33], v0, s[4:7], s18 offen sc1
  ds_read_b128 v[14:17], v0 offset:4096
  s_waitcnt lgkmcnt(0)
  s_barrier
  ds_read_b128 v[38:41], v0 offset:9216
  v_smfmac_f32_16x16x64_bf16 v[22:25], v[18:21], v[72:79], v1
  ds_read_b128 v[42:45], v0 offset:10240
  v_smfmac_f32_16x16x64_bf16 v[26:29], v[18:21], v[80:87], v1
  ds_read_b128 v[46:49], v0 offset:11264
  v_smfmac_f32_16x16x64_bf16 v[22:25], v[10:13], v[88:95], v1
  ds_read_b128 v[50:53], v0 offset:12288
  v_smfmac_f32_16x16x64_bf16 v[26:29], v[10:13], v[96:103], v1
  ds_read_b128 v[30:33], v0 offset:13312
  v_smfmac_f32_16x16x64_bf16 v[22:25], v[14:17], v[104:111], v1
  ds_read_b128 v[18:21], v0 offset:5120
  v_smfmac_f32_16x16x64_bf16 v[26:29], v[14:17], v[112:119], v1
  ds_read_b128 v[10:13], v0 offset:6144
  s_waitcnt lgkmcnt(5)
  v_add_f32 v38, v38, v42
  v_add_f32 v39, v39, v43
  v_add_f32 v40, v40, v44
  v_add_f32 v41, v41, v45
  ds_read_b128 v[14:17], v0 offset:7168
  v_mov_b64 v[34:35], -1
  buffer_store_dwordx2 v[34:35], v7, s[4:7], s55 offen
  s_waitcnt lgkmcnt(4)
  v_add_f32 v46, v46, v50
  v_add_f32 v47, v47, v51
  v_add_f32 v48, v48, v52
  v_add_f32 v38, v38, v46
  v_add_f32 v39, v39, v47
  v_add_f32 v40, v40, v48
  v_add_f32 v49, v49, v53
  s_waitcnt lgkmcnt(3)
  v_add_f32 v30, v30, v31
  v_add_f32 v32, v32, v33
  v_add_f32 v41, v41, v49
  v_add_f32 v30, v30, v32
  v_max3_f32 v42, v38, v39, v40
  v_max3_f32 v42, v42, v41, v30
  s_waitcnt lgkmcnt(2)
  v_smfmac_f32_16x16x64_bf16 v[22:25], v[18:21], v[120:127], v1
  ds_read_b128 v[48:51], v0 offset:20864
  buffer_store_dword v34, v7, s[4:7], s56 offen
  v_max_f32_dpp v42, v42, v42 quad_perm:[2,3,0,1] row_mask:0xf bank_mask:0xf
  v_mov_b32 v43, v42
  v_smfmac_f32_16x16x64_bf16 v[26:29], v[18:21], v[128:135], v1
  ds_read_b128 v[18:21], v0 offset:8192
  buffer_store_dword v34, v7, s[4:7], s56 offen offset:32
  v_permlane16_swap_b32 v42, v43
  ds_read_b64 v[52:53], v0 offset:21888
  v_max_f32 v42, v42, v43
  v_mov_b32 v43, v42
  s_waitcnt lgkmcnt(4)
  v_smfmac_f32_16x16x64_bf16 v[22:25], v[10:13], v[136:143], v1
  ds_read_b128 v[54:57], v2 offset:16384
  v_permlane32_swap_b32 v42, v43
  v_max_f32 v42, v42, v43
  v_mul_f32 v42, s20, v42
  v_fma_f32 v38, v38, s20, -v42
  v_fma_f32 v39, v39, s20, -v42
  v_fma_f32 v40, v40, s20, -v42
  v_fma_f32 v41, v41, s20, -v42
  v_fma_f32 v30, v30, s20, -v42
  v_exp_f32 v38, v38
  ds_read_b128 v[58:61], v2 offset:17408
  v_exp_f32 v39, v39
  v_exp_f32 v40, v40
  v_exp_f32 v41, v41
  v_exp_f32 v30, v30
  v_cvt_pk_bf16_f32 v44, v38, v39
  v_cvt_pk_bf16_f32 v45, v40, v41
  v_cvt_pk_bf16_f32 v32, v30, v30
  v_mov_b32_dpp v46, v44 quad_perm:[0,1,0,1] row_mask:0xf bank_mask:0xf
  v_mov_b32_dpp v47, v45 quad_perm:[0,1,0,1] row_mask:0xf bank_mask:0xf
  v_mov_b32_dpp v33, v32 quad_perm:[0,1,0,1] row_mask:0xf bank_mask:0xf
  v_smfmac_f32_16x16x64_bf16 v[26:29], v[10:13], v[144:151], v1
  s_waitcnt lgkmcnt(5)
  v_smfmac_f32_16x16x64_bf16 v[22:25], v[14:17], v[152:159], v1
  v_smfmac_f32_16x16x64_bf16 v[26:29], v[14:17], v[160:167], v1
  s_waitcnt lgkmcnt(3)
  v_smfmac_f32_16x16x64_bf16 v[22:25], v[18:21], v[168:175], v1
  v_smfmac_f32_16x16x64_bf16 v[26:29], v[18:21], v[176:183], v1
  v_mfma_f32_16x16x32_bf16 v[34:37], v[48:51], v[44:47], 0
  v_cvt_pk_bf16_f32 v22, v22, v23
  v_cvt_pk_bf16_f32 v23, v24, v25
  v_mfma_f32_16x16x32_bf16 v[38:41], v[62:65], v[44:47], 0
  v_cvt_pk_bf16_f32 v24, v26, v27
  v_cvt_pk_bf16_f32 v25, v28, v29
  v_mfma_f32_16x16x32_bf16 v[10:13], v[66:69], v[44:47], 0
  s_waitcnt lgkmcnt(2)
  v_mfma_f32_16x16x16_bf16 v[34:37], v[52:53], v[32:33], v[34:37]
  v_mfma_f32_16x16x16_bf16 v[38:41], v[22:23], v[32:33], v[38:41]
  v_mfma_f32_16x16x16_bf16 v[10:13], v[24:25], v[32:33], v[10:13]
  v_rcp_f32 v42, v34
  s_nop 2
  v_pk_mul_f32 v[38:39], v[38:39], v[42:43] op_sel_hi:[1,0]
  v_pk_mul_f32 v[40:41], v[40:41], v[42:43] op_sel_hi:[1,0]
  v_cvt_pk_bf16_f32 v38, v38, v39
  v_cvt_pk_bf16_f32 v39, v40, v41
  v_pk_mul_f32 v[10:11], v[10:11], v[42:43] op_sel_hi:[1,0]
  v_pk_mul_f32 v[12:13], v[12:13], v[42:43] op_sel_hi:[1,0]
  v_cvt_pk_bf16_f32 v10, v10, v11
  v_cvt_pk_bf16_f32 v11, v12, v13
  ds_write_b64 v3, v[38:39] offset:0
  ds_write_b64 v3, v[10:11] offset:32
  buffer_store_dwordx4 v[22:25], v0, s[4:7], s19 offen sc1
  v_mov_b64 v[42:43], 0
  v_mov_b64 v[44:45], 0
  v_mov_b64 v[46:47], 0
  v_mov_b64 v[48:49], 0
  v_mov_b64 v[50:51], 0
  v_mov_b64 v[52:53], 0
  v_mov_b64 v[40:41], 0
  v_mov_b64 v[38:39], 0
  s_cmp_eq_u32 s10, s38
  s_cbranch_scc1 L_chain_end
  s_waitcnt lgkmcnt(0)
  s_barrier
  ds_read_b128 v[14:17], v6 offset:0
  v_lshrrev_b32 v71, 2, v0
  ds_read_b128 v[18:21], v6 offset:128
  ds_read_b128 v[62:65], v2 offset:18432
  ds_read_b128 v[66:69], v2 offset:19456
  ds_read_b128 v[22:25], v2 offset:20480
  ds_read_b128 v[26:29], v2 offset:21504
  s_waitcnt lgkmcnt(5)
  v_smfmac_f32_16x16x64_bf16 v[38:41], v[14:17], v[184:191], v1
  ds_read_b128 v[30:33], v2 offset:22528
  v_smfmac_f32_16x16x64_bf16 v[42:45], v[14:17], v[192:199], v1
  ds_read_b128 v[34:37], v2 offset:23552
  s_waitcnt lgkmcnt(6)
  v_smfmac_f32_16x16x64_bf16 v[38:41], v[18:21], v[54:61], v1
  ds_read_b128 v[54:57], v2 offset:24576
  s_waitcnt lgkmcnt(5)
  v_smfmac_f32_16x16x64_bf16 v[42:45], v[18:21], v[62:69], v1
  ds_read_b128 v[58:61], v2 offset:25600
  v_smfmac_f32_16x16x64_bf16 v[46:49], v[14:17], v[200:207], v1
  ds_read_b128 v[62:65], v2 offset:26624
  v_add_f32 v38, v38, v39
  v_add_f32 v40, v40, v41
  s_nop 0
  v_add_f32 v42, v42, v43
  ds_read_b128 v[66:69], v2 offset:27648
  v_add_f32 v44, v44, v45
  v_cvt_pk_bf16_f32 v10, v38, v42
  v_cvt_pk_bf16_f32 v12, v40, v44
  v_mov_b64 v[38:39], 0
  v_mov_b64 v[40:41], 0
  v_smfmac_f32_16x16x64_bf16 v[50:53], v[14:17], v[208:215], v1
  v_mov_b64 v[42:43], 0
  v_smfmac_f32_16x16x64_bf16 v[38:41], v[14:17], v[216:223], v1
  v_mov_b64 v[44:45], 0
  s_waitcnt lgkmcnt(6)
  v_smfmac_f32_16x16x64_bf16 v[46:49], v[18:21], v[22:29], v1
  ds_read_b128 v[22:25], v2 offset:28672
  v_bfi_b32 v10, 1, s39, v10
  s_waitcnt lgkmcnt(5)
  v_smfmac_f32_16x16x64_bf16 v[50:53], v[18:21], v[30:37], v1
  ds_read_b128 v[26:29], v2 offset:29696
  v_smfmac_f32_16x16x64_bf16 v[42:45], v[14:17], v[224:231], v1
  ds_read_b128 v[30:33], v2 offset:30720
  v_add_f32 v46, v46, v47
  s_waitcnt lgkmcnt(5)
  v_smfmac_f32_16x16x64_bf16 v[38:41], v[18:21], v[54:61], v1
  ds_read_b128 v[34:37], v2 offset:31744
  v_add_f32 v48, v48, v49
  s_waitcnt lgkmcnt(4)
  v_smfmac_f32_16x16x64_bf16 v[42:45], v[18:21], v[62:69], v1
  ds_read_b128 v[54:57], v2 offset:32768
  v_add_f32 v50, v50, v51
  v_add_f32 v52, v52, v53
  ds_read_b128 v[58:61], v2 offset:33792
  v_cvt_pk_bf16_f32 v11, v46, v50
  v_cvt_pk_bf16_f32 v13, v48, v52
  v_add_f32 v38, v38, v39
  v_add_f32 v40, v40, v41
  v_add_f32 v42, v42, v43
  v_add_f32 v44, v44, v45
  v_mov_b64 v[46:47], 0
  v_mov_b64 v[48:49], 0
  v_mov_b64 v[50:51], 0
  v_mov_b64 v[52:53], 0
  buffer_store_dwordx4 v[10:13], v0, s[4:7], s11 offen offset:0
  s_nop 1
  v_cvt_pk_bf16_f32 v10, v38, v42
  v_cvt_pk_bf16_f32 v12, v40, v44
  v_mov_b64 v[38:39], 0
  v_mov_b64 v[40:41], 0
  v_smfmac_f32_16x16x64_bf16 v[46:49], v[14:17], v[232:239], v1
  v_bfi_b32 v10, 1, s39, v10
  v_smfmac_f32_16x16x64_bf16 v[50:53], v[14:17], v[240:247], v1
  v_smfmac_f32_16x16x64_bf16 v[38:41], v[14:17], v[248:255], v1
  s_waitcnt lgkmcnt(4)
  v_smfmac_f32_16x16x64_bf16 v[46:49], v[18:21], v[22:29], v1
  s_waitcnt lgkmcnt(2)
  v_smfmac_f32_16x16x64_bf16 v[50:53], v[18:21], v[30:37], v1
  s_waitcnt lgkmcnt(0)
  v_smfmac_f32_16x16x64_bf16 v[38:41], v[18:21], v[54:61], v1
  v_add_f32 v46, v46, v47
  v_add_f32 v48, v48, v49
  s_nop 1
  v_add_f32 v50, v50, v51
  v_add_f32 v52, v52, v53
  v_cvt_pk_bf16_f32 v11, v46, v50
  v_cvt_pk_bf16_f32 v13, v48, v52
  v_add_f32 v38, v38, v39
  v_add_f32 v40, v40, v41
  v_cvt_pk_bf16_f32 v70, v38, v40
  buffer_store_dwordx4 v[10:13], v0, s[4:7], s11 offen offset:1024
  v_bfi_b32 v70, 1, s39, v70
  buffer_store_dword v70, v71, s[4:7], s33 offen
  s_cmp_lg_u32 s9, 0
  s_cbranch_scc1 L_rotherf
  v_and_b32 v70, 0xf0, v0
  ds_read_b128 v[58:61], v70 offset:19712
  v_mov_b64 v[38:39], 0
  v_mov_b64 v[40:41], 0
  v_mov_b64 v[42:43], 0
  v_mov_b64 v[44:45], 0
  v_mov_b64 v[46:47], 0
  v_mov_b64 v[48:49], 0
  v_mov_b64 v[50:51], 0
  v_mov_b64 v[52:53], 0
  s_lshl_b32 s58, s10, 2
  s_add_u32 s58, s58, 115408896
  s_cmp_eq_u32 s9, 3
  s_cselect_b32 s58, s58, 1073741824
  s_add_u32 s10, s10, 1
  s_add_u32 s18, s18, 131072
  s_add_u32 s19, s19, 131072
  s_xor_b32 s11, s11, 0x80000
  s_xor_b32 s33, s33, 0x80000
  s_add_u32 s21, s12, s29
  s_cmp_eq_u32 s9, 0
  s_cselect_b32 s55, s21, 1073741824
  s_cmp_eq_u32 s9, 1
  s_cselect_b32 s56, s21, 1073741824
  s_mov_b32 s31, 0
  v_mov_b32 v66, 0
  s_waitcnt vmcnt(0)
L_rpollf:
  s_mov_b32 s21, s28
  buffer_load_dwordx4 v[10:13], v8, s[4:7], s21 offen sc1
  s_add_u32 s21, s21, 36864
  buffer_load_dwordx4 v[14:17], v8, s[4:7], s21 offen sc1
  s_add_u32 s21, s21, 36864
  buffer_load_dwordx4 v[18:21], v8, s[4:7], s21 offen sc1
  s_add_u32 s21, s21, 36864
  buffer_load_dwordx4 v[22:25], v8, s[4:7], s21 offen sc1
  s_add_u32 s21, s21, 36864
  buffer_load_dwordx4 v[26:29], v8, s[4:7], s21 offen sc1
  s_add_u32 s21, s21, 36864
  buffer_load_dwordx4 v[30:33], v8, s[4:7], s21 offen sc1
  s_add_u32 s21, s21, 36864
  buffer_load_dwordx4 v[34:37], v8, s[4:7], s21 offen sc1
  s_add_u32 s21, s21, 36864
  buffer_load_dwordx4 v[54:57], v8, s[4:7], s21 offen sc1
  s_add_u32 s22, s13, s29
  s_waitcnt lgkmcnt(0)
  s_waitcnt vmcnt(7)
  v_mfma_f32_16x16x32_bf16 v[62:65], v[58:61], v[10:13], 0
  v_bitop3_b32 v66, v66, v10, s39 bitop3:0xf6
  s_waitcnt vmcnt(6)
  v_mfma_f32_16x16x32_bf16 v[62:65], v[58:61], v[14:17], v[62:65]
  v_bitop3_b32 v66, v66, v14, s39 bitop3:0xf6
  s_waitcnt vmcnt(5)
  v_mfma_f32_16x16x32_bf16 v[62:65], v[58:61], v[18:21], v[62:65]
  v_bitop3_b32 v66, v66, v18, s39 bitop3:0xf6
  s_waitcnt vmcnt(4)
  v_mfma_f32_16x16x32_bf16 v[62:65], v[58:61], v[22:25], v[62:65]
  v_bitop3_b32 v66, v66, v22, s39 bitop3:0xf6
  s_waitcnt vmcnt(3)
  v_mfma_f32_16x16x32_bf16 v[62:65], v[58:61], v[26:29], v[62:65]
  v_bitop3_b32 v66, v66, v26, s39 bitop3:0xf6
  s_waitcnt vmcnt(2)
  v_mfma_f32_16x16x32_bf16 v[62:65], v[58:61], v[30:33], v[62:65]
  v_bitop3_b32 v66, v66, v30, s39 bitop3:0xf6
  s_waitcnt vmcnt(1)
  v_mfma_f32_16x16x32_bf16 v[62:65], v[58:61], v[34:37], v[62:65]
  v_bitop3_b32 v66, v66, v34, s39 bitop3:0xf6
  s_waitcnt vmcnt(0)
  v_mfma_f32_16x16x32_bf16 v[62:65], v[58:61], v[54:57], v[62:65]
  v_bitop3_b32 v66, v66, v54, s39 bitop3:0xf6
  v_and_b32 v66, 1, v66
  v_cmp_ne_u32 vcc, 0, v66
  s_cbranch_vccnz L_rretryf
L_rokf:
  s_nop 3
  v_cvt_pk_bf16_f32 v70, v62, v63
  v_cvt_pk_bf16_f32 v71, v64, v65
  buffer_store_dwordx2 v[70:71], v7, s[4:7], s22 offen
  s_add_u32 s16, s16, 262144
  s_add_u32 s17, s17, 262144
  s_add_u32 s21, s16, 4096
  s_add_u32 s22, s17, 1024
  buffer_load_dwordx4 v[54:57], v0, s[4:7], s16 offen
  buffer_load_dwordx4 v[58:61], v0, s[4:7], s21 offen
  buffer_load_dwordx4 v[62:65], v0, s[4:7], s17 offen
  buffer_load_dwordx4 v[66:69], v0, s[4:7], s22 offen
L_rjoinf:
  s_lshr_b32 s39, s10, 1
  s_and_b32 s39, s39, 1
  s_xor_b32 s28, s28, 0x80000
  s_mov_b32 s12, s13
  s_add_u32 s13, s13, 9216
  s_cmp_eq_u32 s13, 879616
  s_cselect_b32 s13, 851968, s13
  ds_read_b128 v[22:25], v2 offset:0
  ds_read_b128 v[26:29], v2 offset:1024
  ds_read_b128 v[30:33], v2 offset:2048
  ds_read_b128 v[34:37], v2 offset:3072
  v_add_u32 v70, s25, v0
  v_lshrrev_b32 v19, 2, v0
  v_add_u32 v71, s37, v19
  s_mov_b32 s31, 0
  s_barrier
  s_add_u32 s21, s12, s25
  s_add_u32 s22, s21, 4096
  s_add_u32 s23, s12, s27
  s_sleep 2
  buffer_load_dwordx4 v[10:13], v0, s[4:7], s21 offen sc1
  buffer_load_dwordx4 v[14:17], v0, s[4:7], s22 offen sc1
  buffer_load_dword v18, v19, s[4:7], s23 offen sc1
  s_branch L_stepf
L_gretryf:
  s_add_u32 s31, s31, 1
  s_add_u32 s90, s90, 1
  s_cmp_gt_u32 s31, s30
  s_cbranch_scc1 L_gfailf
  s_waitcnt vmcnt(2)
  buffer_load_dwordx4 v[10:13], v0, s[4:7], s21 offen sc1
  s_waitcnt vmcnt(2)
  buffer_load_dwordx4 v[14:17], v0, s[4:7], s22 offen sc1
  s_waitcnt vmcnt(2)
  buffer_load_dword v18, v19, s[4:7], s23 offen sc1
  s_branch L_stepf
L_gfailf:
  s_mov_b32 s30, 0
  s_branch L_gokf
L_rretryf:
  s_add_u32 s31, s31, 1
  s_add_u32 s91, s91, 1
  v_mov_b32 v66, 0
  s_cmp_le_u32 s31, s30
  s_cbranch_scc1 L_rpollf
  s_mov_b32 s30, 0
  s_nop 7
  s_branch L_rokf
L_rotherf:
  s_cmp_eq_u32 s9, 1
  s_cbranch_scc1 L_r8f
  s_add_u32 s16, s16, 262144
  s_add_u32 s17, s17, 262144
  s_add_u32 s21, s16, 4096
  s_add_u32 s22, s17, 1024
  buffer_load_dwordx4 v[54:57], v0, s[4:7], s16 offen
  buffer_load_dwordx4 v[58:61], v0, s[4:7], s21 offen
  buffer_load_dwordx4 v[62:65], v0, s[4:7], s17 offen
  buffer_load_dwordx4 v[66:69], v0, s[4:7], s22 offen
  v_mov_b64 v[38:39], 0
  v_mov_b64 v[40:41], 0
  v_mov_b64 v[42:43], 0
  v_mov_b64 v[44:45], 0
  v_mov_b64 v[46:47], 0
  v_mov_b64 v[48:49], 0
  v_mov_b64 v[50:51], 0
  v_mov_b64 v[52:53], 0
  s_lshl_b32 s58, s10, 2
  s_add_u32 s58, s58, 115408896
  s_cmp_eq_u32 s9, 3
  s_cselect_b32 s58, s58, 1073741824
  s_add_u32 s10, s10, 1
  s_add_u32 s18, s18, 131072
  s_add_u32 s19, s19, 131072
  s_xor_b32 s11, s11, 0x80000
  s_xor_b32 s33, s33, 0x80000
  s_add_u32 s21, s12, s29
  s_cmp_eq_u32 s9, 0
  s_cselect_b32 s55, s21, 1073741824
  s_cmp_eq_u32 s9, 1
  s_cselect_b32 s56, s21, 1073741824
  s_add_u32 s21, s10, 1
  s_and_b32 s22, s21, 7
  s_cmp_lg_u32 s22, 0
  s_cbranch_scc1 L_rjoinf
  s_cmp_ge_u32 s21, 64
  s_cbranch_scc1 L_rjoinf
  s_lshr_b32 s21, s21, 3
  s_add_u32 s21, s21, 24
  s_lshl_b32 s21, s21, 2
  s_mov_b32 s31, 0
L_kvpollf:
  s_waitcnt vmcnt(6)
  v_mov_b32 v10, s21
  global_load_dword v11, v10, s[62:63] sc1
  s_waitcnt vmcnt(0)
  v_readfirstlane_b32 s22, v11
  s_add_u32 s31, s31, 1
  s_cmp_gt_u32 s31, 400000
  s_cbranch_scc1 L_rjoinf
  s_cmp_lt_u32 s22, 32
  s_cbranch_scc1 L_kvpollf
  s_branch L_rjoinf
L_r8f:
  v_and_b32 v70, 0xf0, v0
  ds_read_b128 v[58:61], v70 offset:19712
  v_mov_b64 v[38:39], 0
  v_mov_b64 v[40:41], 0
  v_mov_b64 v[42:43], 0
  v_mov_b64 v[44:45], 0
  v_mov_b64 v[46:47], 0
  v_mov_b64 v[48:49], 0
  v_mov_b64 v[50:51], 0
  v_mov_b64 v[52:53], 0
  s_lshl_b32 s58, s10, 2
  s_add_u32 s58, s58, 115408896
  s_cmp_eq_u32 s9, 3
  s_cselect_b32 s58, s58, 1073741824
  s_add_u32 s10, s10, 1
  s_add_u32 s18, s18, 131072
  s_add_u32 s19, s19, 131072
  s_xor_b32 s11, s11, 0x80000
  s_xor_b32 s33, s33, 0x80000
  s_add_u32 s21, s12, s29
  s_cmp_eq_u32 s9, 0
  s_cselect_b32 s55, s21, 1073741824
  s_cmp_eq_u32 s9, 1
  s_cselect_b32 s56, s21, 1073741824
  s_mov_b32 s31, 0
  s_add_u32 s22, s13, s29
  s_waitcnt vmcnt(0)
L_rpoll8f:
  buffer_load_dwordx4 v[10:13], v8, s[4:7], s28 offen sc1
  s_add_u32 s31, s31, 1
  s_cmp_gt_u32 s31, s30
  s_cbranch_scc1 L_rfail8f
  s_waitcnt vmcnt(0) lgkmcnt(0)
  v_mfma_f32_16x16x32_bf16 v[62:65], v[58:61], v[10:13], 0
  v_xor_b32 v66, s39, v10
  v_bitop3_b32 v66, v66, v11, s39 bitop3:0xf6
  v_bitop3_b32 v66, v66, v12, s39 bitop3:0xf6
  v_bitop3_b32 v66, v66, v13, s39 bitop3:0xf6
  v_and_b32 v66, 1, v66
  v_cmp_ne_u32 vcc, 0, v66
  s_cbranch_vccnz L_rpoll8f
  s_branch L_rok8f
L_rfail8f:
  s_mov_b32 s30, 0
  s_waitcnt vmcnt(0) lgkmcnt(0)
  v_mfma_f32_16x16x32_bf16 v[62:65], v[58:61], v[10:13], 0
  s_nop 7
L_rok8f:
  s_nop 2
  v_add_f32_dpp v62, v62, v62 row_ror:2 row_mask:0xf bank_mask:0xf
  v_add_f32_dpp v63, v63, v63 row_ror:2 row_mask:0xf bank_mask:0xf
  v_add_f32_dpp v64, v64, v64 row_ror:2 row_mask:0xf bank_mask:0xf
  v_add_f32_dpp v65, v65, v65 row_ror:2 row_mask:0xf bank_mask:0xf
  v_add_f32_dpp v62, v62, v62 row_ror:4 row_mask:0xf bank_mask:0xf
  v_add_f32_dpp v63, v63, v63 row_ror:4 row_mask:0xf bank_mask:0xf
  v_add_f32_dpp v64, v64, v64 row_ror:4 row_mask:0xf bank_mask:0xf
  v_add_f32_dpp v65, v65, v65 row_ror:4 row_mask:0xf bank_mask:0xf
  v_add_f32_dpp v62, v62, v62 row_ror:8 row_mask:0xf bank_mask:0xf
  v_add_f32_dpp v63, v63, v63 row_ror:8 row_mask:0xf bank_mask:0xf
  v_add_f32_dpp v64, v64, v64 row_ror:8 row_mask:0xf bank_mask:0xf
  v_add_f32_dpp v65, v65, v65 row_ror:8 row_mask:0xf bank_mask:0xf
  v_cvt_pk_bf16_f32 v70, v62, v64
  v_cvt_pk_bf16_f32 v71, v63, v65
  buffer_store_dword v70, v7, s[4:7], s22 offen
  buffer_store_dword v71, v7, s[4:7], s22 offen offset:32
  s_add_u32 s16, s16, 262144
  s_add_u32 s17, s17, 262144
  s_add_u32 s21, s16, 4096
  s_add_u32 s22, s17, 1024
  buffer_load_dwordx4 v[54:57], v0, s[4:7], s16 offen
  buffer_load_dwordx4 v[58:61], v0, s[4:7], s21 offen
  buffer_load_dwordx4 v[62:65], v0, s[4:7], s17 offen
  buffer_load_dwordx4 v[66:69], v0, s[4:7], s22 offen
  s_branch L_rjoinf
L_steps:
  s_waitcnt vmcnt(0)
L_gchks:
  v_max3_u32 v20, v10, v11, v12
  v_max3_u32 v21, v13, v14, v15
  v_max3_u32 v20, v20, v16, v17
  v_max3_u32 v20, v20, v21, v18
  v_cmp_eq_u32 vcc, -1, v20
  s_cbranch_vccnz L_gretrys
L_goks:
  ds_write_b128 v70, v[10:13]
  ds_write_b128 v70, v[14:17] offset:4096
  ds_write_b32 v71, v18 offset:8192
  v_smfmac_f32_16x16x64_bf16 v[38:41], v[10:13], a[0:7], v1
  v_smfmac_f32_16x16x64_bf16 v[42:45], v[10:13], a[8:15], v1
  v_smfmac_f32_16x16x64_bf16 v[46:49], v[10:13], a[16:23], v1
  v_smfmac_f32_16x16x64_bf16 v[50:53], v[10:13], a[24:31], v1
  s_waitcnt lgkmcnt(0)
  s_barrier
  v_xor_b32 v71, 1024, v70
  ds_read_b128 v[18:21], v71 offset:0
  v_smfmac_f32_16x16x64_bf16 v[46:49], v[14:17], v[22:29], v1
  s_mov_b64 vcc, s[34:35]
  s_add_u32 s24, s16, 262144
  ds_read_b128 v[10:13], v71 offset:4096
  v_smfmac_f32_16x16x64_bf16 v[50:53], v[14:17], v[30:37], v1
  buffer_load_dword v9, s[4:7], s24 offen lds
  ds_read_b128 v[22:25], v2 offset:4096
  v_xor_b32 v71, 2048, v70
  v_smfmac_f32_16x16x64_bf16 v[38:41], v[14:17], a[32:39], v1
  buffer_atomic_add v8, v7, s[4:7], s58 offen sc1
  ds_read_b128 v[26:29], v2 offset:5120
  v_smfmac_f32_16x16x64_bf16 v[42:45], v[14:17], a[40:47], v1
  ds_read_b128 v[30:33], v2 offset:6144
  ds_read_b128 v[34:37], v2 offset:7168
  s_waitcnt lgkmcnt(5)
  v_smfmac_f32_16x16x64_bf16 v[46:49], v[18:21], a[64:71], v1
  ds_read_b128 v[14:17], v71 offset:0
  v_smfmac_f32_16x16x64_bf16 v[50:53], v[18:21], a[72:79], v1
  v_smfmac_f32_16x16x64_bf16 v[38:41], v[18:21], a[48:55], v1
  v_smfmac_f32_16x16x64_bf16 v[42:45], v[18:21], a[56:63], v1
  ds_read_b128 v[18:21], v71 offset:4096
  v_xor_b32 v71, 3072, v70
  s_waitcnt lgkmcnt(4)
  v_smfmac_f32_16x16x64_bf16 v[46:49], v[10:13], v[22:29], v1
  ds_read_b128 v[22:25], v2 offset:8192
  s_waitcnt lgkmcnt(3)
  v_smfmac_f32_16x16x64_bf16 v[50:53], v[10:13], v[30:37], v1
  ds_read_b128 v[26:29], v2 offset:9216
  v_smfmac_f32_16x16x64_bf16 v[38:41], v[10:13], a[80:87], v1
  ds_read_b128 v[30:33], v2 offset:10240
  v_smfmac_f32_16x16x64_bf16 v[42:45], v[10:13], a[88:95], v1
  ds_read_b128 v[34:37], v2 offset:11264
  s_waitcnt lgkmcnt(5)
  v_smfmac_f32_16x16x64_bf16 v[46:49], v[14:17], a[112:119], v1
  ds_read_b128 v[10:13], v71 offset:0
  v_smfmac_f32_16x16x64_bf16 v[50:53], v[14:17], a[120:127], v1
  v_smfmac_f32_16x16x64_bf16 v[38:41], v[14:17], a[96:103], v1
  v_smfmac_f32_16x16x64_bf16 v[42:45], v[14:17], a[104:111], v1
  ds_read_b128 v[14:17], v71 offset:4096
  s_waitcnt lgkmcnt(4)
  v_smfmac_f32_16x16x64_bf16 v[46:49], v[18:21], v[22:29], v1
  ds_read_b128 v[22:25], v2 offset:12288
  s_waitcnt lgkmcnt(3)
  v_smfmac_f32_16x16x64_bf16 v[50:53], v[18:21], v[30:37], v1
  ds_read_b128 v[26:29], v2 offset:13312
  v_smfmac_f32_16x16x64_bf16 v[38:41], v[18:21], a[128:135], v1
  ds_read_b128 v[30:33], v2 offset:14336
  v_smfmac_f32_16x16x64_bf16 v[42:45], v[18:21], a[136:143], v1
  ds_read_b128 v[34:37], v2 offset:15360
  s_waitcnt lgkmcnt(5)
  v_smfmac_f32_16x16x64_bf16 v[38:41], v[10:13], a[144:151], v1
  ds_read_b128 v[18:21], v0 offset:8192
  v_smfmac_f32_16x16x64_bf16 v[42:45], v[10:13], a[152:159], v1
  v_smfmac_f32_16x16x64_bf16 v[46:49], v[10:13], a[160:167], v1
  v_smfmac_f32_16x16x64_bf16 v[50:53], v[10:13], a[168:175], v1
  ds_read_b128 v[10:13], v0 offset:0
  s_waitcnt lgkmcnt(6)
  v_smfmac_f32_16x16x64_bf16 v[38:41], v[14:17], a[176:183], v1
  v_smfmac_f32_16x16x64_bf16 v[42:45], v[14:17], a[184:191], v1
  s_waitcnt lgkmcnt(4)
  v_smfmac_f32_16x16x64_bf16 v[46:49], v[14:17], v[22:29], v1
  v_mov_b64 v[22:23], 0
  s_waitcnt lgkmcnt(2)
  v_smfmac_f32_16x16x64_bf16 v[50:53], v[14:17], v[30:37], v1
  ds_read_b128 v[14:17], v0 offset:1024
  v_add_u32 v35, s59, v0
  s_waitcnt lgkmcnt(2)
  v_smfmac_f32_16x16x64_bf16 v[38:41], v[18:21], a[192:199], v1
  v_mov_b64 v[24:25], 0
  v_smfmac_f32_16x16x64_bf16 v[42:45], v[18:21], a[200:207], v1
  v_mov_b64 v[26:27], 0
  v_smfmac_f32_16x16x64_bf16 v[46:49], v[18:21], a[208:215], v1
  v_add_f32 v38, v38, v39
  v_smfmac_f32_16x16x64_bf16 v[50:53], v[18:21], a[216:223], v1
  ds_read_b128 v[18:21], v0 offset:2048
  v_add_f32 v40, v40, v41
  v_add_f32 v42, v42, v43
  s_nop 0
  v_add_f32 v46, v46, v47
  v_add_f32 v48, v48, v49
  v_add_f32 v44, v44, v45
  v_cvt_pk_bf16_f32 v46, v46, v48
  v_add_f32 v50, v50, v51
  v_add_f32 v52, v52, v53
  v_cvt_pk_bf16_f32 v47, v38, v40
  v_cvt_pk_bf16_f32 v50, v50, v52
  v_cvt_pk_bf16_f32 v51, v42, v44
  v_mfma_f32_16x16x16_bf16 v[38:41], v[46:47], v[4:5], 0
  v_mov_b64 v[28:29], 0
  v_mfma_f32_16x16x16_bf16 v[42:45], v[50:51], v[4:5], 0
  s_waitcnt lgkmcnt(2)
  v_smfmac_f32_16x16x64_bf16 v[22:25], v[10:13], a[224:231], v1
  v_cvt_pk_bf16_f32 v30, v38, v39
  v_cvt_pk_bf16_f32 v31, v40, v41
  s_nop 1
  v_cvt_pk_bf16_f32 v32, v42, v43
  v_cvt_pk_bf16_f32 v33, v44, v45
  v_smfmac_f32_16x16x64_bf16 v[26:29], v[10:13], a[232:239], v1
  ds_read_b128 v[10:13], v0 offset:3072
  v_mfma_f32_16x16x32_bf16 v[50:53], v[54:57], v[30:33], 0
  v_mfma_f32_16x16x32_bf16 v[38:41], v[58:61], v[30:33], 0
  v_mfma_f32_16x16x32_bf16 v[46:49], v[30:33], v[30:33], 0
  s_waitcnt lgkmcnt(2)
  v_smfmac_f32_16x16x64_bf16 v[22:25], v[14:17], a[240:247], v1
  v_cndmask_b32_dpp v42, v38, v50, vcc quad_perm:[2,3,2,3] row_mask:0xf bank_mask:0xf
  v_cndmask_b32_dpp v43, v39, v51, vcc quad_perm:[2,3,2,3] row_mask:0xf bank_mask:0xf
  v_cndmask_b32_dpp v44, v40, v52, vcc quad_perm:[2,3,2,3] row_mask:0xf bank_mask:0xf
  v_cndmask_b32_dpp v45, v41, v53, vcc quad_perm:[2,3,2,3] row_mask:0xf bank_mask:0xf
  v_cndmask_b32_dpp v34, v47, v46, vcc quad_perm:[2,3,2,3] row_mask:0xf bank_mask:0xf
  ds_write_b128 v70, v[42:45] offset:9216
  v_smfmac_f32_16x16x64_bf16 v[26:29], v[14:17], a[248:255], v1
  ds_write_b32 v35, v34 offset:13312
  buffer_store_dwordx4 v[30:33], v0, s[4:7], s18 offen sc1
  ds_read_b128 v[14:17], v0 offset:4096
  s_waitcnt lgkmcnt(0)
  s_barrier
  ds_read_b128 v[38:41], v0 offset:9216
  v_smfmac_f32_16x16x64_bf16 v[22:25], v[18:21], v[72:79], v1
  ds_read_b128 v[42:45], v0 offset:10240
  v_smfmac_f32_16x16x64_bf16 v[26:29], v[18:21], v[80:87], v1
  ds_read_b128 v[46:49], v0 offset:11264
  v_smfmac_f32_16x16x64_bf16 v[22:25], v[10:13], v[88:95], v1
  ds_read_b128 v[50:53], v0 offset:12288
  v_smfmac_f32_16x16x64_bf16 v[26:29], v[10:13], v[96:103], v1
  ds_read_b128 v[30:33], v0 offset:13312
  v_smfmac_f32_16x16x64_bf16 v[22:25], v[14:17], v[104:111], v1
  ds_read_b128 v[18:21], v0 offset:5120
  v_smfmac_f32_16x16x64_bf16 v[26:29], v[14:17], v[112:119], v1
  ds_read_b128 v[10:13], v0 offset:6144
  s_waitcnt lgkmcnt(5)
  v_add_f32 v38, v38, v42
  v_add_f32 v39, v39, v43
  v_add_f32 v40, v40, v44
  v_add_f32 v41, v41, v45
  ds_read_b128 v[14:17], v0 offset:7168
  v_mov_b64 v[34:35], -1
  buffer_store_dwordx2 v[34:35], v7, s[4:7], s55 offen sc1
  s_waitcnt lgkmcnt(4)
  v_add_f32 v46, v46, v50
  v_add_f32 v47, v47, v51
  v_add_f32 v48, v48, v52
  v_add_f32 v38, v38, v46
  v_add_f32 v39, v39, v47
  v_add_f32 v40, v40, v48
  v_add_f32 v49, v49, v53
  s_waitcnt lgkmcnt(3)
  v_add_f32 v30, v30, v31
  v_add_f32 v32, v32, v33
  v_add_f32 v41, v41, v49
  v_add_f32 v30, v30, v32
  v_max3_f32 v42, v38, v39, v40
  v_max3_f32 v42, v42, v41, v30
  s_waitcnt lgkmcnt(2)
  v_smfmac_f32_16x16x64_bf16 v[22:25], v[18:21], v[120:127], v1
  ds_read_b128 v[48:51], v0 offset:20864
  buffer_store_dword v34, v7, s[4:7], s56 offen sc1
  v_max_f32_dpp v42, v42, v42 quad_perm:[2,3,0,1] row_mask:0xf bank_mask:0xf
  v_mov_b32 v43, v42
  v_smfmac_f32_16x16x64_bf16 v[26:29], v[18:21], v[128:135], v1
  ds_read_b128 v[18:21], v0 offset:8192
  buffer_store_dword v34, v7, s[4:7], s56 offen offset:32 sc1
  v_permlane16_swap_b32 v42, v43
  ds_read_b64 v[52:53], v0 offset:21888
  v_max_f32 v42, v42, v43
  v_mov_b32 v43, v42
  s_waitcnt lgkmcnt(4)
  v_smfmac_f32_16x16x64_bf16 v[22:25], v[10:13], v[136:143], v1
  ds_read_b128 v[54:57], v2 offset:16384
  v_permlane32_swap_b32 v42, v43
  v_max_f32 v42, v42, v43
  v_mul_f32 v42, s20, v42
  v_fma_f32 v38, v38, s20, -v42
  v_fma_f32 v39, v39, s20, -v42
  v_fma_f32 v40, v40, s20, -v42
  v_fma_f32 v41, v41, s20, -v42
  v_fma_f32 v30, v30, s20, -v42
  v_exp_f32 v38, v38
  ds_read_b128 v[58:61], v2 offset:17408
  v_exp_f32 v39, v39
  v_exp_f32 v40, v40
  v_exp_f32 v41, v41
  v_exp_f32 v30, v30
  v_cvt_pk_bf16_f32 v44, v38, v39
  v_cvt_pk_bf16_f32 v45, v40, v41
  v_cvt_pk_bf16_f32 v32, v30, v30
  v_mov_b32_dpp v46, v44 quad_perm:[0,1,0,1] row_mask:0xf bank_mask:0xf
  v_mov_b32_dpp v47, v45 quad_perm:[0,1,0,1] row_mask:0xf bank_mask:0xf
  v_mov_b32_dpp v33, v32 quad_perm:[0,1,0,1] row_mask:0xf bank_mask:0xf
  v_smfmac_f32_16x16x64_bf16 v[26:29], v[10:13], v[144:151], v1
  s_waitcnt lgkmcnt(5)
  v_smfmac_f32_16x16x64_bf16 v[22:25], v[14:17], v[152:159], v1
  v_smfmac_f32_16x16x64_bf16 v[26:29], v[14:17], v[160:167], v1
  s_waitcnt lgkmcnt(3)
  v_smfmac_f32_16x16x64_bf16 v[22:25], v[18:21], v[168:175], v1
  v_smfmac_f32_16x16x64_bf16 v[26:29], v[18:21], v[176:183], v1
  v_mfma_f32_16x16x32_bf16 v[34:37], v[48:51], v[44:47], 0
  v_cvt_pk_bf16_f32 v22, v22, v23
  v_cvt_pk_bf16_f32 v23, v24, v25
  v_mfma_f32_16x16x32_bf16 v[38:41], v[62:65], v[44:47], 0
  v_cvt_pk_bf16_f32 v24, v26, v27
  v_cvt_pk_bf16_f32 v25, v28, v29
  v_mfma_f32_16x16x32_bf16 v[10:13], v[66:69], v[44:47], 0
  s_waitcnt lgkmcnt(2)
  v_mfma_f32_16x16x16_bf16 v[34:37], v[52:53], v[32:33], v[34:37]
  v_mfma_f32_16x16x16_bf16 v[38:41], v[22:23], v[32:33], v[38:41]
  v_mfma_f32_16x16x16_bf16 v[10:13], v[24:25], v[32:33], v[10:13]
  v_rcp_f32 v42, v34
  s_nop 2
  v_pk_mul_f32 v[38:39], v[38:39], v[42:43] op_sel_hi:[1,0]
  v_pk_mul_f32 v[40:41], v[40:41], v[42:43] op_sel_hi:[1,0]
  v_cvt_pk_bf16_f32 v38, v38, v39
  v_cvt_pk_bf16_f32 v39, v40, v41
  v_pk_mul_f32 v[10:11], v[10:11], v[42:43] op_sel_hi:[1,0]
  v_pk_mul_f32 v[12:13], v[12:13], v[42:43] op_sel_hi:[1,0]
  v_cvt_pk_bf16_f32 v10, v10, v11
  v_cvt_pk_bf16_f32 v11, v12, v13
  ds_write_b64 v3, v[38:39] offset:0
  ds_write_b64 v3, v[10:11] offset:32
  buffer_store_dwordx4 v[22:25], v0, s[4:7], s19 offen sc1
  v_mov_b64 v[42:43], 0
  v_mov_b64 v[44:45], 0
  v_mov_b64 v[46:47], 0
  v_mov_b64 v[48:49], 0
  v_mov_b64 v[50:51], 0
  v_mov_b64 v[52:53], 0
  v_mov_b64 v[40:41], 0
  v_mov_b64 v[38:39], 0
  s_cmp_eq_u32 s10, s38
  s_cbranch_scc1 L_chain_end
  s_waitcnt lgkmcnt(0)
  s_barrier
  ds_read_b128 v[14:17], v6 offset:0
  v_lshrrev_b32 v71, 2, v0
  ds_read_b128 v[18:21], v6 offset:128
  ds_read_b128 v[62:65], v2 offset:18432
  ds_read_b128 v[66:69], v2 offset:19456
  ds_read_b128 v[22:25], v2 offset:20480
  ds_read_b128 v[26:29], v2 offset:21504
  s_waitcnt lgkmcnt(5)
  v_smfmac_f32_16x16x64_bf16 v[38:41], v[14:17], v[184:191], v1
  ds_read_b128 v[30:33], v2 offset:22528
  v_smfmac_f32_16x16x64_bf16 v[42:45], v[14:17], v[192:199], v1
  ds_read_b128 v[34:37], v2 offset:23552
  s_waitcnt lgkmcnt(6)
  v_smfmac_f32_16x16x64_bf16 v[38:41], v[18:21], v[54:61], v1
  ds_read_b128 v[54:57], v2 offset:24576
  s_waitcnt lgkmcnt(5)
  v_smfmac_f32_16x16x64_bf16 v[42:45], v[18:21], v[62:69], v1
  ds_read_b128 v[58:61], v2 offset:25600
  v_smfmac_f32_16x16x64_bf16 v[46:49], v[14:17], v[200:207], v1
  ds_read_b128 v[62:65], v2 offset:26624
  v_add_f32 v38, v38, v39
  v_add_f32 v40, v40, v41
  s_nop 0
  v_add_f32 v42, v42, v43
  ds_read_b128 v[66:69], v2 offset:27648
  v_add_f32 v44, v44, v45
  v_cvt_pk_bf16_f32 v10, v38, v42
  v_cvt_pk_bf16_f32 v12, v40, v44
  v_mov_b64 v[38:39], 0
  v_mov_b64 v[40:41], 0
  v_smfmac_f32_16x16x64_bf16 v[50:53], v[14:17], v[208:215], v1
  v_mov_b64 v[42:43], 0
  v_smfmac_f32_16x16x64_bf16 v[38:41], v[14:17], v[216:223], v1
  v_mov_b64 v[44:45], 0
  s_waitcnt lgkmcnt(6)
  v_smfmac_f32_16x16x64_bf16 v[46:49], v[18:21], v[22:29], v1
  ds_read_b128 v[22:25], v2 offset:28672
  v_bfi_b32 v10, 1, s39, v10
  s_waitcnt lgkmcnt(5)
  v_smfmac_f32_16x16x64_bf16 v[50:53], v[18:21], v[30:37], v1
  ds_read_b128 v[26:29], v2 offset:29696
  v_smfmac_f32_16x16x64_bf16 v[42:45], v[14:17], v[224:231], v1
  ds_read_b128 v[30:33], v2 offset:30720
  v_add_f32 v46, v46, v47
  s_waitcnt lgkmcnt(5)
  v_smfmac_f32_16x16x64_bf16 v[38:41], v[18:21], v[54:61], v1
  ds_read_b128 v[34:37], v2 offset:31744
  v_add_f32 v48, v48, v49
  s_waitcnt lgkmcnt(4)
  v_smfmac_f32_16x16x64_bf16 v[42:45], v[18:21], v[62:69], v1
  ds_read_b128 v[54:57], v2 offset:32768
  v_add_f32 v50, v50, v51
  v_add_f32 v52, v52, v53
  ds_read_b128 v[58:61], v2 offset:33792
  v_cvt_pk_bf16_f32 v11, v46, v50
  v_cvt_pk_bf16_f32 v13, v48, v52
  v_add_f32 v38, v38, v39
  v_add_f32 v40, v40, v41
  v_add_f32 v42, v42, v43
  v_add_f32 v44, v44, v45
  v_mov_b64 v[46:47], 0
  v_mov_b64 v[48:49], 0
  v_mov_b64 v[50:51], 0
  v_mov_b64 v[52:53], 0
  buffer_store_dwordx4 v[10:13], v0, s[4:7], s11 offen offset:0 sc1
  s_nop 1
  v_cvt_pk_bf16_f32 v10, v38, v42
  v_cvt_pk_bf16_f32 v12, v40, v44
  v_mov_b64 v[38:39], 0
  v_mov_b64 v[40:41], 0
  v_smfmac_f32_16x16x64_bf16 v[46:49], v[14:17], v[232:239], v1
  v_bfi_b32 v10, 1, s39, v10
  v_smfmac_f32_16x16x64_bf16 v[50:53], v[14:17], v[240:247], v1
  v_smfmac_f32_16x16x64_bf16 v[38:41], v[14:17], v[248:255], v1
  s_waitcnt lgkmcnt(4)
  v_smfmac_f32_16x16x64_bf16 v[46:49], v[18:21], v[22:29], v1
  s_waitcnt lgkmcnt(2)
  v_smfmac_f32_16x16x64_bf16 v[50:53], v[18:21], v[30:37], v1
  s_waitcnt lgkmcnt(0)
  v_smfmac_f32_16x16x64_bf16 v[38:41], v[18:21], v[54:61], v1
  v_add_f32 v46, v46, v47
  v_add_f32 v48, v48, v49
  s_nop 1
  v_add_f32 v50, v50, v51
  v_add_f32 v52, v52, v53
  v_cvt_pk_bf16_f32 v11, v46, v50
  v_cvt_pk_bf16_f32 v13, v48, v52
  v_add_f32 v38, v38, v39
  v_add_f32 v40, v40, v41
  v_cvt_pk_bf16_f32 v70, v38, v40
  buffer_store_dwordx4 v[10:13], v0, s[4:7], s11 offen offset:1024 sc1
  v_bfi_b32 v70, 1, s39, v70
  buffer_store_dword v70, v71, s[4:7], s33 offen sc1
  s_cmp_lg_u32 s9, 0
  s_cbranch_scc1 L_rothers
  v_and_b32 v70, 0xf0, v0
  ds_read_b128 v[58:61], v70 offset:19712
  v_mov_b64 v[38:39], 0
  v_mov_b64 v[40:41], 0
  v_mov_b64 v[42:43], 0
  v_mov_b64 v[44:45], 0
  v_mov_b64 v[46:47], 0
  v_mov_b64 v[48:49], 0
  v_mov_b64 v[50:51], 0
  v_mov_b64 v[52:53], 0
  s_lshl_b32 s58, s10, 2
  s_add_u32 s58, s58, 115408896
  s_cmp_eq_u32 s9, 3
  s_cselect_b32 s58, s58, 1073741824
  s_add_u32 s10, s10, 1
  s_add_u32 s18, s18, 131072
  s_add_u32 s19, s19, 131072
  s_xor_b32 s11, s11, 0x80000
  s_xor_b32 s33, s33, 0x80000
  s_add_u32 s21, s12, s29
  s_cmp_eq_u32 s9, 0
  s_cselect_b32 s55, s21, 1073741824
  s_cmp_eq_u32 s9, 1
  s_cselect_b32 s56, s21, 1073741824
  s_mov_b32 s31, 0
  v_mov_b32 v66, 0
  s_waitcnt vmcnt(0)
L_rpolls:
  s_mov_b32 s21, s28
  buffer_load_dwordx4 v[10:13], v8, s[4:7], s21 offen sc1
  s_add_u32 s21, s21, 36864
  buffer_load_dwordx4 v[14:17], v8, s[4:7], s21 offen sc1
  s_add_u32 s21, s21, 36864
  buffer_load_dwordx4 v[18:21], v8, s[4:7], s21 offen sc1
  s_add_u32 s21, s21, 36864
  buffer_load_dwordx4 v[22:25], v8, s[4:7], s21 offen sc1
  s_add_u32 s21, s21, 36864
  buffer_load_dwordx4 v[26:29], v8, s[4:7], s21 offen sc1
  s_add_u32 s21, s21, 36864
  buffer_load_dwordx4 v[30:33], v8, s[4:7], s21 offen sc1
  s_add_u32 s21, s21, 36864
  buffer_load_dwordx4 v[34:37], v8, s[4:7], s21 offen sc1
  s_add_u32 s21, s21, 36864
  buffer_load_dwordx4 v[54:57], v8, s[4:7], s21 offen sc1
  s_add_u32 s22, s13, s29
  s_waitcnt lgkmcnt(0)
  s_waitcnt vmcnt(7)
  v_mfma_f32_16x16x32_bf16 v[62:65], v[58:61], v[10:13], 0
  v_bitop3_b32 v66, v66, v10, s39 bitop3:0xf6
  s_waitcnt vmcnt(6)
  v_mfma_f32_16x16x32_bf16 v[62:65], v[58:61], v[14:17], v[62:65]
  v_bitop3_b32 v66, v66, v14, s39 bitop3:0xf6
  s_waitcnt vmcnt(5)
  v_mfma_f32_16x16x32_bf16 v[62:65], v[58:61], v[18:21], v[62:65]
  v_bitop3_b32 v66, v66, v18, s39 bitop3:0xf6
  s_waitcnt vmcnt(4)
  v_mfma_f32_16x16x32_bf16 v[62:65], v[58:61], v[22:25], v[62:65]
  v_bitop3_b32 v66, v66, v22, s39 bitop3:0xf6
  s_waitcnt vmcnt(3)
  v_mfma_f32_16x16x32_bf16 v[62:65], v[58:61], v[26:29], v[62:65]
  v_bitop3_b32 v66, v66, v26, s39 bitop3:0xf6
  s_waitcnt vmcnt(2)
  v_mfma_f32_16x16x32_bf16 v[62:65], v[58:61], v[30:33], v[62:65]
  v_bitop3_b32 v66, v66, v30, s39 bitop3:0xf6
  s_waitcnt vmcnt(1)
  v_mfma_f32_16x16x32_bf16 v[62:65], v[58:61], v[34:37], v[62:65]
  v_bitop3_b32 v66, v66, v34, s39 bitop3:0xf6
  s_waitcnt vmcnt(0)
  v_mfma_f32_16x16x32_bf16 v[62:65], v[58:61], v[54:57], v[62:65]
  v_bitop3_b32 v66, v66, v54, s39 bitop3:0xf6
  v_and_b32 v66, 1, v66
  v_cmp_ne_u32 vcc, 0, v66
  s_cbranch_vccnz L_rretrys
L_roks:
  s_nop 3
  v_cvt_pk_bf16_f32 v70, v62, v63
  v_cvt_pk_bf16_f32 v71, v64, v65
  buffer_store_dwordx2 v[70:71], v7, s[4:7], s22 offen sc1
  s_add_u32 s16, s16, 262144
  s_add_u32 s17, s17, 262144
  s_add_u32 s21, s16, 4096
  s_add_u32 s22, s17, 1024
  buffer_load_dwordx4 v[54:57], v0, s[4:7], s16 offen
  buffer_load_dwordx4 v[58:61], v0, s[4:7], s21 offen
  buffer_load_dwordx4 v[62:65], v0, s[4:7], s17 offen
  buffer_load_dwordx4 v[66:69], v0, s[4:7], s22 offen
L_rjoins:
  s_lshr_b32 s39, s10, 1
  s_and_b32 s39, s39, 1
  s_xor_b32 s28, s28, 0x80000
  s_mov_b32 s12, s13
  s_add_u32 s13, s13, 9216
  s_cmp_eq_u32 s13, 879616
  s_cselect_b32 s13, 851968, s13
  ds_read_b128 v[22:25], v2 offset:0
  ds_read_b128 v[26:29], v2 offset:1024
  ds_read_b128 v[30:33], v2 offset:2048
  ds_read_b128 v[34:37], v2 offset:3072
  v_add_u32 v70, s25, v0
  v_lshrrev_b32 v19, 2, v0
  v_add_u32 v71, s37, v19
  s_mov_b32 s31, 0
  s_barrier
  s_add_u32 s21, s12, s25
  s_add_u32 s22, s21, 4096
  s_add_u32 s23, s12, s27
  s_sleep 2
  buffer_load_dwordx4 v[10:13], v0, s[4:7], s21 offen sc1
  buffer_load_dwordx4 v[14:17], v0, s[4:7], s22 offen sc1
  buffer_load_dword v18, v19, s[4:7], s23 offen sc1
  s_branch L_steps
L_gretrys:
  s_add_u32 s31, s31, 1
  s_add_u32 s90, s90, 1
  s_cmp_gt_u32 s31, s30
  s_cbranch_scc1 L_gfails
  s_waitcnt vmcnt(2)
  buffer_load_dwordx4 v[10:13], v0, s[4:7], s21 offen sc1
  s_waitcnt vmcnt(2)
  buffer_load_dwordx4 v[14:17], v0, s[4:7], s22 offen sc1
  s_waitcnt vmcnt(2)
  buffer_load_dword v18, v19, s[4:7], s23 offen sc1
  s_branch L_steps
L_gfails:
  s_mov_b32 s30, 0
  s_branch L_goks
L_rretrys:
  s_add_u32 s31, s31, 1
  s_add_u32 s91, s91, 1
  v_mov_b32 v66, 0
  s_cmp_le_u32 s31, s30
  s_cbranch_scc1 L_rpolls
  s_mov_b32 s30, 0
  s_nop 7
  s_branch L_roks
L_rothers:
  s_cmp_eq_u32 s9, 1
  s_cbranch_scc1 L_r8s
  s_add_u32 s16, s16, 262144
  s_add_u32 s17, s17, 262144
  s_add_u32 s21, s16, 4096
  s_add_u32 s22, s17, 1024
  buffer_load_dwordx4 v[54:57], v0, s[4:7], s16 offen
  buffer_load_dwordx4 v[58:61], v0, s[4:7], s21 offen
  buffer_load_dwordx4 v[62:65], v0, s[4:7], s17 offen
  buffer_load_dwordx4 v[66:69], v0, s[4:7], s22 offen
  v_mov_b64 v[38:39], 0
  v_mov_b64 v[40:41], 0
  v_mov_b64 v[42:43], 0
  v_mov_b64 v[44:45], 0
  v_mov_b64 v[46:47], 0
  v_mov_b64 v[48:49], 0
  v_mov_b64 v[50:51], 0
  v_mov_b64 v[52:53], 0
  s_lshl_b32 s58, s10, 2
  s_add_u32 s58, s58, 115408896
  s_cmp_eq_u32 s9, 3
  s_cselect_b32 s58, s58, 1073741824
  s_add_u32 s10, s10, 1
  s_add_u32 s18, s18, 131072
  s_add_u32 s19, s19, 131072
  s_xor_b32 s11, s11, 0x80000
  s_xor_b32 s33, s33, 0x80000
  s_add_u32 s21, s12, s29
  s_cmp_eq_u32 s9, 0
  s_cselect_b32 s55, s21, 1073741824
  s_cmp_eq_u32 s9, 1
  s_cselect_b32 s56, s21, 1073741824
  s_add_u32 s21, s10, 1
  s_and_b32 s22, s21, 7
  s_cmp_lg_u32 s22, 0
  s_cbranch_scc1 L_rjoins
  s_cmp_ge_u32 s21, 64
  s_cbranch_scc1 L_rjoins
  s_lshr_b32 s21, s21, 3
  s_add_u32 s21, s21, 24
  s_lshl_b32 s21, s21, 2
  s_mov_b32 s31, 0
L_kvpolls:
  s_waitcnt vmcnt(6)
  v_mov_b32 v10, s21
  global_load_dword v11, v10, s[62:63] sc1
  s_waitcnt vmcnt(0)
  v_readfirstlane_b32 s22, v11
  s_add_u32 s31, s31, 1
  s_cmp_gt_u32 s31, 400000
  s_cbranch_scc1 L_rjoins
  s_cmp_lt_u32 s22, 32
  s_cbranch_scc1 L_kvpolls
  s_branch L_rjoins
L_r8s:
  v_and_b32 v70, 0xf0, v0
  ds_read_b128 v[58:61], v70 offset:19712
  v_mov_b64 v[38:39], 0
  v_mov_b64 v[40:41], 0
  v_mov_b64 v[42:43], 0
  v_mov_b64 v[44:45], 0
  v_mov_b64 v[46:47], 0
  v_mov_b64 v[48:49], 0
  v_mov_b64 v[50:51], 0
  v_mov_b64 v[52:53], 0
  s_lshl_b32 s58, s10, 2
  s_add_u32 s58, s58, 115408896
  s_cmp_eq_u32 s9, 3
  s_cselect_b32 s58, s58, 1073741824
  s_add_u32 s10, s10, 1
  s_add_u32 s18, s18, 131072
  s_add_u32 s19, s19, 131072
  s_xor_b32 s11, s11, 0x80000
  s_xor_b32 s33, s33, 0x80000
  s_add_u32 s21, s12, s29
  s_cmp_eq_u32 s9, 0
  s_cselect_b32 s55, s21, 1073741824
  s_cmp_eq_u32 s9, 1
  s_cselect_b32 s56, s21, 1073741824
  s_mov_b32 s31, 0
  s_add_u32 s22, s13, s29
  s_waitcnt vmcnt(0)
L_rpoll8s:
  buffer_load_dwordx4 v[10:13], v8, s[4:7], s28 offen sc1
  s_add_u32 s31, s31, 1
  s_cmp_gt_u32 s31, s30
  s_cbranch_scc1 L_rfail8s
  s_waitcnt vmcnt(0) lgkmcnt(0)
  v_mfma_f32_16x16x32_bf16 v[62:65], v[58:61], v[10:13], 0
  v_xor_b32 v66, s39, v10
  v_bitop3_b32 v66, v66, v11, s39 bitop3:0xf6
  v_bitop3_b32 v66, v66, v12, s39 bitop3:0xf6
  v_bitop3_b32 v66, v66, v13, s39 bitop3:0xf6
  v_and_b32 v66, 1, v66
  v_cmp_ne_u32 vcc, 0, v66
  s_cbranch_vccnz L_rpoll8s
  s_branch L_rok8s
L_rfail8s:
  s_mov_b32 s30, 0
  s_waitcnt vmcnt(0) lgkmcnt(0)
  v_mfma_f32_16x16x32_bf16 v[62:65], v[58:61], v[10:13], 0
  s_nop 7
L_rok8s:
  s_nop 2
  v_add_f32_dpp v62, v62, v62 row_ror:2 row_mask:0xf bank_mask:0xf
  v_add_f32_dpp v63, v63, v63 row_ror:2 row_mask:0xf bank_mask:0xf
  v_add_f32_dpp v64, v64, v64 row_ror:2 row_mask:0xf bank_mask:0xf
  v_add_f32_dpp v65, v65, v65 row_ror:2 row_mask:0xf bank_mask:0xf
  v_add_f32_dpp v62, v62, v62 row_ror:4 row_mask:0xf bank_mask:0xf
  v_add_f32_dpp v63, v63, v63 row_ror:4 row_mask:0xf bank_mask:0xf
  v_add_f32_dpp v64, v64, v64 row_ror:4 row_mask:0xf bank_mask:0xf
  v_add_f32_dpp v65, v65, v65 row_ror:4 row_mask:0xf bank_mask:0xf
  v_add_f32_dpp v62, v62, v62 row_ror:8 row_mask:0xf bank_mask:0xf
  v_add_f32_dpp v63, v63, v63 row_ror:8 row_mask:0xf bank_mask:0xf
  v_add_f32_dpp v64, v64, v64 row_ror:8 row_mask:0xf bank_mask:0xf
  v_add_f32_dpp v65, v65, v65 row_ror:8 row_mask:0xf bank_mask:0xf
  v_cvt_pk_bf16_f32 v70, v62, v64
  v_cvt_pk_bf16_f32 v71, v63, v65
  buffer_store_dword v70, v7, s[4:7], s22 offen sc1
  buffer_store_dword v71, v7, s[4:7], s22 offen offset:32 sc1
  s_add_u32 s16, s16, 262144
  s_add_u32 s17, s17, 262144
  s_add_u32 s21, s16, 4096
  s_add_u32 s22, s17, 1024
  buffer_load_dwordx4 v[54:57], v0, s[4:7], s16 offen
  buffer_load_dwordx4 v[58:61], v0, s[4:7], s21 offen
  buffer_load_dwordx4 v[62:65], v0, s[4:7], s17 offen
  buffer_load_dwordx4 v[66:69], v0, s[4:7], s22 offen
  s_branch L_rjoins
L_chain_end:
  s_waitcnt vmcnt(0)
  s_barrier
  s_mov_b32 s21, 115409148
  s_cmp_eq_u32 s9, 3
  s_cselect_b32 s21, s21, 1073741824
  buffer_atomic_add v8, v7, s[4:7], s21 offen sc1
  s_waitcnt vmcnt(0)
  s_branch L_main_exit
L_worker_end:
L_main_exit:
  s_endpgm
.section .rodata,"a"
.p2align 6
.amdhsa_kernel gated_mix__memory_aug_recurrent_mem_tr__swiglu_ffn__prompt_kernel
  .amdhsa_next_free_vgpr 512
  .amdhsa_next_free_sgpr 102
  .amdhsa_accum_offset 256
  .amdhsa_group_segment_fixed_size 0
  .amdhsa_kernarg_size 120
  .amdhsa_user_sgpr_count 2
  .amdhsa_user_sgpr_kernarg_segment_ptr 1
  .amdhsa_system_sgpr_workgroup_id_x 1
.end_amdhsa_kernel
```
